```python
import torch

def _softmax(x, axis=-1):
    return torch.softmax(x, dim=axis)

def _gelu(x):
    return torch.nn.functional.gelu(x, approximate='tanh')

def _silu(x):
    return torch.nn.functional.silu(x)

def _sigmoid(x):
    return torch.sigmoid(x)

def _layernorm(x, axis=-1, eps=1e-05):
    m = x.mean(dim=axis, keepdim=True)
    v = x.var(dim=axis, keepdim=True, unbiased=False)
    return (x - m) / torch.sqrt(v + eps)

def _scatter_add(tgt, idx, src, axis=0):
    return tgt.clone().index_add_(axis, idx, src)

def _segment_sum(src, seg, n):
    out = torch.zeros((n,) + src.shape[1:], dtype=src.dtype)
    return out.index_add_(0, seg, src)

def _pad(x, pw):
    flat = tuple((v for pair in reversed(pw) for v in pair))
    return torch.nn.functional.pad(x, flat)
kernel_name = 'parallel_sum__linear_attn_block__mixer_gmlp__prompt'

def setup_inputs():

    _w = lambda a: (lambda t: t.to(torch.bfloat16) if t.is_floating_point() else t)(torch.as_tensor(a))

    def _A_setup():
        B, S, D = (1, 2048, 448)
        return {'x': _w((lambda *s: torch.randn(*s, dtype=torch.bfloat16) * 0.05)(B, S, D)), 'wqkv': _w((lambda *s: torch.randn(*s, dtype=torch.bfloat16) * 1.6)(D, 3 * D)), 'wo': _w((lambda *s: torch.randn(*s, dtype=torch.bfloat16) * 0.2)(D, D))}
    _A_in = _A_setup()

    def _B_setup():
        B, S, D, F = (1, 2048, 448, 1792)
        Fh = F // 2
        return {'x': _w((lambda *s: torch.randn(*s, dtype=torch.bfloat16) * 0.05)(B, S, D)), 'w_in': _w((lambda *s: torch.randn(*s, dtype=torch.bfloat16) * 0.4)(D, 2 * Fh)), 'w_sp': _w(0.01 * (lambda *s: torch.randn(*s, dtype=torch.bfloat16) * 0.4)(S, S)), 'b_sp': _w(1.0 + 0.01 * (lambda *s: torch.randn(*s, dtype=torch.bfloat16) * 0.05)(S)), 'w_out': _w((lambda *s: torch.randn(*s, dtype=torch.bfloat16) * 0.05)(Fh, D))}
    _B_in = _B_setup()
    return {'A_x': _A_in['x'], 'A_wqkv': _A_in['wqkv'], 'A_wo': _A_in['wo'], 'B_x': _B_in['x'], 'B_w_in': _B_in['w_in'], 'B_w_sp': _B_in['w_sp'], 'B_b_sp': _B_in['b_sp'], 'B_w_out': _B_in['w_out']}

def reference(A_x, A_wqkv, A_wo, B_x, B_w_in, B_w_sp, B_b_sp, B_w_out):

    def _A_ref(x, wqkv, wo):
        B, S, D = x.shape
        H = 16
        Dh = D // H
        qkv = (lambda x, *d: x.permute(*d))((x @ wqkv).reshape(B, S, 3, H, Dh), 2, 0, 3, 1, 4)
        q, k, v = (qkv[0], qkv[1], qkv[2])
        phi = lambda t: torch.where(t > 0, t + 1, torch.exp(t)) + 1e-06
        pq, pk = (phi(q), phi(k))
        kv = torch.einsum('bhsd,bhse->bhde', pk, v)
        z = torch.einsum('bhsd->bhd', pk)
        num = torch.einsum('bhqd,bhde->bhqe', pq, kv)
        den = torch.einsum('bhqd,bhd->bhq', pq, z)[..., None] + 1e-06
        o = num / den
        return (lambda x, *d: x.permute(*d))(o, 0, 2, 1, 3).reshape(B, S, D) @ wo

    def _B_ref(x, w_in, w_sp, b_sp, w_out):
        B, S, D = x.shape
        F = w_in.shape[-1]
        Fh = F // 2
        z = _gelu(torch.einsum('bsd,df->bsf', x, w_in))
        z1 = z[..., :Fh].clone()
        z2 = _layernorm(z[..., Fh:], axis=-1)
        g = torch.einsum('ts,bsf->btf', w_sp, z2) + b_sp[None, :, None]
        return torch.einsum('bsf,fd->bsd', z1 * g, w_out)
    x = A_x
    xn = _layernorm(x, axis=-1)
    return x + _A_ref(xn, A_wqkv, A_wo) + _B_ref(xn, B_w_in, B_w_sp, B_b_sp, B_w_out)
```

```asm
; @launch grid=(256,1,1) block=(512,1,1) lds=163840
.amdgcn_target "amdgcn-amd-amdhsa--gfx950"
.text
.globl parallel_sum__linear_attn_block__mixer_gmlp__prompt_kernel
.p2align 8
.type parallel_sum__linear_attn_block__mixer_gmlp__prompt_kernel,@function
parallel_sum__linear_attn_block__mixer_gmlp__prompt_kernel:
s_cmp_ge_u32 s2, 256
s_cbranch_scc1 K_EXIT
s_load_dwordx16 s[64:79], s[0:1], 0
s_load_dwordx4 s[56:59], s[0:1], 72
s_load_dwordx2 s[60:61], s[0:1], 64
s_getpc_b64 s[4:5]
s_lshr_b32 s6, s2, 3
s_lshl_b32 s6, s6, 5
v_lshrrev_b32 v2, 4, v0
v_add_lshl_u32 v2, v2, s6, 7
s_and_b32 s4, s4, 0xffffff00
v_min_u32 v2, K_EXIT-parallel_sum__linear_attn_block__mixer_gmlp__prompt_kernel, v2
global_load_dword v113, v2, s[4:5]
v_and_b32 v1, 63, v0
v_lshrrev_b32 v15, 6, v0
s_lshr_b32 s29, s2, 5
v_readfirstlane_b32 s30, v15
s_lshl_b32 s29, s29, 1
s_and_b32 s33, s2, 1
s_add_u32 s29, s29, s33
s_and_b32 s33, s2, 4
s_bfe_u32 s34, s2, 0x20003
s_add_u32 s28, s33, s34
s_lshl_b32 s28, s28, 1
s_bfe_u32 s33, s2, 0x10001
s_add_u32 s28, s28, s33
s_and_b32 s31, s30, 3
s_lshr_b32 s32, s30, 2
s_lshl_b32 s33, s28, 3
s_add_u32 s33, s33, s30
s_mul_i32 s38, s33, 14336
s_mul_i32 s34, s30, 21504
v_lshrrev_b32 v248, 3, v1
v_and_b32 v249, 7, v1
v_lshrrev_b32 v250, 4, v1
v_xor_b32 v250, v250, v249
v_mul_u32_u24 v2, 896, v248
v_xor_b32 v251, 4, v250
v_lshl_add_u32 v3, v251, 4, v2
v_lshl_add_u32 v2, v250, 4, v2
v_lshlrev_b32 v250, 1, v248
v_and_b32 v250, 4, v250
v_xor_b32 v250, v250, v249
v_lshlrev_b32 v250, 4, v250
v_mul_u32_u24 v5, 2688, v248
v_add_u32 v5, v5, v250
s_cmp_ge_u32 s29, 14
s_cbranch_scc1 P1_KC
s_cmp_ge_u32 s29, 7
s_cbranch_scc1 P1_KB
P1_KA:
s_mul_i32 s44, s30, 3072
v_add_u32 v3, 5120, v3
s_mul_i32 s35, s30, 28672
s_lshl_b32 s36, s29, 7
s_add_u32 s41, s35, s36
s_add_u32 s39, s41, 768
s_add_u32 s40, s34, s36
s_mov_b32 s43, 229376
v_mul_u32_u24 v4, 3584, v248
v_add_u32 v4, v4, v250
s_waitcnt lgkmcnt(0)
s_mov_b32 s16, s72
s_and_b32 s17, s73, 0xffff
s_mov_b32 s18, 1605632
s_mov_b32 s19, 0x20000
s_mov_b32 s12, s64
s_and_b32 s13, s65, 0xffff
s_mov_b32 s14, 1835008
s_mov_b32 s15, 0x20000
s_add_u32 m0, s44, 57344
s_add_u32 s33, s38, 0
buffer_load_dwordx4 v2, s[12:15], s33 offen lds
buffer_load_dwordx4 v3, s[12:15], s33 offen offset:2048 lds
buffer_load_dwordx4 v4, s[16:19], s39 offen offset:1024 lds
s_add_u32 s39, s39, s43
s_barrier
s_add_u32 m0, s44, 81920
s_add_u32 s33, s38, 128
buffer_load_dwordx4 v2, s[12:15], s33 offen lds
buffer_load_dwordx4 v3, s[12:15], s33 offen offset:2048 lds
buffer_load_dwordx4 v4, s[16:19], s39 offen offset:1024 lds
s_add_u32 s39, s39, s43
s_add_u32 m0, s44, 106496
s_add_u32 s33, s38, 256
buffer_load_dwordx4 v2, s[12:15], s33 offen lds
buffer_load_dwordx4 v3, s[12:15], s33 offen offset:2048 lds
buffer_load_dwordx4 v4, s[16:19], s39 offen offset:1024 lds
s_add_u32 s39, s39, s43
s_mov_b32 s20, s66
s_and_b32 s21, s67, 0xffff
s_mov_b32 s22, 1204224
s_mov_b32 s23, 0x20000
s_mov_b32 s24, s58
s_and_b32 s25, s59, 0xffff
s_mov_b32 s26, 50331648
s_mov_b32 s27, 0x20000
s_mov_b32 s4, s56
s_and_b32 s5, s57, 0xffff
s_mov_b32 s6, 256
s_mov_b32 s7, 0x20000
s_lshl_b32 s33, s32, 1
s_xor_b32 s46, s33, s31
v_and_b32 v248, 31, v1
v_lshrrev_b32 v249, 5, v1
v_bfe_u32 v250, v1, 1, 3
v_xor_b32 v250, v250, v249
s_lshl_b32 s34, s46, 1
v_xor_b32 v250, s34, v250
v_lshlrev_b32 v250, 4, v250
v_and_b32 v251, 7, v1
v_lshl_add_u32 v250, v251, 7, v250
v_bfe_u32 v251, v1, 3, 1
v_mul_u32_u24 v6, 2048, v251
v_bfe_u32 v251, v1, 4, 1
v_mul_u32_u24 v251, 3072, v251
s_mul_i32 s34, s31, 6144
s_add_u32 s34, s34, 57344
v_add3_u32 v251, v251, v6, s34
v_xor_b32 v6, 0, v250
v_add_u32 v6, v251, v6
v_xor_b32 v7, 32, v250
v_add_u32 v7, v251, v7
v_xor_b32 v8, 64, v250
v_add_u32 v8, v251, v8
v_xor_b32 v9, 96, v250
v_add_u32 v9, v251, v9
v_lshlrev_b32 v252, 5, v248
v_lshl_add_u32 v252, v249, 4, v252
s_lshl_b32 s34, s32, 6
v_and_b32 v248, 3, v1
v_lshlrev_b32 v248, 3, v248
v_and_b32 v250, 16, v1
v_lshl_add_u32 v248, v250, 1, v248
v_and_b32 v250, 8, v1
v_lshlrev_b32 v250, 3, v250
v_xor_b32 v250, s34, v250
v_or_b32 v248, v248, v250
v_bfe_u32 v250, v1, 2, 2
v_lshl_add_u32 v248, v250, 7, v248
v_lshl_add_u32 v15, v249, 10, v248
v_mul_u32_u24 v249, 3072, v249
v_add_u32 v248, v248, v249
s_xor_b32 s35, s46, 0
s_mul_i32 s35, s35, 6144
s_add_u32 s35, s35, 58368
v_add_u32 v10, s35, v248
s_xor_b32 s35, s46, 1
s_mul_i32 s35, s35, 6144
s_add_u32 s35, s35, 58368
v_add_u32 v11, s35, v248
s_xor_b32 s35, s46, 2
s_mul_i32 s35, s35, 6144
s_add_u32 s35, s35, 58368
v_add_u32 v12, s35, v248
s_xor_b32 s35, s46, 3
s_mul_i32 s35, s35, 6144
s_add_u32 s35, s35, 58368
v_add_u32 v13, s35, v248
v_lshlrev_b32 v14, 4, v1
v_lshlrev_b32 v253, 3, v1
s_lshl_b32 s33, s32, 10
s_lshl_b32 s34, s31, 2
s_add_u32 s33, s33, s34
s_add_u32 s33, s33, 114688
v_add_u32 v254, s33, v14
v_mov_b32 v224, 0
v_mov_b32 v225, 0
v_mov_b32 v226, 0
v_mov_b32 v227, 0
s_mov_b32 s54, 0xf0f00f0f
s_mov_b32 s55, 0xf0f00f0f
v_mov_b32 v248, 0x3f803f80
v_cndmask_b32 v232, 0, v248, s[54:55]
v_cndmask_b32 v233, 0, v248, s[54:55]
v_cndmask_b32 v234, 0, v248, s[54:55]
v_cndmask_b32 v235, 0, v248, s[54:55]
s_mov_b32 s54, 0
s_mov_b32 s55, -1
v_mov_b32 v237, 0
v_mov_b32 v238, 0
v_mov_b32 v239, 0
v_mov_b32 v255, 1
s_lshl_b32 s45, s30, 10
s_mov_b32 s53, 0x8000
s_lshl_b32 s33, s28, 2
s_add_u32 s33, s33, s31
s_mul_i32 s35, s33, 28672
s_lshr_b32 s34, s2, 5
s_add_u32 s36, s34, 14
s_lshl_b32 s34, s34, 1
s_bfe_u32 s37, s2, 0x10003
s_add_u32 s34, s34, s37
s_and_b32 s37, s2, 0xd8
s_cmp_eq_u32 s37, 0x8
s_cselect_b32 s37, s36, 0x20000
s_bitcmp1_b32 s2, 4
s_cselect_b32 s37, s34, s37
s_lshl_b32 s37, s37, 3
s_add_u32 s37, s37, s30
s_min_u32 s34, s37, 0x8000
s_and_b32 s36, s34, 0xffe0
s_add_u32 s34, s34, s36
s_lshl_b32 s34, s34, 14
v_lshrrev_b32 v248, 4, v1
v_bfe_u32 v0, v1, 2, 2
v_lshlrev_b32 v0, 7, v0
v_lshl_add_u32 v0, v248, 12, v0
v_add_u32 v0, s34, v0
s_and_b32 s34, s2, 7
s_lshl_b32 s34, s34, 7
s_add_u32 s37, s37, s34
s_and_b32 s34, s2, 4
s_lshl_b32 s8, s34, 20
s_and_b32 s34, s2, 2
s_lshl_b32 s34, s34, 18
s_add_u32 s8, s8, s34
s_and_b32 s34, s2, 1
s_lshl_b32 s34, s34, 11
s_add_u32 s8, s8, s34
v_mov_b32 v230, 0x3fb8aa3b
s_lshl_b32 s36, s29, 1
s_add_u32 s36, s36, s32
s_lshl_b32 s47, s36, 17
s_lshl_b32 s34, s33, 11
s_add_u32 s47, s47, s34
s_lshl_b32 s34, s36, 10
s_add_u32 s34, s34, s35
s_mul_i32 s49, s33, 72
s_add_u32 s49, s49, s36
s_lshl_b32 s49, s49, 11
s_add_u32 s49, s49, 16867328
s_lshl_b32 s34, s36, 11
s_add_u32 s34, s34, s35
s_add_u32 s48, s34, 8388608
s_lshl_b32 s33, s33, 4
s_add_u32 s33, s33, s29
s_lshl_b32 s33, s33, 8
s_add_u32 s10, s33, 14680064
s_and_b32 s33, s29, 14
s_lshr_b32 s34, s28, 3
s_add_u32 s33, s33, s34
s_lshl_b32 s33, s33, 6
s_and_b32 s34, s28, 7
s_add_u32 s33, s33, s34
s_lshl_b32 s33, s33, 1
s_and_b32 s34, s29, 1
s_add_u32 s33, s33, s34
s_lshl_b32 s33, s33, 2
s_add_u32 s9, s33, 15781888
s_lshl_b32 s11, s28, 9
s_add_u32 s11, s11, s29
s_lshl_b32 s11, s11, 2
s_add_u32 s11, s11, 15728640
s_waitcnt vmcnt(6)
s_barrier
ds_read_b128 v[16:19], v6 offset:0
ds_read_b64_tr_b16 v[160:161], v10 offset:0
ds_read_b64_tr_b16 v[162:163], v10 offset:512
ds_read_b128 v[20:23], v7 offset:0
ds_read_b64_tr_b16 v[164:165], v11 offset:0
ds_read_b64_tr_b16 v[166:167], v11 offset:512
ds_read_b128 v[24:27], v8 offset:0
ds_read_b64_tr_b16 v[168:169], v12 offset:0
ds_read_b64_tr_b16 v[170:171], v12 offset:512
ds_read_b128 v[28:31], v9 offset:0
ds_read_b64_tr_b16 v[172:173], v13 offset:0
ds_read_b64_tr_b16 v[174:175], v13 offset:512
s_add_u32 m0, s44, 131072
s_add_u32 s33, s38, 384
buffer_load_dwordx4 v2, s[12:15], s33 offen lds
buffer_load_dwordx4 v3, s[12:15], s33 offen offset:2048 lds
buffer_load_dwordx4 v4, s[16:19], s39 offen offset:1024 lds
s_add_u32 s39, s39, s43
s_waitcnt lgkmcnt(0)
s_waitcnt vmcnt(6)
s_barrier
v_mfma_f32_32x32x16_bf16 v[128:143], v[160:163], v[16:19], 0
ds_read_b128 v[32:35], v6 offset:24576
ds_read_b64_tr_b16 v[176:177], v10 offset:24576
ds_read_b64_tr_b16 v[178:179], v10 offset:25088
v_lshlrev_b32 v248, 16, v16
v_and_b32 v249, 0xffff0000, v16
v_fmac_f32 v225, v248, v248
v_fmac_f32 v227, v249, v249
v_lshlrev_b32 v250, 16, v17
v_and_b32 v251, 0xffff0000, v17
v_fmac_f32 v225, v250, v250
v_fmac_f32 v227, v251, v251
v_mfma_f32_32x32x16_bf16 v[128:143], v[164:167], v[20:23], v[128:143]
ds_read_b128 v[36:39], v7 offset:24576
ds_read_b64_tr_b16 v[180:181], v11 offset:24576
ds_read_b64_tr_b16 v[182:183], v11 offset:25088
s_add_u32 m0, s44, 57344
s_add_u32 s33, s38, 512
buffer_load_dwordx4 v2, s[12:15], s33 offen lds
v_lshlrev_b32 v248, 16, v18
v_and_b32 v249, 0xffff0000, v18
v_fmac_f32 v225, v248, v248
v_fmac_f32 v227, v249, v249
v_lshlrev_b32 v250, 16, v19
v_and_b32 v251, 0xffff0000, v19
v_fmac_f32 v225, v250, v250
v_fmac_f32 v227, v251, v251
v_mfma_f32_16x16x32_bf16 v[240:243], v[232:235], v[160:163], 0
v_mfma_f32_32x32x16_bf16 v[128:143], v[168:171], v[24:27], v[128:143]
ds_read_b128 v[40:43], v8 offset:24576
ds_read_b64_tr_b16 v[184:185], v12 offset:24576
ds_read_b64_tr_b16 v[186:187], v12 offset:25088
buffer_load_dwordx4 v3, s[12:15], s33 offen offset:2048 lds
v_lshlrev_b32 v248, 16, v20
v_and_b32 v249, 0xffff0000, v20
v_fmac_f32 v225, v248, v248
v_fmac_f32 v227, v249, v249
v_lshlrev_b32 v250, 16, v21
v_and_b32 v251, 0xffff0000, v21
v_fmac_f32 v225, v250, v250
v_fmac_f32 v227, v251, v251
v_mfma_f32_16x16x32_bf16 v[244:247], v[232:235], v[16:19], 0
v_mfma_f32_32x32x16_bf16 v[128:143], v[172:175], v[28:31], v[128:143]
ds_read_b128 v[44:47], v9 offset:24576
ds_read_b64_tr_b16 v[188:189], v13 offset:24576
ds_read_b64_tr_b16 v[190:191], v13 offset:25088
buffer_load_dwordx4 v4, s[16:19], s39 offen offset:1024 lds
s_add_u32 s39, s39, s43
v_lshlrev_b32 v248, 16, v22
v_and_b32 v249, 0xffff0000, v22
v_fmac_f32 v225, v248, v248
v_fmac_f32 v227, v249, v249
v_lshlrev_b32 v250, 16, v23
v_and_b32 v251, 0xffff0000, v23
v_fmac_f32 v225, v250, v250
v_fmac_f32 v227, v251, v251
v_mfma_f32_16x16x32_bf16 v[244:247], v[232:235], v[20:23], v[244:247]
s_waitcnt lgkmcnt(0)
s_waitcnt vmcnt(6)
s_barrier
v_add_u32 v6, 49152, v6
v_add_u32 v7, 49152, v7
v_add_u32 v8, 49152, v8
v_add_u32 v9, 49152, v9
v_add_u32 v10, 49152, v10
v_add_u32 v11, 49152, v11
v_add_u32 v12, 49152, v12
v_add_u32 v13, 49152, v13
v_mfma_f32_32x32x16_bf16 v[128:143], v[176:179], v[32:35], v[128:143]
ds_read_b128 v[48:51], v6 offset:0
ds_read_b64_tr_b16 v[160:161], v10 offset:0
ds_read_b64_tr_b16 v[162:163], v10 offset:512
v_lshlrev_b32 v248, 16, v32
v_and_b32 v249, 0xffff0000, v32
v_fmac_f32 v225, v248, v248
v_fmac_f32 v227, v249, v249
v_lshlrev_b32 v250, 16, v33
v_and_b32 v251, 0xffff0000, v33
v_fmac_f32 v225, v250, v250
v_fmac_f32 v227, v251, v251
v_mfma_f32_32x32x16_bf16 v[128:143], v[180:183], v[36:39], v[128:143]
ds_read_b128 v[52:55], v7 offset:0
ds_read_b64_tr_b16 v[164:165], v11 offset:0
ds_read_b64_tr_b16 v[166:167], v11 offset:512
s_add_u32 m0, s44, 81920
s_add_u32 s33, s38, 640
buffer_load_dwordx4 v2, s[12:15], s33 offen lds
v_lshlrev_b32 v248, 16, v34
v_and_b32 v249, 0xffff0000, v34
v_fmac_f32 v225, v248, v248
v_fmac_f32 v227, v249, v249
v_lshlrev_b32 v250, 16, v35
v_and_b32 v251, 0xffff0000, v35
v_fmac_f32 v225, v250, v250
v_fmac_f32 v227, v251, v251
v_mfma_f32_16x16x32_bf16 v[240:243], v[232:235], v[176:179], v[240:243]
v_mfma_f32_32x32x16_bf16 v[128:143], v[184:187], v[40:43], v[128:143]
ds_read_b128 v[56:59], v8 offset:0
ds_read_b64_tr_b16 v[168:169], v12 offset:0
ds_read_b64_tr_b16 v[170:171], v12 offset:512
buffer_load_dwordx4 v3, s[12:15], s33 offen offset:2048 lds
v_lshlrev_b32 v248, 16, v36
v_and_b32 v249, 0xffff0000, v36
v_fmac_f32 v225, v248, v248
v_fmac_f32 v227, v249, v249
v_lshlrev_b32 v250, 16, v37
v_and_b32 v251, 0xffff0000, v37
v_fmac_f32 v225, v250, v250
v_fmac_f32 v227, v251, v251
v_mfma_f32_16x16x32_bf16 v[244:247], v[232:235], v[32:35], v[244:247]
v_mfma_f32_32x32x16_bf16 v[128:143], v[188:191], v[44:47], v[128:143]
ds_read_b128 v[60:63], v9 offset:0
ds_read_b64_tr_b16 v[172:173], v13 offset:0
ds_read_b64_tr_b16 v[174:175], v13 offset:512
buffer_load_dwordx4 v4, s[16:19], s39 offen offset:1024 lds
s_add_u32 s39, s39, s43
v_lshlrev_b32 v248, 16, v38
v_and_b32 v249, 0xffff0000, v38
v_fmac_f32 v225, v248, v248
v_fmac_f32 v227, v249, v249
v_lshlrev_b32 v250, 16, v39
v_and_b32 v251, 0xffff0000, v39
v_fmac_f32 v225, v250, v250
v_fmac_f32 v227, v251, v251
v_mfma_f32_16x16x32_bf16 v[244:247], v[232:235], v[36:39], v[244:247]
s_waitcnt lgkmcnt(0)
s_waitcnt vmcnt(6)
s_barrier
v_mfma_f32_32x32x16_bf16 v[128:143], v[160:163], v[48:51], v[128:143]
ds_read_b128 v[64:67], v6 offset:24576
ds_read_b64_tr_b16 v[176:177], v10 offset:24576
ds_read_b64_tr_b16 v[178:179], v10 offset:25088
v_lshlrev_b32 v248, 16, v48
v_and_b32 v249, 0xffff0000, v48
v_fmac_f32 v225, v248, v248
v_fmac_f32 v227, v249, v249
v_lshlrev_b32 v250, 16, v49
v_and_b32 v251, 0xffff0000, v49
v_fmac_f32 v225, v250, v250
v_fmac_f32 v227, v251, v251
v_mfma_f32_32x32x16_bf16 v[128:143], v[164:167], v[52:55], v[128:143]
ds_read_b128 v[68:71], v7 offset:24576
ds_read_b64_tr_b16 v[180:181], v11 offset:24576
ds_read_b64_tr_b16 v[182:183], v11 offset:25088
s_add_u32 m0, s44, 106496
s_add_u32 s33, s38, 768
buffer_load_dwordx4 v2, s[12:15], s33 offen lds
v_lshlrev_b32 v248, 16, v50
v_and_b32 v249, 0xffff0000, v50
v_fmac_f32 v225, v248, v248
v_fmac_f32 v227, v249, v249
v_lshlrev_b32 v250, 16, v51
v_and_b32 v251, 0xffff0000, v51
v_fmac_f32 v225, v250, v250
v_fmac_f32 v227, v251, v251
v_mfma_f32_16x16x32_bf16 v[240:243], v[232:235], v[160:163], v[240:243]
v_mfma_f32_32x32x16_bf16 v[128:143], v[168:171], v[56:59], v[128:143]
ds_read_b128 v[72:75], v8 offset:24576
ds_read_b64_tr_b16 v[184:185], v12 offset:24576
ds_read_b64_tr_b16 v[186:187], v12 offset:25088
buffer_load_dwordx4 v3, s[12:15], s33 offen offset:2048 lds
v_lshlrev_b32 v248, 16, v52
v_and_b32 v249, 0xffff0000, v52
v_fmac_f32 v225, v248, v248
v_fmac_f32 v227, v249, v249
v_lshlrev_b32 v250, 16, v53
v_and_b32 v251, 0xffff0000, v53
v_fmac_f32 v225, v250, v250
v_fmac_f32 v227, v251, v251
v_mfma_f32_16x16x32_bf16 v[244:247], v[232:235], v[48:51], v[244:247]
v_mfma_f32_32x32x16_bf16 v[128:143], v[172:175], v[60:63], v[128:143]
ds_read_b128 v[76:79], v9 offset:24576
ds_read_b64_tr_b16 v[188:189], v13 offset:24576
ds_read_b64_tr_b16 v[190:191], v13 offset:25088
buffer_load_dwordx4 v4, s[16:19], s39 offen offset:1024 lds
s_add_u32 s39, s39, s43
v_lshlrev_b32 v248, 16, v54
v_and_b32 v249, 0xffff0000, v54
v_fmac_f32 v225, v248, v248
v_fmac_f32 v227, v249, v249
v_lshlrev_b32 v250, 16, v55
v_and_b32 v251, 0xffff0000, v55
v_fmac_f32 v225, v250, v250
v_fmac_f32 v227, v251, v251
v_mfma_f32_16x16x32_bf16 v[244:247], v[232:235], v[52:55], v[244:247]
s_waitcnt lgkmcnt(0)
s_waitcnt vmcnt(6)
s_barrier
v_subrev_u32 v6, 49152, v6
v_subrev_u32 v7, 49152, v7
v_subrev_u32 v8, 49152, v8
v_subrev_u32 v9, 49152, v9
v_subrev_u32 v10, 49152, v10
v_subrev_u32 v11, 49152, v11
v_subrev_u32 v12, 49152, v12
v_subrev_u32 v13, 49152, v13
v_mfma_f32_32x32x16_bf16 v[128:143], v[176:179], v[64:67], v[128:143]
ds_read_b128 v[80:83], v6 offset:0
ds_read_b64_tr_b16 v[160:161], v10 offset:0
ds_read_b64_tr_b16 v[162:163], v10 offset:512
v_lshlrev_b32 v248, 16, v64
v_and_b32 v249, 0xffff0000, v64
v_fmac_f32 v225, v248, v248
v_fmac_f32 v227, v249, v249
v_lshlrev_b32 v250, 16, v65
v_and_b32 v251, 0xffff0000, v65
v_fmac_f32 v225, v250, v250
v_fmac_f32 v227, v251, v251
v_mfma_f32_32x32x16_bf16 v[128:143], v[180:183], v[68:71], v[128:143]
ds_read_b128 v[84:87], v7 offset:0
ds_read_b64_tr_b16 v[164:165], v11 offset:0
ds_read_b64_tr_b16 v[166:167], v11 offset:512
s_add_u32 m0, s45, 0
s_nop 0
buffer_load_dwordx4 v5, s[20:23], s40 offen lds
s_add_u32 s40, s40, 172032
v_lshlrev_b32 v248, 16, v66
v_and_b32 v249, 0xffff0000, v66
v_fmac_f32 v225, v248, v248
v_fmac_f32 v227, v249, v249
v_lshlrev_b32 v250, 16, v67
v_and_b32 v251, 0xffff0000, v67
v_fmac_f32 v225, v250, v250
v_fmac_f32 v227, v251, v251
v_mfma_f32_16x16x32_bf16 v[240:243], v[232:235], v[176:179], v[240:243]
v_mfma_f32_32x32x16_bf16 v[128:143], v[184:187], v[72:75], v[128:143]
ds_read_b128 v[88:91], v8 offset:0
ds_read_b64_tr_b16 v[168:169], v12 offset:0
ds_read_b64_tr_b16 v[170:171], v12 offset:512
s_add_u32 m0, s45, 8192
s_nop 0
buffer_load_dwordx4 v5, s[20:23], s40 offen lds
s_add_u32 s40, s40, 172032
v_lshlrev_b32 v248, 16, v68
v_and_b32 v249, 0xffff0000, v68
v_fmac_f32 v225, v248, v248
v_fmac_f32 v227, v249, v249
v_lshlrev_b32 v250, 16, v69
v_and_b32 v251, 0xffff0000, v69
v_fmac_f32 v225, v250, v250
v_fmac_f32 v227, v251, v251
v_mfma_f32_16x16x32_bf16 v[244:247], v[232:235], v[64:67], v[244:247]
v_mfma_f32_32x32x16_bf16 v[128:143], v[188:191], v[76:79], v[128:143]
ds_read_b128 v[92:95], v9 offset:0
ds_read_b64_tr_b16 v[172:173], v13 offset:0
ds_read_b64_tr_b16 v[174:175], v13 offset:512
s_add_u32 m0, s45, 16384
s_nop 0
buffer_load_dwordx4 v5, s[20:23], s40 offen lds
s_add_u32 s40, s40, 172032
v_lshlrev_b32 v248, 16, v70
v_and_b32 v249, 0xffff0000, v70
v_fmac_f32 v225, v248, v248
v_fmac_f32 v227, v249, v249
v_lshlrev_b32 v250, 16, v71
v_and_b32 v251, 0xffff0000, v71
v_fmac_f32 v225, v250, v250
v_fmac_f32 v227, v251, v251
v_mfma_f32_16x16x32_bf16 v[244:247], v[232:235], v[68:71], v[244:247]
s_waitcnt lgkmcnt(0)
s_waitcnt vmcnt(6)
s_barrier
v_mfma_f32_32x32x16_bf16 v[128:143], v[160:163], v[80:83], v[128:143]
ds_read_b128 v[96:99], v6 offset:24576
ds_read_b64_tr_b16 v[176:177], v10 offset:24576
ds_read_b64_tr_b16 v[178:179], v10 offset:25088
v_lshlrev_b32 v248, 16, v80
v_and_b32 v249, 0xffff0000, v80
v_fmac_f32 v225, v248, v248
v_fmac_f32 v227, v249, v249
v_lshlrev_b32 v250, 16, v81
v_and_b32 v251, 0xffff0000, v81
v_fmac_f32 v225, v250, v250
v_fmac_f32 v227, v251, v251
v_mfma_f32_32x32x16_bf16 v[128:143], v[164:167], v[84:87], v[128:143]
ds_read_b128 v[100:103], v7 offset:24576
ds_read_b64_tr_b16 v[180:181], v11 offset:24576
ds_read_b64_tr_b16 v[182:183], v11 offset:25088
s_add_u32 m0, s45, 24576
s_nop 0
buffer_load_dwordx4 v5, s[20:23], s40 offen lds
s_add_u32 s40, s40, 172032
v_lshlrev_b32 v248, 16, v82
v_and_b32 v249, 0xffff0000, v82
v_fmac_f32 v225, v248, v248
v_fmac_f32 v227, v249, v249
v_lshlrev_b32 v250, 16, v83
v_and_b32 v251, 0xffff0000, v83
v_fmac_f32 v225, v250, v250
v_fmac_f32 v227, v251, v251
v_mfma_f32_16x16x32_bf16 v[240:243], v[232:235], v[160:163], v[240:243]
v_mfma_f32_32x32x16_bf16 v[128:143], v[168:171], v[88:91], v[128:143]
ds_read_b128 v[104:107], v8 offset:24576
ds_read_b64_tr_b16 v[184:185], v12 offset:24576
ds_read_b64_tr_b16 v[186:187], v12 offset:25088
v_lshlrev_b32 v248, 16, v84
v_and_b32 v249, 0xffff0000, v84
v_fmac_f32 v225, v248, v248
v_fmac_f32 v227, v249, v249
v_lshlrev_b32 v250, 16, v85
v_and_b32 v251, 0xffff0000, v85
v_fmac_f32 v225, v250, v250
v_fmac_f32 v227, v251, v251
v_mfma_f32_16x16x32_bf16 v[244:247], v[232:235], v[80:83], v[244:247]
v_mfma_f32_32x32x16_bf16 v[128:143], v[172:175], v[92:95], v[128:143]
ds_read_b128 v[108:111], v9 offset:24576
ds_read_b64_tr_b16 v[188:189], v13 offset:24576
ds_read_b64_tr_b16 v[190:191], v13 offset:25088
s_add_u32 m0, s45, 32768
s_nop 0
buffer_load_dwordx4 v5, s[20:23], s40 offen lds
s_add_u32 s40, s40, 172032
v_lshlrev_b32 v248, 16, v86
v_and_b32 v249, 0xffff0000, v86
v_fmac_f32 v225, v248, v248
v_fmac_f32 v227, v249, v249
v_lshlrev_b32 v250, 16, v87
v_and_b32 v251, 0xffff0000, v87
v_fmac_f32 v225, v250, v250
v_fmac_f32 v227, v251, v251
v_mfma_f32_16x16x32_bf16 v[244:247], v[232:235], v[84:87], v[244:247]
s_waitcnt lgkmcnt(0)
s_waitcnt vmcnt(5)
s_barrier
v_add_u32 v6, 49152, v6
v_add_u32 v7, 49152, v7
v_add_u32 v8, 49152, v8
v_add_u32 v9, 49152, v9
v_add_u32 v10, 49152, v10
v_add_u32 v11, 49152, v11
v_add_u32 v12, 49152, v12
v_add_u32 v13, 49152, v13
v_mfma_f32_32x32x16_bf16 v[128:143], v[176:179], v[96:99], v[128:143]
ds_read_b128 v[112:115], v6 offset:0
ds_read_b64_tr_b16 v[160:161], v10 offset:0
ds_read_b64_tr_b16 v[162:163], v10 offset:512
v_lshlrev_b32 v248, 16, v96
v_and_b32 v249, 0xffff0000, v96
v_fmac_f32 v225, v248, v248
v_fmac_f32 v227, v249, v249
v_lshlrev_b32 v250, 16, v97
v_and_b32 v251, 0xffff0000, v97
v_fmac_f32 v225, v250, v250
v_fmac_f32 v227, v251, v251
v_mfma_f32_32x32x16_bf16 v[128:143], v[180:183], v[100:103], v[128:143]
ds_read_b128 v[116:119], v7 offset:0
ds_read_b64_tr_b16 v[164:165], v11 offset:0
ds_read_b64_tr_b16 v[166:167], v11 offset:512
s_add_u32 m0, s45, 40960
s_nop 0
buffer_load_dwordx4 v5, s[20:23], s40 offen lds
s_add_u32 s40, s40, 172032
v_lshlrev_b32 v248, 16, v98
v_and_b32 v249, 0xffff0000, v98
v_fmac_f32 v225, v248, v248
v_fmac_f32 v227, v249, v249
v_lshlrev_b32 v250, 16, v99
v_and_b32 v251, 0xffff0000, v99
v_fmac_f32 v225, v250, v250
v_fmac_f32 v227, v251, v251
v_mfma_f32_16x16x32_bf16 v[240:243], v[232:235], v[176:179], v[240:243]
v_mfma_f32_32x32x16_bf16 v[128:143], v[184:187], v[104:107], v[128:143]
ds_read_b128 v[120:123], v8 offset:0
ds_read_b64_tr_b16 v[168:169], v12 offset:0
ds_read_b64_tr_b16 v[170:171], v12 offset:512
v_lshlrev_b32 v248, 16, v100
v_and_b32 v249, 0xffff0000, v100
v_fmac_f32 v225, v248, v248
v_fmac_f32 v227, v249, v249
v_lshlrev_b32 v250, 16, v101
v_and_b32 v251, 0xffff0000, v101
v_fmac_f32 v225, v250, v250
v_fmac_f32 v227, v251, v251
v_mfma_f32_16x16x32_bf16 v[244:247], v[232:235], v[96:99], v[244:247]
v_mfma_f32_32x32x16_bf16 v[128:143], v[188:191], v[108:111], v[128:143]
ds_read_b128 v[124:127], v9 offset:0
ds_read_b64_tr_b16 v[172:173], v13 offset:0
ds_read_b64_tr_b16 v[174:175], v13 offset:512
s_add_u32 m0, s45, 49152
s_nop 0
buffer_load_dwordx4 v5, s[20:23], s40 offen lds
s_add_u32 s40, s40, 172032
v_lshlrev_b32 v248, 16, v102
v_and_b32 v249, 0xffff0000, v102
v_fmac_f32 v225, v248, v248
v_fmac_f32 v227, v249, v249
v_lshlrev_b32 v250, 16, v103
v_and_b32 v251, 0xffff0000, v103
v_fmac_f32 v225, v250, v250
v_fmac_f32 v227, v251, v251
v_mfma_f32_16x16x32_bf16 v[244:247], v[232:235], v[100:103], v[244:247]
s_waitcnt lgkmcnt(0)
s_waitcnt vmcnt(4)
s_barrier
v_mfma_f32_32x32x16_bf16 v[128:143], v[160:163], v[112:115], v[128:143]
s_xor_b32 s35, s46, 0
s_lshl_b32 s35, s35, 11
v_add_u32 v10, s35, v15
s_xor_b32 s35, s46, 1
s_lshl_b32 s35, s35, 11
v_add_u32 v11, s35, v15
s_xor_b32 s35, s46, 2
s_lshl_b32 s35, s35, 11
v_add_u32 v12, s35, v15
s_xor_b32 s35, s46, 3
s_lshl_b32 s35, s35, 11
v_add_u32 v13, s35, v15
ds_read_b64_tr_b16 v[176:177], v10 offset:0
v_lshlrev_b32 v248, 16, v112
v_and_b32 v249, 0xffff0000, v112
v_fmac_f32 v225, v248, v248
v_fmac_f32 v227, v249, v249
v_lshlrev_b32 v250, 16, v113
v_and_b32 v251, 0xffff0000, v113
v_fmac_f32 v225, v250, v250
v_fmac_f32 v227, v251, v251
v_mfma_f32_32x32x16_bf16 v[128:143], v[164:167], v[116:119], v[128:143]
ds_read_b64_tr_b16 v[178:179], v10 offset:512
ds_read_b64_tr_b16 v[180:181], v11 offset:0
v_lshlrev_b32 v248, 16, v114
v_and_b32 v249, 0xffff0000, v114
v_fmac_f32 v225, v248, v248
v_fmac_f32 v227, v249, v249
v_lshlrev_b32 v250, 16, v115
v_and_b32 v251, 0xffff0000, v115
v_fmac_f32 v225, v250, v250
v_fmac_f32 v227, v251, v251
v_mfma_f32_16x16x32_bf16 v[240:243], v[232:235], v[160:163], v[240:243]
v_mfma_f32_32x32x16_bf16 v[128:143], v[168:171], v[120:123], v[128:143]
ds_read_b64_tr_b16 v[182:183], v11 offset:512
ds_read_b64_tr_b16 v[184:185], v12 offset:0
v_lshlrev_b32 v248, 16, v116
v_and_b32 v249, 0xffff0000, v116
v_fmac_f32 v225, v248, v248
v_fmac_f32 v227, v249, v249
v_lshlrev_b32 v250, 16, v117
v_and_b32 v251, 0xffff0000, v117
v_fmac_f32 v225, v250, v250
v_fmac_f32 v227, v251, v251
v_mfma_f32_16x16x32_bf16 v[244:247], v[232:235], v[112:115], v[244:247]
v_mfma_f32_32x32x16_bf16 v[128:143], v[172:175], v[124:127], v[128:143]
ds_read_b64_tr_b16 v[186:187], v12 offset:512
ds_read_b64_tr_b16 v[188:189], v13 offset:0
ds_read_b64_tr_b16 v[190:191], v13 offset:512
v_lshlrev_b32 v248, 16, v118
v_and_b32 v249, 0xffff0000, v118
v_fmac_f32 v225, v248, v248
v_fmac_f32 v227, v249, v249
v_lshlrev_b32 v250, 16, v119
v_and_b32 v251, 0xffff0000, v119
v_fmac_f32 v225, v250, v250
v_fmac_f32 v227, v251, v251
v_mfma_f32_16x16x32_bf16 v[244:247], v[232:235], v[116:119], v[244:247]
s_and_b32 s33, s28, 7
s_cmp_ge_u32 s33, 2
s_cbranch_scc1 P1_AL
s_mov_b32 s12, s74
s_and_b32 s13, s75, 0xffff
s_mov_b32 s14, 8388608
s_mov_b32 s15, 0x20000
s_waitcnt lgkmcnt(6)
v_mfma_f32_32x32x16_bf16 v[144:159], v[176:179], v[16:19], 0
ds_read_b64_tr_b16 v[192:193], v10 offset:8192
ds_read_b64_tr_b16 v[194:195], v10 offset:8704
v_lshrrev_b32 v2, 1, v253
buffer_load_dword v2, v2, s[4:7], 0 offen sc1
v_mfma_f32_16x16x32_bf16 v[220:223], v[232:235], v[176:179], 0
v_add_f32 v245, v225, v227
s_lshl_b32 s33, s30, 9
s_add_u32 s33, s33, 118784
v_add_u32 v15, s33, v253
ds_write_b64 v15, v[244:245]
ds_write_b32 v254, v240 offset:0
v_xor_b32 v15, 2048, v15
s_waitcnt lgkmcnt(8)
v_mfma_f32_32x32x16_bf16 v[144:159], v[180:183], v[20:23], v[144:159]
ds_read_b64_tr_b16 v[176:177], v11 offset:8192
ds_read_b64_tr_b16 v[178:179], v11 offset:8704
s_add_u32 m0, s45, 57344
s_nop 0
buffer_load_dwordx4 v4, s[16:19], s41 offen lds
s_add_u32 s41, s41, s43
s_waitcnt lgkmcnt(8)
v_mfma_f32_32x32x16_bf16 v[144:159], v[184:187], v[24:27], v[144:159]
ds_read_b64_tr_b16 v[180:181], v12 offset:8192
ds_read_b64_tr_b16 v[182:183], v12 offset:8704
s_add_u32 m0, s45, 65536
s_nop 0
buffer_load_dwordx4 v4, s[16:19], s41 offen lds
s_add_u32 s41, s41, s43
s_waitcnt lgkmcnt(4)
s_barrier
v_mfma_f32_32x32x16_bf16 v[144:159], v[188:191], v[28:31], v[144:159]
ds_read_b64_tr_b16 v[184:185], v13 offset:8192
ds_read_b64_tr_b16 v[186:187], v13 offset:8704
s_add_u32 m0, s45, 73728
s_nop 0
buffer_load_dwordx4 v4, s[16:19], s41 offen lds
s_add_u32 s41, s41, s43
ds_read_b64 v[196:197], v15
v_and_b32 v15, 0xfffffff0, v254
ds_read_b128 v[200:203], v15 offset:0
v_mfma_f32_32x32x16_bf16 v[144:159], v[192:195], v[32:35], v[144:159]
ds_read_b64_tr_b16 v[188:189], v10 offset:16384
ds_read_b64_tr_b16 v[190:191], v10 offset:16896
s_add_u32 m0, s45, 81920
s_nop 0
buffer_load_dwordx4 v4, s[16:19], s41 offen lds
s_add_u32 s41, s41, s43
s_waitcnt lgkmcnt(3)
v_add_f32 v224, v244, v196
v_add_f32 v225, v245, v197
v_mov_b32 v196, v224
v_mov_b32 v197, v225
v_mov_b32 v241, 0
v_mov_b32 v242, 0
v_permlane32_swap_b32 v197, v225
v_add_f32 v225, v225, v197
v_mul_f32 v224, 0xbb124925, v224
v_mul_f32 v225, 0x3b124925, v225
v_and_b32 v196, 0xffff0000, v224
v_fma_f32 v225, -v224, v224, v225
v_sub_f32 v197, v224, v196
v_mfma_f32_16x16x32_bf16 v[220:223], v[232:235], v[192:195], v[220:223]
v_mfma_f32_32x32x16_bf16 v[144:159], v[176:179], v[36:39], v[144:159]
ds_read_b64_tr_b16 v[192:193], v11 offset:16384
ds_read_b64_tr_b16 v[194:195], v11 offset:16896
s_add_u32 m0, s45, 90112
s_nop 0
buffer_load_dwordx4 v4, s[16:19], s41 offen lds
s_add_u32 s41, s41, s43
v_max_f32 v225, 0, v225
v_cndmask_b32 v196, v196, v197, s[54:55]
v_add_f32 v225, 0x3727c5ac, v225
v_cvt_pk_bf16_f32 v236, v196, v196
v_rsq_f32 v226, v225
v_mov_b32 v243, 0
s_waitcnt lgkmcnt(4)
v_add_f32 v200, v200, v201
v_add_f32 v202, v202, v203
v_add_f32 v200, v200, v202
v_and_b32 v201, 0xffff0000, v200
v_sub_f32 v200, v200, v201
v_cvt_pk_bf16_f32 v240, v201, v200
v_mul_f32 v229, v225, v226
v_mfma_f32_32x32x16_bf16 v[144:159], v[180:183], v[40:43], v[144:159]
ds_read_b64_tr_b16 v[176:177], v12 offset:16384
ds_read_b64_tr_b16 v[178:179], v12 offset:16896
s_add_u32 m0, s45, 98304
s_nop 0
buffer_load_dwordx4 v4, s[16:19], s41 offen lds
s_add_u32 s41, s41, s43
v_mul_f32 v227, 0xc0135761, v226
v_mfma_f32_32x32x16_bf16 v[128:143], v[240:243], v[236:239], v[128:143]
v_mul_f32 v228, v226, v226
v_mul_f32 v228, v228, v226
v_mul_f32 v228, 0xbdd2d3e8, v228
v_mfma_f32_32x32x16_bf16 v[144:159], v[184:187], v[44:47], v[144:159]
ds_read_b64_tr_b16 v[180:181], v13 offset:16384
ds_read_b64_tr_b16 v[182:183], v13 offset:16896
s_add_u32 m0, s45, 106496
s_nop 0
buffer_load_dwordx4 v4, s[16:19], s41 offen lds
s_add_u32 s41, s41, s43
s_waitcnt vmcnt(8)
s_barrier
s_waitcnt lgkmcnt(6)
v_mfma_f32_32x32x16_bf16 v[144:159], v[188:191], v[48:51], v[144:159]
ds_read_b64_tr_b16 v[184:185], v10 offset:24576
ds_read_b64_tr_b16 v[186:187], v10 offset:25088
s_mov_b32 s16, s68
s_and_b32 s17, s69, 0xffff
s_mov_b32 s18, 401408
s_mov_b32 s19, 0x20000
s_mov_b32 s20, s78
s_and_b32 s21, s79, 0xffff
s_mov_b32 s22, 802816
s_mov_b32 s23, 0x20000
s_mov_b32 s40, 0x33333333
s_mov_b32 s41, 0x33333333
v_mfma_f32_16x16x32_bf16 v[220:223], v[232:235], v[188:191], v[220:223]
s_waitcnt lgkmcnt(6)
v_mfma_f32_32x32x16_bf16 v[144:159], v[192:195], v[52:55], v[144:159]
ds_read_b64_tr_b16 v[188:189], v11 offset:24576
ds_read_b64_tr_b16 v[190:191], v11 offset:25088
v_mul_f32 v196, v128, v128
v_mul_f32 v197, v129, v129
v_mul_f32 v198, v130, v130
v_mul_f32 v199, v131, v131
v_mul_f32 v200, v132, v132
v_mul_f32 v201, v133, v133
v_mul_f32 v202, v134, v134
v_mul_f32 v203, v135, v135
v_fma_f32 v196, v196, v228, v227
v_fma_f32 v197, v197, v228, v227
v_fma_f32 v198, v198, v228, v227
v_fma_f32 v199, v199, v228, v227
v_fma_f32 v200, v200, v228, v227
v_fma_f32 v201, v201, v228, v227
v_fma_f32 v202, v202, v228, v227
v_fma_f32 v203, v203, v228, v227
v_mul_f32 v196, v196, v128
v_mul_f32 v197, v197, v129
s_waitcnt lgkmcnt(6)
v_mfma_f32_32x32x16_bf16 v[144:159], v[176:179], v[56:59], v[144:159]
ds_read_b64_tr_b16 v[192:193], v12 offset:24576
ds_read_b64_tr_b16 v[194:195], v12 offset:25088
v_mul_f32 v198, v198, v130
v_mul_f32 v199, v199, v131
v_mul_f32 v200, v200, v132
v_mul_f32 v201, v201, v133
v_mul_f32 v202, v202, v134
v_mul_f32 v203, v203, v135
v_exp_f32 v196, v196
v_exp_f32 v197, v197
v_exp_f32 v198, v198
v_exp_f32 v199, v199
v_exp_f32 v200, v200
v_exp_f32 v201, v201
v_exp_f32 v202, v202
v_exp_f32 v203, v203
v_fma_f32 v196, v196, v229, v229
v_fma_f32 v197, v197, v229, v229
v_fma_f32 v198, v198, v229, v229
s_waitcnt lgkmcnt(6)
v_mfma_f32_32x32x16_bf16 v[144:159], v[180:183], v[60:63], v[144:159]
ds_read_b64_tr_b16 v[176:177], v13 offset:24576
ds_read_b64_tr_b16 v[178:179], v13 offset:25088
v_fma_f32 v199, v199, v229, v229
v_fma_f32 v200, v200, v229, v229
v_fma_f32 v201, v201, v229, v229
v_fma_f32 v202, v202, v229, v229
v_fma_f32 v203, v203, v229, v229
v_rcp_f32 v196, v196
v_rcp_f32 v197, v197
v_rcp_f32 v198, v198
v_rcp_f32 v199, v199
v_rcp_f32 v200, v200
v_rcp_f32 v201, v201
v_rcp_f32 v202, v202
v_rcp_f32 v203, v203
v_mul_f32 v128, v196, v128
v_mul_f32 v129, v197, v129
v_mul_f32 v130, v198, v130
v_mul_f32 v131, v199, v131
s_waitcnt lgkmcnt(6)
v_mfma_f32_32x32x16_bf16 v[144:159], v[184:187], v[64:67], v[144:159]
ds_read_b64_tr_b16 v[180:181], v10 offset:32768
ds_read_b64_tr_b16 v[182:183], v10 offset:33280
v_mul_f32 v132, v200, v132
v_mul_f32 v133, v201, v133
v_mul_f32 v134, v202, v134
v_mul_f32 v135, v203, v135
v_mov_b32 v224, v128
v_mul_f32 v225, v128, v128
v_add_f32 v224, v224, v129
v_fmac_f32 v225, v129, v129
v_add_f32 v224, v224, v130
v_fmac_f32 v225, v130, v130
v_add_f32 v224, v224, v131
v_fmac_f32 v225, v131, v131
v_add_f32 v224, v224, v132
v_fmac_f32 v225, v132, v132
v_add_f32 v224, v224, v133
v_fmac_f32 v225, v133, v133
v_add_f32 v224, v224, v134
v_mfma_f32_16x16x32_bf16 v[220:223], v[232:235], v[184:187], v[220:223]
s_waitcnt lgkmcnt(6)
v_mfma_f32_32x32x16_bf16 v[144:159], v[188:191], v[68:71], v[144:159]
ds_read_b64_tr_b16 v[184:185], v11 offset:32768
ds_read_b64_tr_b16 v[186:187], v11 offset:33280
v_fmac_f32 v225, v134, v134
v_add_f32 v224, v224, v135
v_fmac_f32 v225, v135, v135
v_mul_f32 v204, v136, v136
v_mul_f32 v205, v137, v137
v_mul_f32 v206, v138, v138
v_mul_f32 v207, v139, v139
v_mul_f32 v208, v140, v140
v_mul_f32 v209, v141, v141
v_mul_f32 v210, v142, v142
v_mul_f32 v211, v143, v143
v_fma_f32 v204, v204, v228, v227
v_fma_f32 v205, v205, v228, v227
v_fma_f32 v206, v206, v228, v227
v_fma_f32 v207, v207, v228, v227
v_fma_f32 v208, v208, v228, v227
v_fma_f32 v209, v209, v228, v227
s_waitcnt lgkmcnt(6)
v_mfma_f32_32x32x16_bf16 v[144:159], v[192:195], v[72:75], v[144:159]
ds_read_b64_tr_b16 v[188:189], v12 offset:32768
ds_read_b64_tr_b16 v[190:191], v12 offset:33280
v_fma_f32 v210, v210, v228, v227
v_fma_f32 v211, v211, v228, v227
v_mul_f32 v204, v204, v136
v_mul_f32 v205, v205, v137
v_mul_f32 v206, v206, v138
v_mul_f32 v207, v207, v139
v_mul_f32 v208, v208, v140
v_mul_f32 v209, v209, v141
v_mul_f32 v210, v210, v142
v_mul_f32 v211, v211, v143
v_exp_f32 v204, v204
v_exp_f32 v205, v205
v_exp_f32 v206, v206
v_exp_f32 v207, v207
v_exp_f32 v208, v208
v_exp_f32 v209, v209
v_exp_f32 v210, v210
s_waitcnt lgkmcnt(6)
v_mfma_f32_32x32x16_bf16 v[144:159], v[176:179], v[76:79], v[144:159]
ds_read_b64_tr_b16 v[192:193], v13 offset:32768
ds_read_b64_tr_b16 v[194:195], v13 offset:33280
v_exp_f32 v211, v211
v_fma_f32 v204, v204, v229, v229
v_fma_f32 v205, v205, v229, v229
v_fma_f32 v206, v206, v229, v229
v_fma_f32 v207, v207, v229, v229
v_fma_f32 v208, v208, v229, v229
v_fma_f32 v209, v209, v229, v229
v_fma_f32 v210, v210, v229, v229
v_fma_f32 v211, v211, v229, v229
v_rcp_f32 v204, v204
v_rcp_f32 v205, v205
v_rcp_f32 v206, v206
v_rcp_f32 v207, v207
v_rcp_f32 v208, v208
v_rcp_f32 v209, v209
v_rcp_f32 v210, v210
v_rcp_f32 v211, v211
s_waitcnt lgkmcnt(6)
v_mfma_f32_32x32x16_bf16 v[144:159], v[180:183], v[80:83], v[144:159]
ds_read_b64_tr_b16 v[176:177], v10 offset:40960
ds_read_b64_tr_b16 v[178:179], v10 offset:41472
v_mul_f32 v136, v204, v136
v_mul_f32 v137, v205, v137
v_mul_f32 v138, v206, v138
v_mul_f32 v139, v207, v139
v_mul_f32 v140, v208, v140
v_mul_f32 v141, v209, v141
v_mul_f32 v142, v210, v142
v_mul_f32 v143, v211, v143
v_add_f32 v224, v224, v136
v_fmac_f32 v225, v136, v136
v_add_f32 v224, v224, v137
v_fmac_f32 v225, v137, v137
v_add_f32 v224, v224, v138
v_fmac_f32 v225, v138, v138
v_add_f32 v224, v224, v139
v_fmac_f32 v225, v139, v139
v_add_f32 v224, v224, v140
v_mfma_f32_16x16x32_bf16 v[220:223], v[232:235], v[180:183], v[220:223]
s_waitcnt lgkmcnt(6)
v_mfma_f32_32x32x16_bf16 v[144:159], v[184:187], v[84:87], v[144:159]
ds_read_b64_tr_b16 v[180:181], v11 offset:40960
ds_read_b64_tr_b16 v[182:183], v11 offset:41472
v_fmac_f32 v225, v140, v140
v_add_f32 v224, v224, v141
v_fmac_f32 v225, v141, v141
v_add_f32 v224, v224, v142
v_fmac_f32 v225, v142, v142
v_add_f32 v224, v224, v143
v_fmac_f32 v225, v143, v143
v_mov_b32 v196, v224
v_mov_b32 v197, v225
s_lshl_b32 s33, s30, 9
s_add_u32 s33, s33, 118784
v_add_u32 v8, s33, v253
v_mov_b32 v227, 1
v_permlane32_swap_b32 v196, v224
v_permlane32_swap_b32 v197, v225
v_add_f32 v224, v224, v196
v_add_f32 v225, v225, v197
ds_write_b64 v8, v[224:225]
v_xor_b32 v8, 2048, v8
s_waitcnt lgkmcnt(0)
s_barrier
v_mfma_f32_32x32x16_bf16 v[144:159], v[188:191], v[88:91], v[144:159]
ds_read_b64_tr_b16 v[184:185], v12 offset:40960
ds_read_b64_tr_b16 v[186:187], v12 offset:41472
ds_read_b64 v[196:197], v8
s_waitcnt vmcnt(7)
P1_A_CR:
v_cmp_eq_u32 vcc, 0, v2
s_and_b64 vcc, vcc, s[40:41]
s_cbranch_vccnz P1_A_CW
P1_A_CX:
v_mfma_f32_32x32x16_bf16 v[144:159], v[192:195], v[92:95], v[144:159]
ds_read_b64_tr_b16 v[188:189], v13 offset:40960
ds_read_b64_tr_b16 v[190:191], v13 offset:41472
s_waitcnt lgkmcnt(2)
v_add_f32 v224, v224, v196
v_add_f32 v225, v225, v197
s_lshl_b32 s33, s32, 4
s_lshl_b32 exec_lo, 0xffff, s33
s_mov_b32 exec_hi, 0
buffer_store_dwordx2 v[224:225], v253, s[24:27], s10 offen sc1
s_mov_b64 exec, -1
s_and_b32 s10, s10, 0xfffff000
v_mfma_f32_32x32x16_bf16 v[144:159], v[176:179], v[96:99], v[144:159]
ds_read_b64_tr_b16 v[192:193], v10 offset:49152
ds_read_b64_tr_b16 v[194:195], v10 offset:49664
v_mfma_f32_16x16x32_bf16 v[220:223], v[232:235], v[176:179], v[220:223]
v_mfma_f32_32x32x16_bf16 v[144:159], v[180:183], v[100:103], v[144:159]
ds_read_b64_tr_b16 v[176:177], v11 offset:49152
ds_read_b64_tr_b16 v[178:179], v11 offset:49664
v_mfma_f32_32x32x16_bf16 v[144:159], v[184:187], v[104:107], v[144:159]
ds_read_b64_tr_b16 v[180:181], v12 offset:49152
ds_read_b64_tr_b16 v[182:183], v12 offset:49664
s_waitcnt lgkmcnt(6)
v_mfma_f32_32x32x16_bf16 v[144:159], v[188:191], v[108:111], v[144:159]
ds_read_b64_tr_b16 v[184:185], v13 offset:49152
ds_read_b64_tr_b16 v[186:187], v13 offset:49664
s_waitcnt vmcnt(1)
s_barrier
s_waitcnt lgkmcnt(6)
v_mfma_f32_32x32x16_bf16 v[144:159], v[192:195], v[112:115], v[144:159]
v_add_u32 v10, 57344, v10
v_add_u32 v11, 57344, v11
v_add_u32 v12, 57344, v12
v_add_u32 v13, 57344, v13
ds_read_b64_tr_b16 v[188:189], v10 offset:0
ds_read_b64_tr_b16 v[190:191], v10 offset:512
v_mfma_f32_16x16x32_bf16 v[220:223], v[232:235], v[192:195], v[220:223]
s_waitcnt lgkmcnt(6)
v_mfma_f32_32x32x16_bf16 v[144:159], v[176:179], v[116:119], v[144:159]
ds_read_b64_tr_b16 v[192:193], v11 offset:0
ds_read_b64_tr_b16 v[194:195], v11 offset:512
s_waitcnt lgkmcnt(6)
v_mfma_f32_32x32x16_bf16 v[144:159], v[180:183], v[120:123], v[144:159]
ds_read_b64_tr_b16 v[176:177], v12 offset:0
ds_read_b64_tr_b16 v[178:179], v12 offset:512
s_waitcnt lgkmcnt(6)
v_mfma_f32_32x32x16_bf16 v[144:159], v[184:187], v[124:127], v[144:159]
ds_read_b64_tr_b16 v[180:181], v13 offset:0
ds_read_b64_tr_b16 v[182:183], v13 offset:512
ds_write_b32 v254, v220 offset:2048
buffer_load_dwordx2 v[2:3], v253, s[24:27], s10 offen offset:0 sc1
buffer_load_dwordx2 v[4:5], v253, s[24:27], s10 offen offset:512 sc1
buffer_load_dwordx2 v[6:7], v253, s[24:27], s10 offen offset:1024 sc1
buffer_load_dwordx2 v[8:9], v253, s[24:27], s10 offen offset:1536 sc1
buffer_load_dwordx2 v[244:245], v253, s[24:27], s10 offen offset:2048 sc1
buffer_load_dwordx2 v[246:247], v253, s[24:27], s10 offen offset:2560 sc1
buffer_load_dwordx2 v[228:229], v253, s[24:27], s10 offen offset:3072 sc1
s_waitcnt lgkmcnt(7)
v_mfma_f32_32x32x16_bf16 v[160:175], v[188:191], v[16:19], 0
ds_read_b64_tr_b16 v[184:185], v10 offset:8192
ds_read_b64_tr_b16 v[186:187], v10 offset:8704
v_mfma_f32_16x16x32_bf16 v[220:223], v[232:235], v[188:191], 0
s_waitcnt lgkmcnt(7)
v_mfma_f32_32x32x16_bf16 v[160:175], v[192:195], v[20:23], v[160:175]
ds_read_b64_tr_b16 v[188:189], v11 offset:8192
ds_read_b64_tr_b16 v[190:191], v11 offset:8704
s_waitcnt lgkmcnt(4)
s_barrier
v_mfma_f32_32x32x16_bf16 v[160:175], v[176:179], v[24:27], v[160:175]
ds_read_b64_tr_b16 v[192:193], v12 offset:8192
ds_read_b64_tr_b16 v[194:195], v12 offset:8704
v_mfma_f32_32x32x16_bf16 v[160:175], v[180:183], v[28:31], v[160:175]
ds_read_b64_tr_b16 v[176:177], v13 offset:8192
ds_read_b64_tr_b16 v[178:179], v13 offset:8704
s_waitcnt lgkmcnt(6)
v_mfma_f32_32x32x16_bf16 v[160:175], v[184:187], v[32:35], v[160:175]
ds_read_b64_tr_b16 v[180:181], v10 offset:16384
ds_read_b64_tr_b16 v[182:183], v10 offset:16896
s_waitcnt vmcnt(0)
P1_A_PR:
v_max3_u32 v224, v3, v5, v7
v_max3_u32 v225, v9, v245, v247
v_max3_u32 v224, v224, v225, v229
v_cmp_eq_u32 vcc, -1, v224
s_cbranch_vccnz P1_A_PW
P1_A_PX:
v_add_f32 v2, v2, v4
v_add_f32 v3, v3, v5
v_add_f32 v6, v6, v8
v_add_f32 v7, v7, v9
v_add_f32 v244, v244, v246
v_add_f32 v245, v245, v247
v_add_f32 v2, v2, v6
v_add_f32 v3, v3, v7
v_mfma_f32_16x16x32_bf16 v[220:223], v[232:235], v[184:187], v[220:223]
s_waitcnt lgkmcnt(6)
v_mfma_f32_32x32x16_bf16 v[160:175], v[188:191], v[36:39], v[160:175]
ds_read_b64_tr_b16 v[184:185], v11 offset:16384
ds_read_b64_tr_b16 v[186:187], v11 offset:16896
v_add_f32 v244, v244, v228
v_add_f32 v245, v245, v229
v_add_f32 v2, v2, v244
v_add_f32 v3, v3, v245
v_mov_b32 v4, v2
v_mov_b32 v5, v3
s_nop 0
v_permlane32_swap_b32 v4, v2
v_permlane32_swap_b32 v5, v3
s_waitcnt lgkmcnt(6)
v_mfma_f32_32x32x16_bf16 v[160:175], v[192:195], v[40:43], v[160:175]
ds_read_b64_tr_b16 v[188:189], v12 offset:16384
ds_read_b64_tr_b16 v[190:191], v12 offset:16896
v_add_f32 v2, v2, v4
v_add_f32 v3, v3, v5
v_mul_f32 v2, 0xba924925, v2
v_mul_f32 v3, 0x3a924925, v3
v_fma_f32 v3, -v2, v2, v3
v_max_f32 v3, 0, v3
v_add_f32 v3, 0x3727c5ac, v3
v_rsq_f32 v3, v3
s_nop 0
s_waitcnt lgkmcnt(6)
v_mfma_f32_32x32x16_bf16 v[160:175], v[176:179], v[44:47], v[160:175]
ds_read_b64_tr_b16 v[192:193], v13 offset:16384
ds_read_b64_tr_b16 v[194:195], v13 offset:16896
v_mul_f32 v2, v2, v3
v_fma_f32 v128, v128, v3, v2
v_fma_f32 v129, v129, v3, v2
v_fma_f32 v130, v130, v3, v2
v_fma_f32 v131, v131, v3, v2
v_fma_f32 v132, v132, v3, v2
v_fma_f32 v133, v133, v3, v2
v_fma_f32 v134, v134, v3, v2
v_fma_f32 v135, v135, v3, v2
s_waitcnt lgkmcnt(6)
v_mfma_f32_32x32x16_bf16 v[160:175], v[180:183], v[48:51], v[160:175]
ds_read_b64_tr_b16 v[176:177], v10 offset:24576
ds_read_b64_tr_b16 v[178:179], v10 offset:25088
v_cvt_pk_bf16_f32 v128, v128, v129
v_cvt_pk_bf16_f32 v129, v130, v131
v_cvt_pk_bf16_f32 v130, v132, v133
v_cvt_pk_bf16_f32 v131, v134, v135
buffer_store_dwordx4 v[128:131], v14, s[24:27], s47 offen sc1
v_fma_f32 v136, v136, v3, v2
v_fma_f32 v137, v137, v3, v2
v_fma_f32 v138, v138, v3, v2
v_fma_f32 v139, v139, v3, v2
v_mfma_f32_16x16x32_bf16 v[220:223], v[232:235], v[180:183], v[220:223]
s_waitcnt lgkmcnt(6)
v_mfma_f32_32x32x16_bf16 v[160:175], v[184:187], v[52:55], v[160:175]
ds_read_b64_tr_b16 v[180:181], v11 offset:24576
ds_read_b64_tr_b16 v[182:183], v11 offset:25088
v_fma_f32 v140, v140, v3, v2
v_fma_f32 v141, v141, v3, v2
v_fma_f32 v142, v142, v3, v2
v_fma_f32 v143, v143, v3, v2
v_cvt_pk_bf16_f32 v132, v136, v137
v_cvt_pk_bf16_f32 v133, v138, v139
v_cvt_pk_bf16_f32 v134, v140, v141
v_cvt_pk_bf16_f32 v135, v142, v143
buffer_store_dwordx4 v[132:135], v14, s[24:27], s47 offen offset:1024 sc1
s_waitcnt lgkmcnt(6)
v_mfma_f32_32x32x16_bf16 v[160:175], v[188:191], v[56:59], v[160:175]
ds_read_b64_tr_b16 v[184:185], v12 offset:24576
ds_read_b64_tr_b16 v[186:187], v12 offset:25088
ds_read_b128 v[248:251], v15 offset:2048
s_waitcnt lgkmcnt(7)
v_mfma_f32_32x32x16_bf16 v[160:175], v[192:195], v[60:63], v[160:175]
ds_read_b64_tr_b16 v[188:189], v13 offset:24576
ds_read_b64_tr_b16 v[190:191], v13 offset:25088
s_waitcnt lgkmcnt(2)
v_add_f32 v248, v248, v249
v_add_f32 v250, v250, v251
v_add_f32 v248, v248, v250
v_and_b32 v249, 0xffff0000, v248
v_sub_f32 v248, v248, v249
v_cvt_pk_bf16_f32 v240, v249, v248
s_nop 1
v_mfma_f32_32x32x16_bf16 v[160:175], v[176:179], v[64:67], v[160:175]
ds_read_b64_tr_b16 v[192:193], v10 offset:32768
ds_read_b64_tr_b16 v[194:195], v10 offset:33280
v_mfma_f32_32x32x16_bf16 v[144:159], v[240:243], v[236:239], v[144:159]
v_mfma_f32_16x16x32_bf16 v[220:223], v[232:235], v[176:179], v[220:223]
v_mfma_f32_32x32x16_bf16 v[160:175], v[180:183], v[68:71], v[160:175]
ds_read_b64_tr_b16 v[176:177], v11 offset:32768
ds_read_b64_tr_b16 v[178:179], v11 offset:33280
v_mfma_f32_32x32x16_bf16 v[160:175], v[184:187], v[72:75], v[160:175]
ds_read_b64_tr_b16 v[180:181], v12 offset:32768
ds_read_b64_tr_b16 v[182:183], v12 offset:33280
s_waitcnt lgkmcnt(6)
v_mfma_f32_32x32x16_bf16 v[160:175], v[188:191], v[76:79], v[160:175]
ds_read_b64_tr_b16 v[184:185], v13 offset:32768
ds_read_b64_tr_b16 v[186:187], v13 offset:33280
v_fmaak_f32 v144, v144, v226, 0x358637bd
v_fmaak_f32 v145, v145, v226, 0x358637bd
v_fmaak_f32 v146, v146, v226, 0x358637bd
v_fmaak_f32 v147, v147, v226, 0x358637bd
v_fmaak_f32 v148, v148, v226, 0x358637bd
v_fmaak_f32 v149, v149, v226, 0x358637bd
v_fmaak_f32 v150, v150, v226, 0x358637bd
v_fmaak_f32 v151, v151, v226, 0x358637bd
v_fmaak_f32 v196, v144, v230, 0xb5c1a2a0
v_fmaak_f32 v197, v145, v230, 0xb5c1a2a0
s_waitcnt lgkmcnt(6)
v_mfma_f32_32x32x16_bf16 v[160:175], v[192:195], v[80:83], v[160:175]
ds_read_b64_tr_b16 v[188:189], v10 offset:40960
ds_read_b64_tr_b16 v[190:191], v10 offset:41472
v_fmaak_f32 v198, v146, v230, 0xb5c1a2a0
v_fmaak_f32 v199, v147, v230, 0xb5c1a2a0
v_fmaak_f32 v200, v148, v230, 0xb5c1a2a0
v_fmaak_f32 v201, v149, v230, 0xb5c1a2a0
v_fmaak_f32 v202, v150, v230, 0xb5c1a2a0
v_fmaak_f32 v203, v151, v230, 0xb5c1a2a0
v_exp_f32_e64 v196, v196 clamp
v_exp_f32_e64 v197, v197 clamp
v_exp_f32_e64 v198, v198 clamp
v_exp_f32_e64 v199, v199 clamp
v_mfma_f32_16x16x32_bf16 v[220:223], v[232:235], v[192:195], v[220:223]
s_waitcnt lgkmcnt(6)
v_mfma_f32_32x32x16_bf16 v[160:175], v[176:179], v[84:87], v[160:175]
ds_read_b64_tr_b16 v[192:193], v11 offset:40960
ds_read_b64_tr_b16 v[194:195], v11 offset:41472
v_exp_f32_e64 v200, v200 clamp
v_exp_f32_e64 v201, v201 clamp
v_exp_f32_e64 v202, v202 clamp
v_exp_f32_e64 v203, v203 clamp
v_max_f32 v144, 0x358637bd, v144
v_max_f32 v145, 0x358637bd, v145
v_max_f32 v146, 0x358637bd, v146
v_max_f32 v147, 0x358637bd, v147
v_max_f32 v148, 0x358637bd, v148
v_lshlrev_b32 v224, 7, v1
s_waitcnt vmcnt(0)
s_barrier
s_cmp_eq_u32 s30, 0
s_cselect_b64 exec, 15, 0
buffer_store_dword v227, v224, s[24:27], s9 offen sc1
s_mov_b64 exec, -1
s_waitcnt lgkmcnt(6)
v_mfma_f32_32x32x16_bf16 v[160:175], v[180:183], v[88:91], v[160:175]
ds_read_b64_tr_b16 v[176:177], v12 offset:40960
ds_read_b64_tr_b16 v[178:179], v12 offset:41472
v_max_f32 v149, 0x358637bd, v149
v_max_f32 v150, 0x358637bd, v150
v_max_f32 v151, 0x358637bd, v151
v_add_f32 v144, v144, v196
v_add_f32 v145, v145, v197
v_add_f32 v146, v146, v198
v_add_f32 v147, v147, v199
v_add_f32 v148, v148, v200
v_add_f32 v149, v149, v201
s_waitcnt lgkmcnt(6)
v_mfma_f32_32x32x16_bf16 v[160:175], v[184:187], v[92:95], v[160:175]
ds_read_b64_tr_b16 v[180:181], v13 offset:40960
ds_read_b64_tr_b16 v[182:183], v13 offset:41472
v_add_f32 v150, v150, v202
v_add_f32 v151, v151, v203
v_fmaak_f32 v152, v152, v226, 0x358637bd
v_fmaak_f32 v153, v153, v226, 0x358637bd
v_fmaak_f32 v154, v154, v226, 0x358637bd
v_fmaak_f32 v155, v155, v226, 0x358637bd
v_fmaak_f32 v156, v156, v226, 0x358637bd
v_fmaak_f32 v157, v157, v226, 0x358637bd
v_fmaak_f32 v158, v158, v226, 0x358637bd
s_waitcnt lgkmcnt(6)
v_mfma_f32_32x32x16_bf16 v[160:175], v[188:191], v[96:99], v[160:175]
ds_read_b64_tr_b16 v[184:185], v10 offset:49152
ds_read_b64_tr_b16 v[186:187], v10 offset:49664
v_fmaak_f32 v159, v159, v226, 0x358637bd
v_fmaak_f32 v204, v152, v230, 0xb5c1a2a0
v_fmaak_f32 v205, v153, v230, 0xb5c1a2a0
v_fmaak_f32 v206, v154, v230, 0xb5c1a2a0
v_fmaak_f32 v207, v155, v230, 0xb5c1a2a0
v_fmaak_f32 v208, v156, v230, 0xb5c1a2a0
v_fmaak_f32 v209, v157, v230, 0xb5c1a2a0
v_fmaak_f32 v210, v158, v230, 0xb5c1a2a0
v_fmaak_f32 v211, v159, v230, 0xb5c1a2a0
v_mfma_f32_16x16x32_bf16 v[220:223], v[232:235], v[188:191], v[220:223]
s_waitcnt lgkmcnt(6)
v_mfma_f32_32x32x16_bf16 v[160:175], v[192:195], v[100:103], v[160:175]
ds_read_b64_tr_b16 v[188:189], v11 offset:49152
ds_read_b64_tr_b16 v[190:191], v11 offset:49664
v_exp_f32_e64 v204, v204 clamp
v_exp_f32_e64 v205, v205 clamp
v_exp_f32_e64 v206, v206 clamp
v_exp_f32_e64 v207, v207 clamp
v_exp_f32_e64 v208, v208 clamp
v_exp_f32_e64 v209, v209 clamp
v_exp_f32_e64 v210, v210 clamp
v_exp_f32_e64 v211, v211 clamp
v_max_f32 v152, 0x358637bd, v152
s_waitcnt lgkmcnt(6)
v_mfma_f32_32x32x16_bf16 v[160:175], v[176:179], v[104:107], v[160:175]
ds_read_b64_tr_b16 v[192:193], v12 offset:49152
ds_read_b64_tr_b16 v[194:195], v12 offset:49664
v_max_f32 v153, 0x358637bd, v153
v_max_f32 v154, 0x358637bd, v154
v_max_f32 v155, 0x358637bd, v155
v_max_f32 v156, 0x358637bd, v156
v_max_f32 v157, 0x358637bd, v157
v_max_f32 v158, 0x358637bd, v158
v_max_f32 v159, 0x358637bd, v159
v_add_f32 v152, v152, v204
v_add_f32 v153, v153, v205
s_waitcnt lgkmcnt(6)
v_mfma_f32_32x32x16_bf16 v[160:175], v[180:183], v[108:111], v[160:175]
ds_read_b64_tr_b16 v[176:177], v13 offset:49152
ds_read_b64_tr_b16 v[178:179], v13 offset:49664
v_add_f32 v154, v154, v206
v_add_f32 v155, v155, v207
v_add_f32 v156, v156, v208
v_add_f32 v157, v157, v209
v_add_f32 v158, v158, v210
v_add_f32 v159, v159, v211
v_cvt_pk_bf16_f32 v212, v144, v145
v_cvt_pk_bf16_f32 v213, v146, v147
v_cvt_pk_bf16_f32 v214, v148, v149
s_waitcnt lgkmcnt(6)
v_mfma_f32_32x32x16_bf16 v[160:175], v[184:187], v[112:115], v[160:175]
v_cvt_pk_bf16_f32 v215, v150, v151
v_cvt_pk_bf16_f32 v216, v152, v153
v_cvt_pk_bf16_f32 v217, v154, v155
v_cvt_pk_bf16_f32 v218, v156, v157
v_cvt_pk_bf16_f32 v219, v158, v159
buffer_store_dwordx2 v[212:213], v253, s[24:27], s48 offen offset:0 sc1
buffer_store_dwordx2 v[214:215], v253, s[24:27], s48 offen offset:512 sc1
buffer_store_dwordx2 v[216:217], v253, s[24:27], s48 offen offset:1024 sc1
buffer_store_dwordx2 v[218:219], v253, s[24:27], s48 offen offset:1536 sc1
v_mfma_f32_16x16x32_bf16 v[220:223], v[232:235], v[184:187], v[220:223]
s_waitcnt lgkmcnt(4)
v_mfma_f32_32x32x16_bf16 v[160:175], v[188:191], v[116:119], v[160:175]
s_waitcnt lgkmcnt(2)
v_mfma_f32_32x32x16_bf16 v[160:175], v[192:195], v[120:123], v[160:175]
s_waitcnt lgkmcnt(0)
v_mfma_f32_32x32x16_bf16 v[160:175], v[176:179], v[124:127], v[160:175]
ds_write_b32 v254, v220
P1_GT:
s_cmp_eq_u32 s32, 0
s_cbranch_scc0 P2_CMP
s_and_b32 s37, s2, 1
s_bfe_u32 s34, s2, 0x20003
s_and_b32 s33, s2, 7
s_lshl_b32 s46, s33, 2
s_add_u32 s46, s46, s34
s_lshr_b32 s29, s2, 5
s_mul_i32 s51, s34, 0
s_lshr_b32 s51, s51, 1
s_mul_i32 s33, s29, 0
s_add_u32 s51, s51, s33
s_cmp_ge_u32 s51, 14
s_cselect_b32 s33, 14, 0
s_sub_u32 s51, s51, s33
s_lshl_b32 s33, s29, 1
s_add_u32 s33, s33, s37
s_lshl_b32 s33, s33, 2
s_bfe_u32 s34, s2, 0x20001
s_add_u32 s33, s33, s34
s_lshl_b32 s33, s33, 7
s_add_u32 s52, s33, 15781888
s_xor_b32 s62, s46, s29
s_and_b32 s62, s62, 0
s_lshl_b32 s33, s62, 3
s_add_u32 s41, s33, s52
s_mov_b64 s[72:73], -1
s_mov_b32 s45, s62
s_buffer_load_dwordx4 s[72:75], s[24:27], s52 glc
s_lshr_b32 s34, s31, 1
s_lshl_b32 s36, s37, 5
s_add_u32 s36, s36, s34
s_lshl_b32 s38, s36, 11
s_lshl_b32 s36, s29, 2
s_and_b32 s34, s31, 1
s_add_u32 s36, s36, s34
s_lshl_b32 s36, s36, 17
s_add_u32 s38, s38, s36
v_lshrrev_b32 v12, 3, v1
v_and_b32 v3, 7, v1
v_lshrrev_b32 v13, 4, v1
v_xor_b32 v13, v13, v3
v_lshlrev_b32 v6, 12, v12
v_lshl_add_u32 v2, v13, 4, v6
v_lshlrev_b32 v13, 1, v12
v_and_b32 v13, 4, v13
v_xor_b32 v13, v13, v3
v_xor_b32 v3, 64, v2
v_add_u32 v3, 31744, v3
v_add_u32 v4, 63488, v2
v_add_u32 v5, 63488, v3
s_lshl_b32 s39, s28, 2
s_add_u32 s39, s39, s31
s_lshl_b32 s39, s39, 17
s_lshl_b32 s35, s37, 11
s_add_u32 s39, s39, s35
s_lshl_b32 s40, s31, 12
s_mov_b32 s63, s45
s_add_u32 m0, s40, 16384
s_lshl_b32 s36, s45, 8
s_add_u32 s36, s36, s39
buffer_load_dwordx4 v2, s[12:15], s36 offen offset:0 lds
buffer_load_dwordx4 v3, s[12:15], s36 offen offset:1024 lds
buffer_load_dwordx4 v4, s[12:15], s36 offen offset:2048 lds
buffer_load_dwordx4 v5, s[12:15], s36 offen offset:3072 lds
s_add_u32 m0, s40, 147456
s_lshl_b32 s36, s45, 8
s_add_u32 s36, s36, s39
s_add_u32 s36, s36, 128
buffer_load_dwordx4 v2, s[12:15], s36 offen offset:0 lds
buffer_load_dwordx4 v3, s[12:15], s36 offen offset:1024 lds
buffer_load_dwordx4 v4, s[12:15], s36 offen offset:2048 lds
buffer_load_dwordx4 v5, s[12:15], s36 offen offset:3072 lds
v_and_b32 v6, 4, v12
v_xor_b32 v6, v6, v1
v_lshlrev_b32 v6, 4, v6
s_lshl_b32 s33, s37, 18
v_add_u32 v8, s33, v6
v_xor_b32 v9, 128, v8
v_xor_b32 v6, 262144, v8
v_xor_b32 v7, 262144, v9
v_mul_u32_u24 v11, 896, v12
v_lshl_add_u32 v11, v13, 4, v11
s_lshl_b32 s33, s29, 7
v_add_u32 v11, s33, v11
s_mul_i32 s42, s31, 200704
s_mov_b32 s54, 0
s_waitcnt lgkmcnt(0)

s_barrier
L_T0_R:
s_waitcnt lgkmcnt(0)
s_and_b64 s[72:73], s[72:73], s[74:75]
s_and_b32 s54, s72, s73
s_cbranch_scc0 L_T0_X
L_T0_G:
s_add_u32 m0, s40, 0
s_lshl_b32 s35, s63, 13
s_add_u32 s35, s35, s38
buffer_load_dwordx4 v6, s[24:27], s35 offen offset:0 lds
buffer_load_dwordx4 v7, s[24:27], s35 offen offset:1024 lds
s_add_u32 m0, m0, 2048
s_nop 0
buffer_load_dwordx4 v8, s[24:27], s35 offen offset:0 lds
buffer_load_dwordx4 v9, s[24:27], s35 offen offset:1024 lds
s_add_u32 m0, s40, 131072
s_lshl_b32 s35, s63, 13
s_add_u32 s35, s35, s38
s_add_u32 s35, s35, 4096
buffer_load_dwordx4 v6, s[24:27], s35 offen offset:0 lds
buffer_load_dwordx4 v7, s[24:27], s35 offen offset:1024 lds
s_add_u32 m0, m0, 2048
s_nop 0
buffer_load_dwordx4 v8, s[24:27], s35 offen offset:0 lds
buffer_load_dwordx4 v9, s[24:27], s35 offen offset:1024 lds
s_xor_b32 s45, s45, 1
s_add_u32 m0, s40, 81920
s_lshl_b32 s36, s45, 8
s_add_u32 s36, s36, s39
buffer_load_dwordx4 v2, s[12:15], s36 offen offset:0 lds
buffer_load_dwordx4 v3, s[12:15], s36 offen offset:1024 lds
buffer_load_dwordx4 v4, s[12:15], s36 offen offset:2048 lds
buffer_load_dwordx4 v5, s[12:15], s36 offen offset:3072 lds
L_T0_X:
ds_read_b128 v[248:251], v15 offset:0
s_waitcnt lgkmcnt(0)
v_add_f32 v248, v248, v249
v_add_f32 v250, v250, v251
v_add_f32 v248, v248, v250
v_and_b32 v249, 0xffff0000, v248
v_sub_f32 v248, v248, v249
v_cvt_pk_bf16_f32 v240, v249, v248
s_nop 1
v_mfma_f32_32x32x16_bf16 v[160:175], v[240:243], v[236:239], v[160:175]
v_rcp_f32 v229, v226
v_mul_f32 v228, v226, v226
v_mul_f32 v227, 0xc0135761, v226
v_mul_f32 v228, v228, v226
v_mul_f32 v228, 0xbdd2d3e8, v228
s_cmp_lg_u32 s54, 0
s_cbranch_scc1 L_T1_A
s_buffer_load_dwordx4 s[72:75], s[24:27], s52 glc
L_T1_A:
s_nop 7
v_mul_f32 v196, v160, v160
v_mul_f32 v197, v161, v161
v_mul_f32 v198, v162, v162
v_mul_f32 v199, v163, v163
v_mul_f32 v200, v164, v164
v_mul_f32 v201, v165, v165
v_mul_f32 v202, v166, v166
v_mul_f32 v203, v167, v167
v_fma_f32 v196, v196, v228, v227
v_fma_f32 v197, v197, v228, v227
v_fma_f32 v198, v198, v228, v227
v_fma_f32 v199, v199, v228, v227
v_fma_f32 v200, v200, v228, v227
v_fma_f32 v201, v201, v228, v227
v_fma_f32 v202, v202, v228, v227
v_fma_f32 v203, v203, v228, v227
v_mul_f32 v196, v196, v160
v_mul_f32 v197, v197, v161
v_mul_f32 v198, v198, v162
v_mul_f32 v199, v199, v163
v_mul_f32 v200, v200, v164
v_mul_f32 v201, v201, v165
v_mul_f32 v202, v202, v166
v_mul_f32 v203, v203, v167
v_exp_f32 v196, v196
v_exp_f32 v197, v197
v_exp_f32 v198, v198
v_exp_f32 v199, v199
v_exp_f32 v200, v200
v_exp_f32 v201, v201
v_exp_f32 v202, v202
v_exp_f32 v203, v203
v_fma_f32 v196, v196, v229, v229
v_fma_f32 v197, v197, v229, v229
v_fma_f32 v198, v198, v229, v229
v_fma_f32 v199, v199, v229, v229
v_fma_f32 v200, v200, v229, v229
v_fma_f32 v201, v201, v229, v229
v_fma_f32 v202, v202, v229, v229
v_fma_f32 v203, v203, v229, v229
v_rcp_f32 v196, v196
v_rcp_f32 v197, v197
v_rcp_f32 v198, v198
v_rcp_f32 v199, v199
v_rcp_f32 v200, v200
v_rcp_f32 v201, v201
v_rcp_f32 v202, v202
v_rcp_f32 v203, v203
v_mul_f32 v160, v196, v160
v_mul_f32 v161, v197, v161
v_mul_f32 v162, v198, v162
v_mul_f32 v163, v199, v163
v_mul_f32 v164, v200, v164
v_mul_f32 v165, v201, v165
v_mul_f32 v166, v202, v166
v_mul_f32 v167, v203, v167
v_mul_f32 v204, v168, v168
v_mul_f32 v205, v169, v169
v_mul_f32 v206, v170, v170
v_mul_f32 v207, v171, v171
s_cmp_lg_u32 s54, 0
s_cbranch_scc1 L_T1_X
L_T1_R:
s_waitcnt lgkmcnt(0)
s_and_b64 s[72:73], s[72:73], s[74:75]
s_and_b32 s54, s72, s73
s_cbranch_scc0 L_T1_W
L_T1_G:
s_add_u32 m0, s40, 0
s_lshl_b32 s35, s63, 13
s_add_u32 s35, s35, s38
buffer_load_dwordx4 v6, s[24:27], s35 offen offset:0 lds
buffer_load_dwordx4 v7, s[24:27], s35 offen offset:1024 lds
s_add_u32 m0, m0, 2048
s_nop 0
buffer_load_dwordx4 v8, s[24:27], s35 offen offset:0 lds
buffer_load_dwordx4 v9, s[24:27], s35 offen offset:1024 lds
s_add_u32 m0, s40, 131072
s_lshl_b32 s35, s63, 13
s_add_u32 s35, s35, s38
s_add_u32 s35, s35, 4096
buffer_load_dwordx4 v6, s[24:27], s35 offen offset:0 lds
buffer_load_dwordx4 v7, s[24:27], s35 offen offset:1024 lds
s_add_u32 m0, m0, 2048
s_nop 0
buffer_load_dwordx4 v8, s[24:27], s35 offen offset:0 lds
buffer_load_dwordx4 v9, s[24:27], s35 offen offset:1024 lds
s_xor_b32 s45, s45, 1
s_add_u32 m0, s40, 81920
s_lshl_b32 s36, s45, 8
s_add_u32 s36, s36, s39
buffer_load_dwordx4 v2, s[12:15], s36 offen offset:0 lds
buffer_load_dwordx4 v3, s[12:15], s36 offen offset:1024 lds
buffer_load_dwordx4 v4, s[12:15], s36 offen offset:2048 lds
buffer_load_dwordx4 v5, s[12:15], s36 offen offset:3072 lds
L_T1_X:
s_mov_b64 s[72:73], -1
s_xor_b32 s62, s62, 1
v_bfe_u32 v12, v1, 2, 2
v_lshrrev_b32 v13, 5, v1
v_lshl_add_u32 v12, v13, 2, v12
v_lshlrev_b32 v244, 7, v12
v_and_b32 v12, 3, v1
v_lshl_add_u32 v244, v12, 3, v244
v_and_b32 v12, 16, v1
v_lshl_add_u32 v244, v12, 1, v244
v_and_b32 v12, 8, v1
v_lshl_add_u32 v244, v12, 3, v244
s_lshl_b32 s33, s31, 5
v_xor_b32 v244, s33, v244
s_lshl_b32 s33, s31, 11
s_add_u32 s33, s33, 57344
v_add_u32 v246, s33, v244
s_mul_i32 s33, s31, 14336
v_add_u32 v244, s33, v244
v_xor_b32 v245, 64, v244
v_xor_b32 v247, 64, v246
v_add_u32 v248, 0x10000, v246
v_add_u32 v249, 0x10000, v247
s_waitcnt vmcnt(8)
s_barrier
s_xor_b32 s63, s63, 1
s_add_u32 m0, s40, 65536
s_lshl_b32 s35, s63, 13
s_add_u32 s35, s35, s38
buffer_load_dwordx4 v6, s[24:27], s35 offen offset:0 lds
buffer_load_dwordx4 v7, s[24:27], s35 offen offset:1024 lds
s_add_u32 m0, m0, 2048
s_nop 0
buffer_load_dwordx4 v8, s[24:27], s35 offen offset:0 lds
buffer_load_dwordx4 v9, s[24:27], s35 offen offset:1024 lds
s_add_u32 m0, s40, 114688
s_lshl_b32 s36, s45, 8
s_add_u32 s36, s36, s39
s_add_u32 s36, s36, 128
buffer_load_dwordx4 v2, s[12:15], s36 offen offset:0 lds
buffer_load_dwordx4 v3, s[12:15], s36 offen offset:1024 lds
buffer_load_dwordx4 v4, s[12:15], s36 offen offset:2048 lds
buffer_load_dwordx4 v5, s[12:15], s36 offen offset:3072 lds
v_mul_f32 v208, v172, v172
v_mul_f32 v209, v173, v173
v_mul_f32 v210, v174, v174
v_mul_f32 v211, v175, v175
v_fma_f32 v204, v204, v228, v227
v_fma_f32 v205, v205, v228, v227
v_fma_f32 v206, v206, v228, v227
v_fma_f32 v207, v207, v228, v227
v_fma_f32 v208, v208, v228, v227
v_fma_f32 v209, v209, v228, v227
v_fma_f32 v210, v210, v228, v227
v_fma_f32 v211, v211, v228, v227
v_mul_f32 v204, v204, v168
v_mul_f32 v205, v205, v169
v_mul_f32 v206, v206, v170
v_mul_f32 v207, v207, v171
v_mul_f32 v208, v208, v172
v_mul_f32 v209, v209, v173
v_mul_f32 v210, v210, v174
v_mul_f32 v211, v211, v175
v_exp_f32 v204, v204
v_exp_f32 v205, v205
v_exp_f32 v206, v206
v_exp_f32 v207, v207
v_exp_f32 v208, v208
v_exp_f32 v209, v209
v_exp_f32 v210, v210
v_exp_f32 v211, v211
v_fma_f32 v204, v204, v229, v229
v_fma_f32 v205, v205, v229, v229
v_fma_f32 v206, v206, v229, v229
v_fma_f32 v207, v207, v229, v229
v_fma_f32 v208, v208, v229, v229
v_fma_f32 v209, v209, v229, v229
v_fma_f32 v210, v210, v229, v229
v_fma_f32 v211, v211, v229, v229
v_rcp_f32 v204, v204
v_rcp_f32 v205, v205
v_rcp_f32 v206, v206
v_rcp_f32 v207, v207
v_rcp_f32 v208, v208
v_rcp_f32 v209, v209
v_rcp_f32 v210, v210
v_rcp_f32 v211, v211
v_mul_f32 v168, v204, v168
v_mul_f32 v169, v205, v169
v_mul_f32 v170, v206, v170
v_mul_f32 v171, v207, v171
v_mul_f32 v172, v208, v172
v_mul_f32 v173, v209, v173
v_mul_f32 v174, v210, v174
v_mul_f32 v175, v211, v175
v_cvt_pk_bf16_f32 v212, v160, v161
v_cvt_pk_bf16_f32 v213, v162, v163
v_cvt_pk_bf16_f32 v214, v164, v165
v_cvt_pk_bf16_f32 v215, v166, v167
v_cvt_pk_bf16_f32 v216, v168, v169
v_cvt_pk_bf16_f32 v217, v170, v171
v_cvt_pk_bf16_f32 v218, v172, v173
v_cvt_pk_bf16_f32 v219, v174, v175
s_waitcnt vmcnt(12)
s_barrier
s_mov_b32 s62, 2
s_lshl_b32 s33, s62, 3
s_add_u32 s41, s33, s52
s_cmp_lg_u32 s31, 0
s_cbranch_scc1 L_Z2_A
s_buffer_load_dwordx2 s[72:73], s[24:27], s41 glc
L_Z2_A:
s_add_u32 m0, s40, 98304
s_lshl_b32 s35, s63, 13
s_add_u32 s35, s35, s38
s_add_u32 s35, s35, 4096
buffer_load_dwordx4 v6, s[24:27], s35 offen offset:0 lds
buffer_load_dwordx4 v7, s[24:27], s35 offen offset:1024 lds
s_add_u32 m0, m0, 2048
s_nop 0
buffer_load_dwordx4 v8, s[24:27], s35 offen offset:0 lds
buffer_load_dwordx4 v9, s[24:27], s35 offen offset:1024 lds
s_mov_b32 s45, 2
s_add_u32 m0, s40, 16384
s_lshl_b32 s36, s45, 8
s_add_u32 s36, s36, s39
buffer_load_dwordx4 v2, s[12:15], s36 offen offset:0 lds
buffer_load_dwordx4 v3, s[12:15], s36 offen offset:1024 lds
buffer_load_dwordx4 v4, s[12:15], s36 offen offset:2048 lds
buffer_load_dwordx4 v5, s[12:15], s36 offen offset:3072 lds
v_add_u32 v12, s40, v14
ds_write_b128 v12, v[212:215] offset:32768
ds_write_b128 v12, v[216:219] offset:33792
s_waitcnt lgkmcnt(0)
s_and_b32 s72, s72, s73
s_cbranch_scc0 L_Z2_W
L_Z2_X:
s_waitcnt vmcnt(12)
s_barrier
s_add_u32 s62, s62, 1
s_cmp_eq_u32 s62, 8
s_cselect_b32 s62, 2, s62
s_lshl_b32 s33, s62, 3
s_add_u32 s41, s33, s52
s_cmp_lg_u32 s31, 0
s_cbranch_scc1 L_Z3_A
s_buffer_load_dwordx2 s[72:73], s[24:27], s41 glc
L_Z3_A:
s_mov_b32 s63, 2
s_add_u32 m0, s40, 0
s_lshl_b32 s35, s63, 13
s_add_u32 s35, s35, s38
buffer_load_dwordx4 v6, s[24:27], s35 offen offset:0 lds
buffer_load_dwordx4 v7, s[24:27], s35 offen offset:1024 lds
s_add_u32 m0, m0, 2048
s_nop 0
buffer_load_dwordx4 v8, s[24:27], s35 offen offset:0 lds
buffer_load_dwordx4 v9, s[24:27], s35 offen offset:1024 lds
s_add_u32 m0, s40, 131072
s_lshl_b32 s35, s63, 13
s_add_u32 s35, s35, s38
s_add_u32 s35, s35, 4096
buffer_load_dwordx4 v6, s[24:27], s35 offen offset:0 lds
buffer_load_dwordx4 v7, s[24:27], s35 offen offset:1024 lds
s_add_u32 m0, m0, 2048
s_nop 0
buffer_load_dwordx4 v8, s[24:27], s35 offen offset:0 lds
buffer_load_dwordx4 v9, s[24:27], s35 offen offset:1024 lds
s_add_u32 m0, s40, 147456
s_lshl_b32 s36, s45, 8
s_add_u32 s36, s36, s39
s_add_u32 s36, s36, 128
buffer_load_dwordx4 v2, s[12:15], s36 offen offset:0 lds
buffer_load_dwordx4 v3, s[12:15], s36 offen offset:1024 lds
buffer_load_dwordx4 v4, s[12:15], s36 offen offset:2048 lds
buffer_load_dwordx4 v5, s[12:15], s36 offen offset:3072 lds
s_waitcnt lgkmcnt(0)
s_and_b32 s72, s72, s73
s_cbranch_scc0 L_Z3_W
L_Z3_X:
s_waitcnt vmcnt(16)
s_waitcnt lgkmcnt(0)
s_barrier
s_add_u32 s63, s63, 1
s_cmp_eq_u32 s63, 8
s_cselect_b32 s63, 2, s63
s_add_u32 m0, s40, 65536
s_lshl_b32 s35, s63, 13
s_add_u32 s35, s35, s38
buffer_load_dwordx4 v6, s[24:27], s35 offen offset:0 lds
buffer_load_dwordx4 v7, s[24:27], s35 offen offset:1024 lds
s_add_u32 m0, m0, 2048
s_nop 0
buffer_load_dwordx4 v8, s[24:27], s35 offen offset:0 lds
buffer_load_dwordx4 v9, s[24:27], s35 offen offset:1024 lds
s_add_u32 s45, s45, 1
s_cmp_eq_u32 s45, 8
s_cselect_b32 s45, 2, s45
s_add_u32 m0, s40, 81920
s_lshl_b32 s36, s45, 8
s_add_u32 s36, s36, s39
buffer_load_dwordx4 v2, s[12:15], s36 offen offset:0 lds
buffer_load_dwordx4 v3, s[12:15], s36 offen offset:1024 lds
buffer_load_dwordx4 v4, s[12:15], s36 offen offset:2048 lds
buffer_load_dwordx4 v5, s[12:15], s36 offen offset:3072 lds
s_waitcnt vmcnt(16)
s_barrier
s_add_u32 s62, s62, 1
s_cmp_eq_u32 s62, 8
s_cselect_b32 s62, 2, s62
s_lshl_b32 s33, s62, 3
s_add_u32 s41, s33, s52
s_cmp_lg_u32 s31, 0
s_cbranch_scc1 L_Z4_A
s_buffer_load_dwordx2 s[72:73], s[24:27], s41 glc
L_Z4_A:
s_add_u32 m0, s40, 98304
s_lshl_b32 s35, s63, 13
s_add_u32 s35, s35, s38
s_add_u32 s35, s35, 4096
buffer_load_dwordx4 v6, s[24:27], s35 offen offset:0 lds
buffer_load_dwordx4 v7, s[24:27], s35 offen offset:1024 lds
s_add_u32 m0, m0, 2048
s_nop 0
buffer_load_dwordx4 v8, s[24:27], s35 offen offset:0 lds
buffer_load_dwordx4 v9, s[24:27], s35 offen offset:1024 lds
s_add_u32 m0, s40, 114688
s_lshl_b32 s36, s45, 8
s_add_u32 s36, s36, s39
s_add_u32 s36, s36, 128
buffer_load_dwordx4 v2, s[12:15], s36 offen offset:0 lds
buffer_load_dwordx4 v3, s[12:15], s36 offen offset:1024 lds
buffer_load_dwordx4 v4, s[12:15], s36 offen offset:2048 lds
buffer_load_dwordx4 v5, s[12:15], s36 offen offset:3072 lds
s_waitcnt lgkmcnt(0)
s_and_b32 s72, s72, s73
s_cbranch_scc0 L_Z4_W
L_Z4_X:
s_waitcnt vmcnt(16)
s_barrier
s_add_u32 s63, s63, 1
s_cmp_eq_u32 s63, 8
s_cselect_b32 s63, 2, s63
s_add_u32 m0, s40, 0
s_lshl_b32 s35, s63, 13
s_add_u32 s35, s35, s38
buffer_load_dwordx4 v6, s[24:27], s35 offen offset:0 lds
buffer_load_dwordx4 v7, s[24:27], s35 offen offset:1024 lds
s_add_u32 m0, m0, 2048
s_nop 0
buffer_load_dwordx4 v8, s[24:27], s35 offen offset:0 lds
buffer_load_dwordx4 v9, s[24:27], s35 offen offset:1024 lds
s_add_u32 s45, s45, 1
s_cmp_eq_u32 s45, 8
s_cselect_b32 s45, 2, s45
s_add_u32 m0, s40, 16384
s_lshl_b32 s36, s45, 8
s_add_u32 s36, s36, s39
buffer_load_dwordx4 v2, s[12:15], s36 offen offset:0 lds
buffer_load_dwordx4 v3, s[12:15], s36 offen offset:1024 lds
buffer_load_dwordx4 v4, s[12:15], s36 offen offset:2048 lds
buffer_load_dwordx4 v5, s[12:15], s36 offen offset:3072 lds
s_waitcnt vmcnt(16)
s_barrier
s_add_u32 s62, s62, 1
s_cmp_eq_u32 s62, 8
s_cselect_b32 s62, 2, s62
s_lshl_b32 s33, s62, 3
s_add_u32 s41, s33, s52
s_cmp_lg_u32 s31, 0
s_cbranch_scc1 L_Z5_A
s_buffer_load_dwordx2 s[72:73], s[24:27], s41 glc
L_Z5_A:
s_add_u32 m0, s40, 131072
s_lshl_b32 s35, s63, 13
s_add_u32 s35, s35, s38
s_add_u32 s35, s35, 4096
buffer_load_dwordx4 v6, s[24:27], s35 offen offset:0 lds
buffer_load_dwordx4 v7, s[24:27], s35 offen offset:1024 lds
s_add_u32 m0, m0, 2048
s_nop 0
buffer_load_dwordx4 v8, s[24:27], s35 offen offset:0 lds
buffer_load_dwordx4 v9, s[24:27], s35 offen offset:1024 lds
s_add_u32 m0, s40, 147456
s_lshl_b32 s36, s45, 8
s_add_u32 s36, s36, s39
s_add_u32 s36, s36, 128
buffer_load_dwordx4 v2, s[12:15], s36 offen offset:0 lds
buffer_load_dwordx4 v3, s[12:15], s36 offen offset:1024 lds
buffer_load_dwordx4 v4, s[12:15], s36 offen offset:2048 lds
buffer_load_dwordx4 v5, s[12:15], s36 offen offset:3072 lds
s_waitcnt lgkmcnt(0)
s_and_b32 s72, s72, s73
s_cbranch_scc0 L_Z5_W
L_Z5_X:
s_waitcnt vmcnt(16)
s_barrier
s_add_u32 s63, s63, 1
s_cmp_eq_u32 s63, 8
s_cselect_b32 s63, 2, s63
s_add_u32 m0, s40, 65536
s_lshl_b32 s35, s63, 13
s_add_u32 s35, s35, s38
buffer_load_dwordx4 v6, s[24:27], s35 offen offset:0 lds
buffer_load_dwordx4 v7, s[24:27], s35 offen offset:1024 lds
s_add_u32 m0, m0, 2048
s_nop 0
buffer_load_dwordx4 v8, s[24:27], s35 offen offset:0 lds
buffer_load_dwordx4 v9, s[24:27], s35 offen offset:1024 lds
s_add_u32 s45, s45, 1
s_cmp_eq_u32 s45, 8
s_cselect_b32 s45, 2, s45
s_add_u32 m0, s40, 81920
s_lshl_b32 s36, s45, 8
s_add_u32 s36, s36, s39
buffer_load_dwordx4 v2, s[12:15], s36 offen offset:0 lds
buffer_load_dwordx4 v3, s[12:15], s36 offen offset:1024 lds
buffer_load_dwordx4 v4, s[12:15], s36 offen offset:2048 lds
buffer_load_dwordx4 v5, s[12:15], s36 offen offset:3072 lds
s_waitcnt vmcnt(16)
s_barrier
s_add_u32 s62, s62, 1
s_cmp_eq_u32 s62, 8
s_cselect_b32 s62, 2, s62
s_lshl_b32 s33, s62, 3
s_add_u32 s41, s33, s52
s_cmp_lg_u32 s31, 0
s_cbranch_scc1 L_Z6_A
s_buffer_load_dwordx2 s[72:73], s[24:27], s41 glc
L_Z6_A:
s_add_u32 m0, s40, 98304
s_lshl_b32 s35, s63, 13
s_add_u32 s35, s35, s38
s_add_u32 s35, s35, 4096
buffer_load_dwordx4 v6, s[24:27], s35 offen offset:0 lds
buffer_load_dwordx4 v7, s[24:27], s35 offen offset:1024 lds
s_add_u32 m0, m0, 2048
s_nop 0
buffer_load_dwordx4 v8, s[24:27], s35 offen offset:0 lds
buffer_load_dwordx4 v9, s[24:27], s35 offen offset:1024 lds
s_add_u32 m0, s40, 114688
s_lshl_b32 s36, s45, 8
s_add_u32 s36, s36, s39
s_add_u32 s36, s36, 128
buffer_load_dwordx4 v2, s[12:15], s36 offen offset:0 lds
buffer_load_dwordx4 v3, s[12:15], s36 offen offset:1024 lds
buffer_load_dwordx4 v4, s[12:15], s36 offen offset:2048 lds
buffer_load_dwordx4 v5, s[12:15], s36 offen offset:3072 lds
s_waitcnt lgkmcnt(0)
s_and_b32 s72, s72, s73
s_cbranch_scc0 L_Z6_W
L_Z6_X:
s_waitcnt vmcnt(16)
s_barrier
s_add_u32 s63, s63, 1
s_cmp_eq_u32 s63, 8
s_cselect_b32 s63, 2, s63
s_add_u32 m0, s40, 0
s_lshl_b32 s35, s63, 13
s_add_u32 s35, s35, s38
buffer_load_dwordx4 v6, s[24:27], s35 offen offset:0 lds
buffer_load_dwordx4 v7, s[24:27], s35 offen offset:1024 lds
s_add_u32 m0, m0, 2048
s_nop 0
buffer_load_dwordx4 v8, s[24:27], s35 offen offset:0 lds
buffer_load_dwordx4 v9, s[24:27], s35 offen offset:1024 lds
s_add_u32 s45, s45, 1
s_cmp_eq_u32 s45, 8
s_cselect_b32 s45, 2, s45
s_add_u32 m0, s40, 16384
s_lshl_b32 s36, s45, 8
s_add_u32 s36, s36, s39
buffer_load_dwordx4 v2, s[12:15], s36 offen offset:0 lds
buffer_load_dwordx4 v3, s[12:15], s36 offen offset:1024 lds
buffer_load_dwordx4 v4, s[12:15], s36 offen offset:2048 lds
buffer_load_dwordx4 v5, s[12:15], s36 offen offset:3072 lds
s_waitcnt vmcnt(16)
s_barrier
s_add_u32 s62, s62, 1
s_cmp_eq_u32 s62, 8
s_cselect_b32 s62, 2, s62
s_lshl_b32 s33, s62, 3
s_add_u32 s41, s33, s52
s_cmp_lg_u32 s31, 0
s_cbranch_scc1 L_Z7_A
s_buffer_load_dwordx2 s[72:73], s[24:27], s41 glc
L_Z7_A:
s_add_u32 m0, s40, 131072
s_lshl_b32 s35, s63, 13
s_add_u32 s35, s35, s38
s_add_u32 s35, s35, 4096
buffer_load_dwordx4 v6, s[24:27], s35 offen offset:0 lds
buffer_load_dwordx4 v7, s[24:27], s35 offen offset:1024 lds
s_add_u32 m0, m0, 2048
s_nop 0
buffer_load_dwordx4 v8, s[24:27], s35 offen offset:0 lds
buffer_load_dwordx4 v9, s[24:27], s35 offen offset:1024 lds
s_add_u32 m0, s40, 147456
s_lshl_b32 s36, s45, 8
s_add_u32 s36, s36, s39
s_add_u32 s36, s36, 128
buffer_load_dwordx4 v2, s[12:15], s36 offen offset:0 lds
buffer_load_dwordx4 v3, s[12:15], s36 offen offset:1024 lds
buffer_load_dwordx4 v4, s[12:15], s36 offen offset:2048 lds
buffer_load_dwordx4 v5, s[12:15], s36 offen offset:3072 lds
s_waitcnt lgkmcnt(0)
s_and_b32 s72, s72, s73
s_cbranch_scc0 L_Z7_W
L_Z7_X:
s_waitcnt vmcnt(16)
s_barrier
s_add_u32 s63, s63, 1
s_cmp_eq_u32 s63, 8
s_cselect_b32 s63, 2, s63
s_add_u32 m0, s40, 65536
s_lshl_b32 s35, s63, 13
s_add_u32 s35, s35, s38
buffer_load_dwordx4 v6, s[24:27], s35 offen offset:0 lds
buffer_load_dwordx4 v7, s[24:27], s35 offen offset:1024 lds
s_add_u32 m0, m0, 2048
s_nop 0
buffer_load_dwordx4 v8, s[24:27], s35 offen offset:0 lds
buffer_load_dwordx4 v9, s[24:27], s35 offen offset:1024 lds
s_add_u32 s45, s45, 1
s_cmp_eq_u32 s45, 8
s_cselect_b32 s45, 2, s45
s_add_u32 m0, s40, 81920
s_lshl_b32 s36, s45, 8
s_add_u32 s36, s36, s39
buffer_load_dwordx4 v2, s[12:15], s36 offen offset:0 lds
buffer_load_dwordx4 v3, s[12:15], s36 offen offset:1024 lds
buffer_load_dwordx4 v4, s[12:15], s36 offen offset:2048 lds
buffer_load_dwordx4 v5, s[12:15], s36 offen offset:3072 lds
s_mul_i32 s33, s31, 14
s_bfe_u32 s34, s46, 0x20002
s_lshl_b32 s34, s34, 1
s_and_b32 s35, s46, 1
s_add_u32 s34, s34, s35
s_lshl2_add_u32 s34, s34, s32
s_lshl_b32 s34, s34, 1
s_lshr_b32 s35, s46, 4
s_and_b32 s36, s46, 2
s_lshl2_add_u32 s35, s35, s36
s_or_b32 s35, s35, 1
v_min_u32 v176, 13, v1
v_add_u32 v176, s33, v176
v_lshrrev_b32 v177, 3, v176
v_lshl_add_u32 v177, v177, 6, s34
v_and_b32 v178, 2, v176
v_lshl_add_u32 v177, v178, 1, v177
v_and_b32 v178, 1, v176
v_add_u32 v177, v177, v178
v_bfe_u32 v178, v176, 2, 1
v_xor_b32 v178, s35, v178
v_cmp_le_u32 vcc, 224, v177
v_subrev_u32 v176, 224, v177
s_nop 0
v_cndmask_b32 v177, v177, v176, vcc
v_cndmask_b32 v179, 14, 7, vcc
v_cndmask_b32 v176, 1, 2, vcc
v_lshlrev_b32 v180, v176, v177
v_mul_u32_u24 v180, 9363, v180
v_lshrrev_b32 v180, 16, v180
v_lshlrev_b32 v177, 2, v177
v_mad_u32_u24 v191, v180, v179, v179
v_sub_u32 v191, v191, v177
v_min_u32 v191, 4, v191
v_sub_u32 v191, 4, v191
v_lshlrev_b32 v191, 8, v191
v_mul_u32_u24 v189, 1792, v179
v_mad_u32_u24 v178, v180, 7, v178
v_mad_u32_u24 v190, v178, v179, v177
v_lshrrev_b32 v176, 1, v176
v_lshl_add_u32 v190, v176, 13, v190
v_lshlrev_b32 v190, 8, v190
s_nop 0
s_waitcnt vmcnt(16)
s_barrier
s_add_u32 m0, s40, 98304
s_lshl_b32 s35, s63, 13
s_add_u32 s35, s35, s38
s_add_u32 s35, s35, 4096
buffer_load_dwordx4 v6, s[24:27], s35 offen offset:0 lds
buffer_load_dwordx4 v7, s[24:27], s35 offen offset:1024 lds
s_add_u32 m0, m0, 2048
s_nop 0
buffer_load_dwordx4 v8, s[24:27], s35 offen offset:0 lds
buffer_load_dwordx4 v9, s[24:27], s35 offen offset:1024 lds
s_add_u32 m0, s40, 114688
s_lshl_b32 s36, s45, 8
s_add_u32 s36, s36, s39
s_add_u32 s36, s36, 128
buffer_load_dwordx4 v2, s[12:15], s36 offen offset:0 lds
buffer_load_dwordx4 v3, s[12:15], s36 offen offset:1024 lds
buffer_load_dwordx4 v4, s[12:15], s36 offen offset:2048 lds
buffer_load_dwordx4 v5, s[12:15], s36 offen offset:3072 lds
s_and_b32 s43, s2, 6
s_lshl_b32 s43, s43, 7
s_add_u32 s43, s43, 15794176
v_lshlrev_b32 v13, 2, v1
buffer_load_dword v10, v13, s[24:27], s43 offen sc1
v_readlane_b32 s76, v191, 1
v_readlane_b32 s77, v189, 1
v_readlane_b32 s78, v190, 1
v_add_u32 v176, s76, v14
v_lshrrev_b32 v176, 10, v176
v_mad_u32_u24 v176, v176, s77, v14
v_add_u32 v176, s78, v176
v_readlane_b32 s76, v191, 2
v_readlane_b32 s77, v189, 2
v_readlane_b32 s78, v190, 2
v_add_u32 v177, s76, v14
v_lshrrev_b32 v177, 10, v177
v_mad_u32_u24 v177, v177, s77, v14
v_add_u32 v177, s78, v177
v_readlane_b32 s76, v191, 3
v_readlane_b32 s77, v189, 3
v_readlane_b32 s78, v190, 3
v_add_u32 v178, s76, v14
v_lshrrev_b32 v178, 10, v178
v_mad_u32_u24 v178, v178, s77, v14
v_add_u32 v178, s78, v178
v_readlane_b32 s76, v191, 4
v_readlane_b32 s77, v189, 4
v_readlane_b32 s78, v190, 4
v_add_u32 v179, s76, v14
v_lshrrev_b32 v179, 10, v179
v_mad_u32_u24 v179, v179, s77, v14
v_add_u32 v179, s78, v179
s_waitcnt vmcnt(17)
s_barrier
s_mul_i32 s35, s31, 200704
s_lshl_b32 s36, s31, 11
s_add_u32 s34, s51, 0
s_cmp_ge_u32 s34, 14
s_cselect_b32 s33, 14, 0
s_sub_u32 s34, s34, s33
s_mul_i32 s34, s34, 14336
s_add_u32 m0, s36, 57344
s_add_u32 s34, s34, s35
buffer_load_dwordx4 v11, s[20:23], s34 offen offset:0 lds
s_add_u32 s34, s34, 6144
buffer_load_dwordx4 v11, s[20:23], s34 offen offset:1024 lds
s_mul_i32 s35, s31, 6
s_and_b32 s36, s46, 0
s_mul_i32 s36, s36, 14
s_add_u32 s35, s35, s36
s_add_u32 s35, s35, 32
s_cmp_ge_u32 s35, 56
s_cselect_b32 s36, 56, 0
s_sub_u32 s35, s35, s36
s_mul_i32 s36, s31, 6144
s_add_u32 m0, s36, 32768
s_mul_i32 s34, s35, 7168
buffer_load_dwordx4 v11, s[16:19], s34 offen lds
s_add_u32 s35, s35, 1
s_cmp_eq_u32 s35, 56
s_cselect_b32 s35, 0, s35
s_add_u32 m0, s36, 33792
s_mul_i32 s34, s35, 7168
buffer_load_dwordx4 v11, s[16:19], s34 offen lds
s_add_u32 s35, s35, 1
s_cmp_eq_u32 s35, 56
s_cselect_b32 s35, 0, s35
s_add_u32 m0, s36, 34816
s_mul_i32 s34, s35, 7168
buffer_load_dwordx4 v11, s[16:19], s34 offen lds
s_add_u32 s35, s35, 1
s_cmp_eq_u32 s35, 56
s_cselect_b32 s35, 0, s35
s_add_u32 m0, s36, 35840
s_mul_i32 s34, s35, 7168
buffer_load_dwordx4 v11, s[16:19], s34 offen lds
s_add_u32 s35, s35, 1
s_cmp_eq_u32 s35, 56
s_cselect_b32 s35, 0, s35
s_add_u32 m0, s36, 36864
s_mul_i32 s34, s35, 7168
buffer_load_dwordx4 v11, s[16:19], s34 offen lds
s_add_u32 s35, s35, 1
s_cmp_eq_u32 s35, 56
s_cselect_b32 s35, 0, s35
s_add_u32 m0, s36, 37888
s_mul_i32 s34, s35, 7168
buffer_load_dwordx4 v11, s[16:19], s34 offen lds
v_readlane_b32 s76, v191, 5
v_readlane_b32 s77, v189, 5
v_readlane_b32 s78, v190, 5
v_add_u32 v180, s76, v14
v_lshrrev_b32 v180, 10, v180
v_mad_u32_u24 v180, v180, s77, v14
v_add_u32 v180, s78, v180
v_readlane_b32 s76, v191, 6
v_readlane_b32 s77, v189, 6
v_readlane_b32 s78, v190, 6
v_add_u32 v181, s76, v14
v_lshrrev_b32 v181, 10, v181
v_mad_u32_u24 v181, v181, s77, v14
v_add_u32 v181, s78, v181
v_readlane_b32 s76, v191, 7
v_readlane_b32 s77, v189, 7
v_readlane_b32 s78, v190, 7
v_add_u32 v182, s76, v14
v_lshrrev_b32 v182, 10, v182
v_mad_u32_u24 v182, v182, s77, v14
v_add_u32 v182, s78, v182
v_readlane_b32 s76, v191, 8
v_readlane_b32 s77, v189, 8
v_readlane_b32 s78, v190, 8
v_add_u32 v183, s76, v14
v_lshrrev_b32 v183, 10, v183
v_mad_u32_u24 v183, v183, s77, v14
v_add_u32 v183, s78, v183
s_waitcnt vmcnt(17)
s_barrier
s_mul_i32 s35, s31, 8
s_and_b32 s36, s46, 0
s_mul_i32 s36, s36, 14
s_add_u32 s35, s35, s36
s_add_u32 s35, s35, 0
s_cmp_ge_u32 s35, 56
s_cselect_b32 s36, 56, 0
s_sub_u32 s35, s35, s36
s_mul_i32 s36, s31, 8192
s_add_u32 m0, s36, 0
s_mul_i32 s34, s35, 7168
buffer_load_dwordx4 v11, s[16:19], s34 offen lds
s_add_u32 s35, s35, 1
s_cmp_eq_u32 s35, 56
s_cselect_b32 s35, 0, s35
s_add_u32 m0, s36, 1024
s_mul_i32 s34, s35, 7168
buffer_load_dwordx4 v11, s[16:19], s34 offen lds
s_add_u32 s35, s35, 1
s_cmp_eq_u32 s35, 56
s_cselect_b32 s35, 0, s35
s_add_u32 m0, s36, 2048
s_mul_i32 s34, s35, 7168
buffer_load_dwordx4 v11, s[16:19], s34 offen lds
s_add_u32 s35, s35, 1
s_cmp_eq_u32 s35, 56
s_cselect_b32 s35, 0, s35
s_add_u32 m0, s36, 3072
s_mul_i32 s34, s35, 7168
buffer_load_dwordx4 v11, s[16:19], s34 offen lds
s_add_u32 s35, s35, 1
s_cmp_eq_u32 s35, 56
s_cselect_b32 s35, 0, s35
s_add_u32 m0, s36, 4096
s_mul_i32 s34, s35, 7168
buffer_load_dwordx4 v11, s[16:19], s34 offen lds
s_add_u32 s35, s35, 1
s_cmp_eq_u32 s35, 56
s_cselect_b32 s35, 0, s35
s_add_u32 m0, s36, 5120
s_mul_i32 s34, s35, 7168
buffer_load_dwordx4 v11, s[16:19], s34 offen lds
s_add_u32 s35, s35, 1
s_cmp_eq_u32 s35, 56
s_cselect_b32 s35, 0, s35
s_add_u32 m0, s36, 6144
s_mul_i32 s34, s35, 7168
buffer_load_dwordx4 v11, s[16:19], s34 offen lds
s_add_u32 s35, s35, 1
s_cmp_eq_u32 s35, 56
s_cselect_b32 s35, 0, s35
s_add_u32 m0, s36, 7168
s_mul_i32 s34, s35, 7168
buffer_load_dwordx4 v11, s[16:19], s34 offen lds
v_readlane_b32 s76, v191, 9
v_readlane_b32 s77, v189, 9
v_readlane_b32 s78, v190, 9
v_add_u32 v184, s76, v14
v_lshrrev_b32 v184, 10, v184
v_mad_u32_u24 v184, v184, s77, v14
v_add_u32 v184, s78, v184
v_readlane_b32 s76, v191, 10
v_readlane_b32 s77, v189, 10
v_readlane_b32 s78, v190, 10
v_add_u32 v185, s76, v14
v_lshrrev_b32 v185, 10, v185
v_mad_u32_u24 v185, v185, s77, v14
v_add_u32 v185, s78, v185
v_readlane_b32 s76, v191, 11
v_readlane_b32 s77, v189, 11
v_readlane_b32 s78, v190, 11
v_add_u32 v186, s76, v14
v_lshrrev_b32 v186, 10, v186
v_mad_u32_u24 v186, v186, s77, v14
v_add_u32 v186, s78, v186
v_readlane_b32 s76, v191, 12
v_readlane_b32 s77, v189, 12
v_readlane_b32 s78, v190, 12
v_add_u32 v187, s76, v14
v_lshrrev_b32 v187, 10, v187
v_mad_u32_u24 v187, v187, s77, v14
v_add_u32 v187, s78, v187
s_waitcnt vmcnt(16)
L_4_R:
v_cmp_eq_u32 vcc, 0, v10
s_cbranch_vccnz L_4_W
L_4_X:
s_waitcnt vmcnt(14)
s_barrier
ds_read_b64_tr_b16 v[216:217], v246 offset:0
ds_read_b64_tr_b16 v[218:219], v246 offset:1024
ds_read_b64_tr_b16 v[220:221], v247 offset:0
ds_read_b64_tr_b16 v[222:223], v247 offset:1024
v_readlane_b32 s76, v191, 13
v_readlane_b32 s77, v189, 13
v_readlane_b32 s78, v190, 13
v_add_u32 v188, s76, v14
v_lshrrev_b32 v188, 10, v188
v_mad_u32_u24 v188, v188, s77, v14
v_add_u32 v188, s78, v188
v_readlane_b32 s76, v191, 0
v_readlane_b32 s77, v189, 0
v_readlane_b32 s78, v190, 0
v_add_u32 v189, s76, v14
v_lshrrev_b32 v189, 10, v189
v_mad_u32_u24 v189, v189, s77, v14
v_add_u32 v189, s78, v189
s_mov_b32 s12, s64
s_and_b32 s13, s65, 0xffff
s_mov_b32 s14, 1835008
s_mov_b32 s15, 0x20000
s_mov_b32 s4, s60
s_and_b32 s5, s61, 0xffff
s_mov_b32 s6, 1835008
s_mov_b32 s7, 0x20000
s_lshl_b32 s33, s46, 1
s_add_u32 s33, s33, s32
s_mul_i32 s48, s33, 28672
s_lshl_b32 s34, s29, 2
s_add_u32 s34, s34, s31
s_lshl_b32 s34, s34, 5
s_add_u32 s48, s48, s34
s_mul_i32 s33, s33, 147456
s_add_u32 s33, s33, 16777216
s_and_b32 s34, s46, 0
s_add_u32 s34, s34, s31
s_and_b32 s34, s34, 3
s_lshl_b32 s34, s34, 13
s_add_u32 s47, s33, s34
s_mul_i32 s34, s31, 14336
s_add_u32 s41, s33, s34
s_add_u32 s41, s41, 32768
v_and_b32 v250, 31, v1
v_mul_u32_u24 v250, 896, v250
v_lshrrev_b32 v251, 5, v1
v_lshl_add_u32 v250, v251, 4, v250
v_add_u32 v251, 57344, v14
s_mov_b32 s41, 8388608
s_waitcnt vmcnt(0)
s_cmp_lg_u32 s31, 0
s_cbranch_scc1 L_O_X
s_lshl_b32 s33, s46, 7
s_add_u32 s33, s33, 15777792
L_O_R:
s_buffer_load_dwordx16 s[64:79], s[24:27], s33 glc
s_waitcnt lgkmcnt(0)
s_and_b64 s[64:65], s[64:65], s[66:67]
s_and_b64 s[64:65], s[64:65], s[68:69]
s_and_b64 s[64:65], s[64:65], s[70:71]
s_and_b64 s[64:65], s[64:65], s[72:73]
s_and_b64 s[64:65], s[64:65], s[74:75]
s_and_b64 s[64:65], s[64:65], s[76:77]
s_and_b64 s[64:65], s[64:65], s[78:79]
s_and_b32 s64, s64, s65
s_cbranch_scc1 L_O_X

s_addk_i32 s53, -1
s_cmp_lt_i32 s53, 0
s_cbranch_scc0 L_O_R
L_O_X:
s_waitcnt lgkmcnt(0)
s_barrier
buffer_load_dwordx4 v[48:51], v14, s[24:27], s47 offen offset:0
buffer_load_dwordx4 v[52:55], v14, s[24:27], s47 offen offset:1024
buffer_load_dwordx4 v[56:59], v14, s[24:27], s47 offen offset:2048
buffer_load_dwordx4 v[60:63], v14, s[24:27], s47 offen offset:3072
s_add_u32 s47, s47, 4096
buffer_load_dwordx4 v[64:67], v14, s[24:27], s47 offen offset:0
buffer_load_dwordx4 v[68:71], v14, s[24:27], s47 offen offset:1024
buffer_load_dwordx4 v[72:75], v14, s[24:27], s47 offen offset:2048
buffer_load_dwordx4 v[76:79], v14, s[24:27], s47 offen offset:3072
ds_read_b64_tr_b16 v[80:81], v244 offset:0
ds_read_b64_tr_b16 v[82:83], v244 offset:1024
ds_read_b64_tr_b16 v[84:85], v245 offset:0
ds_read_b64_tr_b16 v[86:87], v245 offset:1024
ds_read_b64_tr_b16 v[88:89], v244 offset:2048
ds_read_b64_tr_b16 v[90:91], v244 offset:3072
ds_read_b64_tr_b16 v[92:93], v245 offset:2048
ds_read_b64_tr_b16 v[94:95], v245 offset:3072
ds_read_b64_tr_b16 v[96:97], v244 offset:3584
ds_read_b64_tr_b16 v[98:99], v244 offset:4608
ds_read_b64_tr_b16 v[100:101], v245 offset:3584
ds_read_b64_tr_b16 v[102:103], v245 offset:4608
ds_read_b64_tr_b16 v[104:105], v244 offset:5632
ds_read_b64_tr_b16 v[106:107], v244 offset:6656
ds_read_b64_tr_b16 v[108:109], v245 offset:5632
ds_read_b64_tr_b16 v[110:111], v245 offset:6656
ds_read_b64_tr_b16 v[112:113], v244 offset:7168
ds_read_b64_tr_b16 v[114:115], v244 offset:8192
ds_read_b64_tr_b16 v[116:117], v245 offset:7168
ds_read_b64_tr_b16 v[118:119], v245 offset:8192
ds_read_b64_tr_b16 v[120:121], v244 offset:9216
ds_read_b64_tr_b16 v[122:123], v244 offset:10240
ds_read_b64_tr_b16 v[124:125], v245 offset:9216
ds_read_b64_tr_b16 v[126:127], v245 offset:10240
ds_read_b64_tr_b16 v[128:129], v244 offset:10752
ds_read_b64_tr_b16 v[130:131], v244 offset:11776
ds_read_b64_tr_b16 v[132:133], v245 offset:10752
ds_read_b64_tr_b16 v[134:135], v245 offset:11776
ds_read_b64_tr_b16 v[136:137], v244 offset:12800
ds_read_b64_tr_b16 v[138:139], v244 offset:13824
ds_read_b64_tr_b16 v[140:141], v245 offset:12800
ds_read_b64_tr_b16 v[142:143], v245 offset:13824
s_mul_i32 s35, s31, 200704
s_lshl_b32 s36, s31, 11
s_add_u32 s34, s51, 1
s_cmp_ge_u32 s34, 14
s_cselect_b32 s33, 14, 0
s_sub_u32 s34, s34, s33
s_mul_i32 s34, s34, 14336
s_add_u32 m0, s36, 131072
s_add_u32 s34, s34, s35
buffer_load_dwordx4 v11, s[20:23], s34 offen offset:0 lds
s_add_u32 s34, s34, 6144
buffer_load_dwordx4 v11, s[20:23], s34 offen offset:1024 lds
s_add_u32 s34, s51, 2
s_cmp_ge_u32 s34, 14
s_cselect_b32 s33, 14, 0
s_sub_u32 s34, s34, s33
s_mul_i32 s34, s34, 14336
s_add_u32 m0, s36, 139264
s_add_u32 s34, s34, s35
buffer_load_dwordx4 v11, s[20:23], s34 offen offset:0 lds
s_add_u32 s34, s34, 6144
buffer_load_dwordx4 v11, s[20:23], s34 offen offset:1024 lds
s_add_u32 s34, s51, 3
s_cmp_ge_u32 s34, 14
s_cselect_b32 s33, 14, 0
s_sub_u32 s34, s34, s33
s_mul_i32 s34, s34, 14336
s_add_u32 m0, s36, 147456
s_add_u32 s34, s34, s35
buffer_load_dwordx4 v11, s[20:23], s34 offen offset:0 lds
s_add_u32 s34, s34, 6144
buffer_load_dwordx4 v11, s[20:23], s34 offen offset:1024 lds
s_add_u32 s34, s51, 4
s_cmp_ge_u32 s34, 14
s_cselect_b32 s33, 14, 0
s_sub_u32 s34, s34, s33
s_mul_i32 s34, s34, 14336
s_add_u32 m0, s36, 155648
s_add_u32 s34, s34, s35
buffer_load_dwordx4 v11, s[20:23], s34 offen offset:0 lds
s_add_u32 s34, s34, 6144
buffer_load_dwordx4 v11, s[20:23], s34 offen offset:1024 lds
s_mul_i32 s35, s31, 200704
s_lshl_b32 s36, s31, 11
s_add_u32 s34, s51, 5
s_cmp_ge_u32 s34, 14
s_cselect_b32 s33, 14, 0
s_sub_u32 s34, s34, s33
s_mul_i32 s34, s34, 14336
s_add_u32 m0, s36, 65536
s_add_u32 s34, s34, s35
buffer_load_dwordx4 v11, s[20:23], s34 offen offset:0 lds
s_add_u32 s34, s34, 6144
buffer_load_dwordx4 v11, s[20:23], s34 offen offset:1024 lds
s_add_u32 s34, s51, 6
s_cmp_ge_u32 s34, 14
s_cselect_b32 s33, 14, 0
s_sub_u32 s34, s34, s33
s_mul_i32 s34, s34, 14336
s_add_u32 m0, s36, 73728
s_add_u32 s34, s34, s35
buffer_load_dwordx4 v11, s[20:23], s34 offen offset:0 lds
s_add_u32 s34, s34, 6144
buffer_load_dwordx4 v11, s[20:23], s34 offen offset:1024 lds
s_add_u32 s34, s51, 7
s_cmp_ge_u32 s34, 14
s_cselect_b32 s33, 14, 0
s_sub_u32 s34, s34, s33
s_mul_i32 s34, s34, 14336
s_add_u32 m0, s36, 81920
s_add_u32 s34, s34, s35
buffer_load_dwordx4 v11, s[20:23], s34 offen offset:0 lds
s_add_u32 s34, s34, 6144
buffer_load_dwordx4 v11, s[20:23], s34 offen offset:1024 lds
s_add_u32 s34, s51, 8
s_cmp_ge_u32 s34, 14
s_cselect_b32 s33, 14, 0
s_sub_u32 s34, s34, s33
s_mul_i32 s34, s34, 14336
s_add_u32 m0, s36, 90112
s_add_u32 s34, s34, s35
buffer_load_dwordx4 v11, s[20:23], s34 offen offset:0 lds
s_add_u32 s34, s34, 6144
buffer_load_dwordx4 v11, s[20:23], s34 offen offset:1024 lds
s_mul_i32 s35, s31, 200704
s_lshl_b32 s36, s31, 11
s_add_u32 s34, s51, 13
s_cmp_ge_u32 s34, 14
s_cselect_b32 s33, 14, 0
s_sub_u32 s34, s34, s33
s_mul_i32 s34, s34, 14336
s_add_u32 m0, s36, 57344
s_add_u32 s34, s34, s35
buffer_load_dwordx4 v11, s[20:23], s34 offen offset:0 lds
s_add_u32 s34, s34, 6144
buffer_load_dwordx4 v11, s[20:23], s34 offen offset:1024 lds
s_waitcnt lgkmcnt(0)
s_waitcnt vmcnt(25)
v_mfma_f32_32x32x16_bf16 v[16:31], v[80:83], v[48:51], 0
v_mfma_f32_32x32x16_bf16 v[32:47], v[84:87], v[48:51], 0
s_waitcnt vmcnt(24)
v_mfma_f32_32x32x16_bf16 v[16:31], v[88:91], v[52:55], v[16:31]
v_mfma_f32_32x32x16_bf16 v[32:47], v[92:95], v[52:55], v[32:47]
s_waitcnt vmcnt(23)
v_mfma_f32_32x32x16_bf16 v[16:31], v[96:99], v[56:59], v[16:31]
v_mfma_f32_32x32x16_bf16 v[32:47], v[100:103], v[56:59], v[32:47]
s_waitcnt vmcnt(22)
v_mfma_f32_32x32x16_bf16 v[16:31], v[104:107], v[60:63], v[16:31]
v_mfma_f32_32x32x16_bf16 v[32:47], v[108:111], v[60:63], v[32:47]
s_waitcnt vmcnt(21)
v_mfma_f32_32x32x16_bf16 v[16:31], v[112:115], v[64:67], v[16:31]
v_mfma_f32_32x32x16_bf16 v[32:47], v[116:119], v[64:67], v[32:47]
s_waitcnt vmcnt(20)
v_mfma_f32_32x32x16_bf16 v[16:31], v[120:123], v[68:71], v[16:31]
v_mfma_f32_32x32x16_bf16 v[32:47], v[124:127], v[68:71], v[32:47]
s_waitcnt vmcnt(19)
v_mfma_f32_32x32x16_bf16 v[16:31], v[128:131], v[72:75], v[16:31]
v_mfma_f32_32x32x16_bf16 v[32:47], v[132:135], v[72:75], v[32:47]
s_waitcnt vmcnt(18)
v_mfma_f32_32x32x16_bf16 v[16:31], v[136:139], v[76:79], v[16:31]
v_mfma_f32_32x32x16_bf16 v[32:47], v[140:143], v[76:79], v[32:47]
s_mul_i32 s35, s31, 200704
s_lshl_b32 s36, s31, 11
s_add_u32 s34, s51, 9
s_cmp_ge_u32 s34, 14
s_cselect_b32 s33, 14, 0
s_sub_u32 s34, s34, s33
s_mul_i32 s34, s34, 14336
s_add_u32 m0, s36, 98304
s_add_u32 s34, s34, s35
buffer_load_dwordx4 v11, s[20:23], s34 offen offset:0 lds
s_add_u32 s34, s34, 6144
buffer_load_dwordx4 v11, s[20:23], s34 offen offset:1024 lds
s_add_u32 s34, s51, 10
s_cmp_ge_u32 s34, 14
s_cselect_b32 s33, 14, 0
s_sub_u32 s34, s34, s33
s_mul_i32 s34, s34, 14336
s_add_u32 m0, s36, 106496
s_add_u32 s34, s34, s35
buffer_load_dwordx4 v11, s[20:23], s34 offen offset:0 lds
s_add_u32 s34, s34, 6144
buffer_load_dwordx4 v11, s[20:23], s34 offen offset:1024 lds
s_add_u32 s34, s51, 11
s_cmp_ge_u32 s34, 14
s_cselect_b32 s33, 14, 0
s_sub_u32 s34, s34, s33
s_mul_i32 s34, s34, 14336
s_add_u32 m0, s36, 114688
s_add_u32 s34, s34, s35
buffer_load_dwordx4 v11, s[20:23], s34 offen offset:0 lds
s_add_u32 s34, s34, 6144
buffer_load_dwordx4 v11, s[20:23], s34 offen offset:1024 lds
s_add_u32 s34, s51, 12
s_cmp_ge_u32 s34, 14
s_cselect_b32 s33, 14, 0
s_sub_u32 s34, s34, s33
s_mul_i32 s34, s34, 14336
s_add_u32 m0, s36, 122880
s_add_u32 s34, s34, s35
buffer_load_dwordx4 v11, s[20:23], s34 offen offset:0 lds
s_add_u32 s34, s34, 6144
buffer_load_dwordx4 v11, s[20:23], s34 offen offset:1024 lds
s_branch P3_GO
P2_CMP:
v_mov_b32 v0, 1
v_lshlrev_b32 v2, 7, v1
s_waitcnt lgkmcnt(0)

s_barrier
ds_read_b128 v[248:251], v15 offset:0
s_waitcnt lgkmcnt(0)
v_add_f32 v248, v248, v249
v_add_f32 v250, v250, v251
v_add_f32 v248, v248, v250
v_and_b32 v249, 0xffff0000, v248
v_sub_f32 v248, v248, v249
v_cvt_pk_bf16_f32 v240, v249, v248
s_nop 1
v_mfma_f32_32x32x16_bf16 v[160:175], v[240:243], v[236:239], v[160:175]
v_rcp_f32 v229, v226
v_mul_f32 v228, v226, v226
v_mul_f32 v227, 0xc0135761, v226
v_mul_f32 v228, v228, v226
v_mul_f32 v228, 0xbdd2d3e8, v228
s_and_b32 s37, s2, 1
s_bfe_u32 s34, s2, 0x20003
s_and_b32 s33, s2, 7
s_lshl_b32 s46, s33, 2
s_add_u32 s46, s46, s34
s_lshr_b32 s29, s2, 5
s_mul_i32 s51, s34, 0
s_lshr_b32 s51, s51, 1
s_mul_i32 s33, s29, 0
s_add_u32 s51, s51, s33
s_cmp_ge_u32 s51, 14
s_cselect_b32 s33, 14, 0
s_sub_u32 s51, s51, s33
v_and_b32 v136, 31, v1
v_lshrrev_b32 v137, 5, v1
v_bfe_u32 v2, v1, 1, 3
v_xor_b32 v2, v2, v137
v_lshlrev_b32 v2, 4, v2
v_lshl_add_u32 v2, v136, 7, v2
s_lshr_b32 s34, s31, 1
s_lshl_b32 s36, s34, 13
s_add_u32 s36, s36, 16384
v_add_u32 v4, s36, v2
v_xor_b32 v5, 32, v4
v_xor_b32 v6, 64, v4
v_xor_b32 v7, 96, v4
v_lshlrev_b32 v233, 1, v136
v_bfe_u32 v2, v1, 4, 1
v_lshlrev_b32 v2, 1, v2
v_and_b32 v136, 1, v1
v_add_u32 v2, v2, v136
v_mul_u32_u24 v2, 576, v2
v_lshlrev_b32 v137, 7, v137
v_xor_b32 v2, v2, v137
v_bfe_u32 v136, v1, 2, 2
v_lshl_add_u32 v2, v136, 4, v2
v_bfe_u32 v136, v1, 1, 1
v_lshl_add_u32 v2, v136, 3, v2
s_and_b32 s33, s31, 1
s_lshl_b32 s36, s33, 12
v_add_u32 v2, s36, v2
v_xor_b32 v3, 64, v2
s_lshl_b32 s35, s28, 1
s_add_u32 s35, s35, s34
s_lshl_b32 s39, s35, 7
s_lshl_b32 s36, s29, 1
s_add_u32 s36, s36, s37
s_lshl_b32 s36, s36, 1
s_add_u32 s36, s36, s33
s_lshl_b32 s36, s36, 11
s_mul_i32 s42, s35, 294912
s_add_u32 s38, s42, s36
s_add_u32 s38, s38, 16809984
s_xor_b32 s36, s36, 4096
s_add_u32 s42, s42, s36
s_add_u32 s42, s42, 16867328
s_lshl_b32 s40, s35, 2
s_lshr_b32 s36, s29, 1
s_add_u32 s40, s40, s36
s_lshl_b32 s40, s40, 3
s_and_b32 s36, s29, 1
s_add_u32 s40, s40, s36
s_lshl_b32 s40, s40, 1
s_add_u32 s40, s40, s37
s_lshl_b32 s40, s40, 1
s_add_u32 s40, s40, s33
s_lshl_b32 s40, s40, 2
s_add_u32 s40, s40, 15761408
s_mov_b32 s44, -1
s_mov_b32 s45, 0
s_mov_b32 s20, s76
s_and_b32 s21, s77, 0xffff
s_mov_b32 s22, 4096
s_mov_b32 s23, 0x20000
v_add_u32 v128, 0x20000, v2
v_add_u32 v129, 0x20000, v3
v_add_u32 v130, 0x20000, v4
v_add_u32 v131, 0x20000, v5
v_add_u32 v132, 0x20000, v6
v_add_u32 v133, 0x20000, v7
v_add_u32 v8, 0x10000, v2
v_add_u32 v9, 0x10000, v3
v_add_u32 v10, 0x10000, v4
v_add_u32 v11, 0x10000, v5
v_add_u32 v12, 0x10000, v6
v_add_u32 v13, 0x10000, v7
v_mov_b32 v234, 0
v_mov_b32 v235, 0
v_mov_b32 v236, 0
v_mov_b32 v240, 0x3f803f80
v_mov_b32 v241, 0x3f803f80
v_mov_b32 v242, 0x3f803f80
v_mov_b32 v243, 0x3f803f80
s_mul_i32 s63, s28, 7
s_add_u32 s63, s63, s29
s_lshl_b32 s63, s63, 2
s_add_u32 s63, s63, s31
s_lshl_b32 s42, s37, 9
s_add_u32 s63, s63, s42
s_lshl_b32 s63, s63, 12
s_add_u32 s63, s63, 8388608
s_xor_b32 s42, s63, 2097152
s_mov_b32 s70, 1.0
s_mov_b32 s71, 0x1f800000
s_mov_b32 s72, 0x5f800000
s_lshr_b32 s73, s2, 3
s_sub_u32 s74, s73, 14
s_cselect_b32 s73, s73, s74
s_cselect_b32 s74, 9, 8
s_cselect_b32 s52, 0, 2097152
s_or_b32 s52, s52, 8388608
s_lshl_b32 s73, s73, 2
s_add_u32 s73, s73, s31
s_lshl_b32 s73, s73, 12
s_lshl_b32 s75, 7, s74
s_and_b32 s42, s2, 7
s_xor_b32 s63, s42, 1
s_mul_i32 s42, s42, s75
s_mul_i32 s63, s63, s75
s_add_u32 s42, s42, s52
s_add_u32 s63, s63, s52
s_mul_i32 s75, s75, 7
v_bfe_u32 v136, v1, 2, 2
v_lshrrev_b32 v137, 5, v1
v_lshl_add_u32 v136, v137, 2, v136
v_lshlrev_b32 v244, 7, v136
v_and_b32 v136, 3, v1
v_lshl_add_u32 v244, v136, 3, v244
v_and_b32 v136, 16, v1
v_lshl_add_u32 v244, v136, 1, v244
v_and_b32 v136, 8, v1
v_lshl_add_u32 v244, v136, 3, v244
s_lshl_b32 s33, s31, 5
v_xor_b32 v244, s33, v244
s_lshl_b32 s33, s31, 11
s_add_u32 s33, s33, 57344
v_add_u32 v246, s33, v244
s_mul_i32 s33, s31, 14336
v_add_u32 v244, s33, v244
v_xor_b32 v245, 64, v244
v_xor_b32 v247, 64, v246
v_add_u32 v248, 0x10000, v246
v_add_u32 v249, 0x10000, v247
v_lshlrev_b32 v136, 7, v1
s_setprio 3
s_waitcnt vmcnt(0)
s_barrier
ds_read_b64_tr_b16 v[112:113], v2 offset:0
ds_read_b64_tr_b16 v[114:115], v3 offset:0
ds_read_b128 v[120:123], v4 offset:0
ds_read_b64_tr_b16 v[116:117], v2 offset:2048
ds_read_b64_tr_b16 v[118:119], v3 offset:2048
ds_read_b128 v[124:127], v4 offset:4096
ds_read_b64_tr_b16 v[80:81], v2 offset:256
ds_read_b64_tr_b16 v[82:83], v3 offset:256
ds_read_b128 v[88:91], v5 offset:0
ds_read_b64_tr_b16 v[84:85], v2 offset:2304
ds_read_b64_tr_b16 v[86:87], v3 offset:2304
ds_read_b128 v[92:95], v5 offset:4096
s_cmp_eq_u32 s31, 0
s_cselect_b64 exec, 15, 0
buffer_store_dword v0, v136, s[24:27], s9 offen offset:0 sc1
s_mov_b64 exec, -1
s_cmp_eq_u32 s31, 0
s_cselect_b64 exec, 255, 0
buffer_store_dword v0, v136, s[24:27], s11 offen offset:0 sc1
s_mov_b64 exec, -1
s_waitcnt lgkmcnt(6)
v_mfma_f32_32x32x16_bf16 v[16:31], v[112:115], v[120:123], 0
ds_read_b64_tr_b16 v[96:97], v2 offset:8192
ds_read_b64_tr_b16 v[98:99], v3 offset:8192
v_mul_f32 v196, v160, v160
v_mul_f32 v197, v161, v161
v_mul_f32 v198, v162, v162
v_mul_f32 v199, v163, v163
v_mul_f32 v200, v164, v164
v_mfma_f32_32x32x16_bf16 v[48:63], v[116:119], v[120:123], 0
ds_read_b128 v[104:107], v6 offset:0
ds_read_b64_tr_b16 v[100:101], v2 offset:10240
v_mul_f32 v201, v165, v165
v_mul_f32 v202, v166, v166
v_mul_f32 v203, v167, v167
v_fma_f32 v196, v196, v228, v227
v_fma_f32 v197, v197, v228, v227
v_mfma_f32_32x32x16_bf16 v[32:47], v[112:115], v[124:127], 0
ds_read_b64_tr_b16 v[102:103], v3 offset:10240
ds_read_b128 v[108:111], v6 offset:4096
v_fma_f32 v198, v198, v228, v227
v_fma_f32 v199, v199, v228, v227
v_fma_f32 v200, v200, v228, v227
v_fma_f32 v201, v201, v228, v227
v_fma_f32 v202, v202, v228, v227
v_mfma_f32_32x32x16_bf16 v[64:79], v[116:119], v[124:127], 0
v_fma_f32 v203, v203, v228, v227
v_mul_f32 v196, v196, v160
v_mul_f32 v197, v197, v161
v_mul_f32 v198, v198, v162
v_mul_f32 v199, v199, v163
s_waitcnt lgkmcnt(6)
v_mfma_f32_32x32x16_bf16 v[16:31], v[80:83], v[88:91], v[16:31]
ds_read_b64_tr_b16 v[112:113], v2 offset:8448
ds_read_b64_tr_b16 v[114:115], v3 offset:8448
v_mul_f32 v200, v200, v164
v_mul_f32 v201, v201, v165
v_mul_f32 v202, v202, v166
v_mul_f32 v203, v203, v167
v_exp_f32 v196, v196
v_mfma_f32_32x32x16_bf16 v[48:63], v[84:87], v[88:91], v[48:63]
ds_read_b128 v[120:123], v7 offset:0
ds_read_b64_tr_b16 v[116:117], v2 offset:10496
v_exp_f32 v197, v197
v_exp_f32 v198, v198
v_exp_f32 v199, v199
v_exp_f32 v200, v200
v_exp_f32 v201, v201
v_mfma_f32_32x32x16_bf16 v[32:47], v[80:83], v[92:95], v[32:47]
ds_read_b64_tr_b16 v[118:119], v3 offset:10496
ds_read_b128 v[124:127], v7 offset:4096
v_exp_f32 v202, v202
v_exp_f32 v203, v203
v_fma_f32 v196, v196, v229, v229
v_fma_f32 v197, v197, v229, v229
v_fma_f32 v198, v198, v229, v229
v_mfma_f32_32x32x16_bf16 v[64:79], v[84:87], v[92:95], v[64:79]
v_fma_f32 v199, v199, v229, v229
v_fma_f32 v200, v200, v229, v229
v_fma_f32 v201, v201, v229, v229
v_fma_f32 v202, v202, v229, v229
v_fma_f32 v203, v203, v229, v229
s_waitcnt lgkmcnt(0)
s_barrier
v_mfma_f32_32x32x16_bf16 v[16:31], v[96:99], v[104:107], v[16:31]
ds_read_b64_tr_b16 v[80:81], v128 offset:0
ds_read_b64_tr_b16 v[82:83], v129 offset:0
v_rcp_f32 v196, v196
v_rcp_f32 v197, v197
v_rcp_f32 v198, v198
v_rcp_f32 v199, v199
v_rcp_f32 v200, v200
v_mfma_f32_32x32x16_bf16 v[48:63], v[100:103], v[104:107], v[48:63]
ds_read_b128 v[88:91], v130 offset:0
ds_read_b64_tr_b16 v[84:85], v128 offset:2048
v_rcp_f32 v201, v201
v_rcp_f32 v202, v202
v_rcp_f32 v203, v203
v_mul_f32 v160, v196, v160
v_mul_f32 v161, v197, v161
v_mfma_f32_32x32x16_bf16 v[32:47], v[96:99], v[108:111], v[32:47]
ds_read_b64_tr_b16 v[86:87], v129 offset:2048
ds_read_b128 v[92:95], v130 offset:4096
v_mul_f32 v162, v198, v162
v_mul_f32 v163, v199, v163
v_mul_f32 v164, v200, v164
v_mul_f32 v165, v201, v165
v_mul_f32 v166, v202, v166
v_mfma_f32_32x32x16_bf16 v[64:79], v[100:103], v[108:111], v[64:79]
v_mul_f32 v167, v203, v167
v_mul_f32 v204, v168, v168
v_mul_f32 v205, v169, v169
v_mul_f32 v206, v170, v170
v_mul_f32 v207, v171, v171
v_mfma_f32_32x32x16_bf16 v[16:31], v[112:115], v[120:123], v[16:31]
ds_read_b64_tr_b16 v[96:97], v128 offset:256
ds_read_b64_tr_b16 v[98:99], v129 offset:256
v_mul_f32 v208, v172, v172
v_mul_f32 v209, v173, v173
v_mul_f32 v210, v174, v174
v_mul_f32 v211, v175, v175
v_fma_f32 v204, v204, v228, v227
v_mfma_f32_32x32x16_bf16 v[48:63], v[116:119], v[120:123], v[48:63]
ds_read_b128 v[104:107], v131 offset:0
ds_read_b64_tr_b16 v[100:101], v128 offset:2304
v_fma_f32 v205, v205, v228, v227
v_fma_f32 v206, v206, v228, v227
v_fma_f32 v207, v207, v228, v227
v_fma_f32 v208, v208, v228, v227
v_fma_f32 v209, v209, v228, v227
v_mfma_f32_32x32x16_bf16 v[32:47], v[112:115], v[124:127], v[32:47]
ds_read_b64_tr_b16 v[102:103], v129 offset:2304
ds_read_b128 v[108:111], v131 offset:4096
v_fma_f32 v210, v210, v228, v227
v_fma_f32 v211, v211, v228, v227
v_mul_f32 v204, v204, v168
v_mul_f32 v205, v205, v169
v_mul_f32 v206, v206, v170
v_mfma_f32_32x32x16_bf16 v[64:79], v[116:119], v[124:127], v[64:79]
v_mul_f32 v207, v207, v171
v_mul_f32 v208, v208, v172
v_mul_f32 v209, v209, v173
v_mul_f32 v210, v210, v174
v_mul_f32 v211, v211, v175
s_waitcnt lgkmcnt(6)
v_mfma_f32_32x32x16_bf16 v[16:31], v[80:83], v[88:91], v[16:31]
ds_read_b64_tr_b16 v[112:113], v128 offset:8192
ds_read_b64_tr_b16 v[114:115], v129 offset:8192
v_exp_f32 v204, v204
v_exp_f32 v205, v205
v_exp_f32 v206, v206
v_exp_f32 v207, v207
v_exp_f32 v208, v208
v_mfma_f32_32x32x16_bf16 v[48:63], v[84:87], v[88:91], v[48:63]
ds_read_b128 v[120:123], v132 offset:0
ds_read_b64_tr_b16 v[116:117], v128 offset:10240
v_exp_f32 v209, v209
v_exp_f32 v210, v210
v_exp_f32 v211, v211
v_fma_f32 v204, v204, v229, v229
v_fma_f32 v205, v205, v229, v229
v_mfma_f32_32x32x16_bf16 v[32:47], v[80:83], v[92:95], v[32:47]
ds_read_b64_tr_b16 v[118:119], v129 offset:10240
ds_read_b128 v[124:127], v132 offset:4096
v_fma_f32 v206, v206, v229, v229
v_fma_f32 v207, v207, v229, v229
v_fma_f32 v208, v208, v229, v229
v_fma_f32 v209, v209, v229, v229
v_fma_f32 v210, v210, v229, v229
v_mfma_f32_32x32x16_bf16 v[64:79], v[84:87], v[92:95], v[64:79]
v_fma_f32 v211, v211, v229, v229
v_rcp_f32 v204, v204
v_rcp_f32 v205, v205
v_rcp_f32 v206, v206
v_rcp_f32 v207, v207
s_waitcnt lgkmcnt(6)
v_mfma_f32_32x32x16_bf16 v[16:31], v[96:99], v[104:107], v[16:31]
ds_read_b64_tr_b16 v[80:81], v128 offset:8448
ds_read_b64_tr_b16 v[82:83], v129 offset:8448
v_rcp_f32 v208, v208
v_rcp_f32 v209, v209
v_rcp_f32 v210, v210
v_rcp_f32 v211, v211
v_mul_f32 v168, v204, v168
v_mfma_f32_32x32x16_bf16 v[48:63], v[100:103], v[104:107], v[48:63]
ds_read_b128 v[88:91], v133 offset:0
ds_read_b64_tr_b16 v[84:85], v128 offset:10496
v_mul_f32 v169, v205, v169
v_mul_f32 v170, v206, v170
v_mul_f32 v171, v207, v171
v_mul_f32 v172, v208, v172
v_mul_f32 v173, v209, v173
v_mfma_f32_32x32x16_bf16 v[32:47], v[96:99], v[108:111], v[32:47]
ds_read_b64_tr_b16 v[86:87], v129 offset:10496
ds_read_b128 v[92:95], v133 offset:4096
v_mul_f32 v174, v210, v174
v_mul_f32 v175, v211, v175
v_cvt_pk_bf16_f32 v212, v160, v161
v_cvt_pk_bf16_f32 v213, v162, v163
v_cvt_pk_bf16_f32 v214, v164, v165
v_mfma_f32_32x32x16_bf16 v[64:79], v[100:103], v[108:111], v[64:79]
v_cvt_pk_bf16_f32 v215, v166, v167
v_cvt_pk_bf16_f32 v216, v168, v169
v_cvt_pk_bf16_f32 v217, v170, v171
v_cvt_pk_bf16_f32 v218, v172, v173
v_cvt_pk_bf16_f32 v219, v174, v175
s_waitcnt lgkmcnt(0)
s_barrier
s_lshl_b32 s33, s31, 12
v_add_u32 v137, s33, v14
ds_write_b128 v137, v[212:215] offset:34816
ds_write_b128 v137, v[216:219] offset:35840
v_mfma_f32_32x32x16_bf16 v[16:31], v[112:115], v[120:123], v[16:31]
ds_read_b64_tr_b16 v[96:97], v8 offset:0
ds_read_b64_tr_b16 v[98:99], v9 offset:0
v_mfma_f32_32x32x16_bf16 v[48:63], v[116:119], v[120:123], v[48:63]
ds_read_b128 v[104:107], v10 offset:0
ds_read_b64_tr_b16 v[100:101], v8 offset:2048
v_mfma_f32_32x32x16_bf16 v[32:47], v[112:115], v[124:127], v[32:47]
ds_read_b64_tr_b16 v[102:103], v9 offset:2048
ds_read_b128 v[108:111], v10 offset:4096
v_mfma_f32_32x32x16_bf16 v[64:79], v[116:119], v[124:127], v[64:79]
v_mfma_f32_32x32x16_bf16 v[16:31], v[80:83], v[88:91], v[16:31]
ds_read_b64_tr_b16 v[112:113], v8 offset:256
ds_read_b64_tr_b16 v[114:115], v9 offset:256
v_mfma_f32_32x32x16_bf16 v[48:63], v[84:87], v[88:91], v[48:63]
ds_read_b128 v[120:123], v11 offset:0
ds_read_b64_tr_b16 v[116:117], v8 offset:2304
v_mfma_f32_32x32x16_bf16 v[32:47], v[80:83], v[92:95], v[32:47]
ds_read_b64_tr_b16 v[118:119], v9 offset:2304
ds_read_b128 v[124:127], v11 offset:4096
v_mfma_f32_32x32x16_bf16 v[64:79], v[84:87], v[92:95], v[64:79]
s_waitcnt lgkmcnt(6)
v_mfma_f32_32x32x16_bf16 v[16:31], v[96:99], v[104:107], v[16:31]
ds_read_b64_tr_b16 v[80:81], v8 offset:8192
ds_read_b64_tr_b16 v[82:83], v9 offset:8192
v_mfma_f32_32x32x16_bf16 v[48:63], v[100:103], v[104:107], v[48:63]
ds_read_b128 v[88:91], v12 offset:0
ds_read_b64_tr_b16 v[84:85], v8 offset:10240
v_mfma_f32_32x32x16_bf16 v[32:47], v[96:99], v[108:111], v[32:47]
ds_read_b64_tr_b16 v[86:87], v9 offset:10240
ds_read_b128 v[92:95], v12 offset:4096
v_mfma_f32_32x32x16_bf16 v[64:79], v[100:103], v[108:111], v[64:79]
s_waitcnt lgkmcnt(6)
v_mfma_f32_32x32x16_bf16 v[16:31], v[112:115], v[120:123], v[16:31]
ds_read_b64_tr_b16 v[96:97], v8 offset:8448
ds_read_b64_tr_b16 v[98:99], v9 offset:8448
v_mfma_f32_32x32x16_bf16 v[48:63], v[116:119], v[120:123], v[48:63]
ds_read_b128 v[104:107], v13 offset:0
ds_read_b64_tr_b16 v[100:101], v8 offset:10496
v_mfma_f32_32x32x16_bf16 v[32:47], v[112:115], v[124:127], v[32:47]
ds_read_b64_tr_b16 v[102:103], v9 offset:10496
ds_read_b128 v[108:111], v13 offset:4096
v_mfma_f32_32x32x16_bf16 v[64:79], v[116:119], v[124:127], v[64:79]
s_waitcnt lgkmcnt(0)
s_barrier
s_and_b32 s33, s31, 2
s_lshl_b32 s33, s33, 12
s_and_b32 s34, s31, 1
s_lshl_b32 s34, s34, 11
s_add_u32 s33, s33, s34
v_add_u32 v137, s33, v14
ds_read_b128 v[148:151], v137 offset:32768
ds_read_b128 v[156:159], v137 offset:33792
ds_read_b128 v[164:167], v137 offset:36864
ds_read_b128 v[172:175], v137 offset:37888
v_mfma_f32_32x32x16_bf16 v[16:31], v[80:83], v[88:91], v[16:31]
ds_read_b64_tr_b16 v[112:113], v8 offset:32768
ds_read_b64_tr_b16 v[114:115], v9 offset:32768
v_mfma_f32_32x32x16_bf16 v[48:63], v[84:87], v[88:91], v[48:63]
ds_read_b128 v[120:123], v10 offset:32768
ds_read_b64_tr_b16 v[116:117], v8 offset:34816
v_mfma_f32_32x32x16_bf16 v[32:47], v[80:83], v[92:95], v[32:47]
ds_read_b64_tr_b16 v[118:119], v9 offset:34816
ds_read_b128 v[124:127], v10 offset:36864
v_mfma_f32_32x32x16_bf16 v[64:79], v[84:87], v[92:95], v[64:79]
v_mfma_f32_32x32x16_bf16 v[16:31], v[96:99], v[104:107], v[16:31]
ds_read_b64_tr_b16 v[80:81], v8 offset:33024
ds_read_b64_tr_b16 v[82:83], v9 offset:33024
v_mfma_f32_32x32x16_bf16 v[48:63], v[100:103], v[104:107], v[48:63]
ds_read_b128 v[88:91], v11 offset:32768
ds_read_b64_tr_b16 v[84:85], v8 offset:35072
v_mfma_f32_32x32x16_bf16 v[32:47], v[96:99], v[108:111], v[32:47]
ds_read_b64_tr_b16 v[86:87], v9 offset:35072
ds_read_b128 v[92:95], v11 offset:36864
v_mfma_f32_32x32x16_bf16 v[64:79], v[100:103], v[108:111], v[64:79]
s_waitcnt lgkmcnt(6)
v_mfma_f32_32x32x16_bf16 v[16:31], v[112:115], v[120:123], v[16:31]
ds_read_b64_tr_b16 v[96:97], v8 offset:40960
ds_read_b64_tr_b16 v[98:99], v9 offset:40960
v_lshlrev_b32 v144, 16, v148
v_mfma_f32_32x32x16_bf16 v[48:63], v[116:119], v[120:123], v[48:63]
ds_read_b128 v[104:107], v12 offset:32768
ds_read_b64_tr_b16 v[100:101], v8 offset:43008
v_and_b32 v145, 0xffff0000, v148
v_mfma_f32_32x32x16_bf16 v[32:47], v[112:115], v[124:127], v[32:47]
ds_read_b64_tr_b16 v[102:103], v9 offset:43008
ds_read_b128 v[108:111], v12 offset:36864
v_lshlrev_b32 v146, 16, v149
v_mfma_f32_32x32x16_bf16 v[64:79], v[116:119], v[124:127], v[64:79]
v_and_b32 v147, 0xffff0000, v149
buffer_load_ushort v232, v233, s[20:23], s39 offen
buffer_load_ushort v237, v233, s[20:23], s39 offen offset:64
s_waitcnt lgkmcnt(6)
v_mfma_f32_32x32x16_bf16 v[16:31], v[80:83], v[88:91], v[16:31]
ds_read_b64_tr_b16 v[112:113], v8 offset:41216
ds_read_b64_tr_b16 v[114:115], v9 offset:41216
v_lshlrev_b32 v148, 16, v150
v_mfma_f32_32x32x16_bf16 v[48:63], v[84:87], v[88:91], v[48:63]
ds_read_b128 v[120:123], v13 offset:32768
ds_read_b64_tr_b16 v[116:117], v8 offset:43264
v_and_b32 v149, 0xffff0000, v150
v_mfma_f32_32x32x16_bf16 v[32:47], v[80:83], v[92:95], v[32:47]
ds_read_b64_tr_b16 v[118:119], v9 offset:43264
ds_read_b128 v[124:127], v13 offset:36864
v_lshlrev_b32 v150, 16, v151
v_mfma_f32_32x32x16_bf16 v[64:79], v[84:87], v[92:95], v[64:79]
v_and_b32 v151, 0xffff0000, v151
s_waitcnt lgkmcnt(0)
s_barrier
v_mfma_f32_32x32x16_bf16 v[16:31], v[96:99], v[104:107], v[16:31]
ds_read_b64_tr_b16 v[80:81], v2 offset:0
ds_read_b64_tr_b16 v[82:83], v3 offset:0
v_lshlrev_b32 v152, 16, v156
v_mfma_f32_32x32x16_bf16 v[48:63], v[100:103], v[104:107], v[48:63]
ds_read_b128 v[88:91], v4 offset:0
ds_read_b64_tr_b16 v[84:85], v2 offset:2048
v_and_b32 v153, 0xffff0000, v156
v_mfma_f32_32x32x16_bf16 v[32:47], v[96:99], v[108:111], v[32:47]
ds_read_b64_tr_b16 v[86:87], v3 offset:2048
ds_read_b128 v[92:95], v4 offset:4096
v_lshlrev_b32 v154, 16, v157
v_mfma_f32_32x32x16_bf16 v[64:79], v[100:103], v[108:111], v[64:79]
v_and_b32 v155, 0xffff0000, v157
v_mfma_f32_32x32x16_bf16 v[16:31], v[112:115], v[120:123], v[16:31]
ds_read_b64_tr_b16 v[96:97], v2 offset:256
ds_read_b64_tr_b16 v[98:99], v3 offset:256
v_lshlrev_b32 v156, 16, v158
v_mfma_f32_32x32x16_bf16 v[48:63], v[116:119], v[120:123], v[48:63]
ds_read_b128 v[104:107], v5 offset:0
ds_read_b64_tr_b16 v[100:101], v2 offset:2304
v_and_b32 v157, 0xffff0000, v158
v_mfma_f32_32x32x16_bf16 v[32:47], v[112:115], v[124:127], v[32:47]
ds_read_b64_tr_b16 v[102:103], v3 offset:2304
ds_read_b128 v[108:111], v5 offset:4096
v_lshlrev_b32 v158, 16, v159
v_mfma_f32_32x32x16_bf16 v[64:79], v[116:119], v[124:127], v[64:79]
v_and_b32 v159, 0xffff0000, v159
s_waitcnt lgkmcnt(6)
v_mfma_f32_32x32x16_bf16 v[16:31], v[80:83], v[88:91], v[16:31]
ds_read_b64_tr_b16 v[112:113], v2 offset:8192
ds_read_b64_tr_b16 v[114:115], v3 offset:8192
v_lshlrev_b32 v160, 16, v164
v_mfma_f32_32x32x16_bf16 v[48:63], v[84:87], v[88:91], v[48:63]
ds_read_b128 v[120:123], v6 offset:0
ds_read_b64_tr_b16 v[116:117], v2 offset:10240
v_and_b32 v161, 0xffff0000, v164
v_mfma_f32_32x32x16_bf16 v[32:47], v[80:83], v[92:95], v[32:47]
ds_read_b64_tr_b16 v[118:119], v3 offset:10240
ds_read_b128 v[124:127], v6 offset:4096
v_lshlrev_b32 v162, 16, v165
v_mfma_f32_32x32x16_bf16 v[64:79], v[84:87], v[92:95], v[64:79]
v_and_b32 v163, 0xffff0000, v165
s_waitcnt lgkmcnt(6)
v_mfma_f32_32x32x16_bf16 v[16:31], v[96:99], v[104:107], v[16:31]
ds_read_b64_tr_b16 v[80:81], v2 offset:8448
ds_read_b64_tr_b16 v[82:83], v3 offset:8448
v_lshlrev_b32 v164, 16, v166
v_mfma_f32_32x32x16_bf16 v[48:63], v[100:103], v[104:107], v[48:63]
ds_read_b128 v[88:91], v7 offset:0
ds_read_b64_tr_b16 v[84:85], v2 offset:10496
v_and_b32 v165, 0xffff0000, v166
v_mfma_f32_32x32x16_bf16 v[32:47], v[96:99], v[108:111], v[32:47]
ds_read_b64_tr_b16 v[86:87], v3 offset:10496
ds_read_b128 v[92:95], v7 offset:4096
v_lshlrev_b32 v166, 16, v167
v_mfma_f32_32x32x16_bf16 v[64:79], v[100:103], v[108:111], v[64:79]
v_and_b32 v167, 0xffff0000, v167
s_waitcnt lgkmcnt(0)
s_barrier
v_mfma_f32_32x32x16_bf16 v[16:31], v[112:115], v[120:123], v[16:31]
ds_read_b64_tr_b16 v[96:97], v128 offset:0
ds_read_b64_tr_b16 v[98:99], v129 offset:0
v_lshlrev_b32 v168, 16, v172
v_mfma_f32_32x32x16_bf16 v[48:63], v[116:119], v[120:123], v[48:63]
ds_read_b128 v[104:107], v130 offset:0
ds_read_b64_tr_b16 v[100:101], v128 offset:2048
v_and_b32 v169, 0xffff0000, v172
v_mfma_f32_32x32x16_bf16 v[32:47], v[112:115], v[124:127], v[32:47]
ds_read_b64_tr_b16 v[102:103], v129 offset:2048
ds_read_b128 v[108:111], v130 offset:4096
v_lshlrev_b32 v170, 16, v173
v_mfma_f32_32x32x16_bf16 v[64:79], v[116:119], v[124:127], v[64:79]
v_and_b32 v171, 0xffff0000, v173
v_mfma_f32_32x32x16_bf16 v[16:31], v[80:83], v[88:91], v[16:31]
ds_read_b64_tr_b16 v[112:113], v128 offset:256
ds_read_b64_tr_b16 v[114:115], v129 offset:256
v_lshlrev_b32 v172, 16, v174
v_mfma_f32_32x32x16_bf16 v[48:63], v[84:87], v[88:91], v[48:63]
ds_read_b128 v[120:123], v131 offset:0
ds_read_b64_tr_b16 v[116:117], v128 offset:2304
v_and_b32 v173, 0xffff0000, v174
v_mfma_f32_32x32x16_bf16 v[32:47], v[80:83], v[92:95], v[32:47]
ds_read_b64_tr_b16 v[118:119], v129 offset:2304
ds_read_b128 v[124:127], v131 offset:4096
v_lshlrev_b32 v174, 16, v175
v_mfma_f32_32x32x16_bf16 v[64:79], v[84:87], v[92:95], v[64:79]
v_and_b32 v175, 0xffff0000, v175
s_waitcnt lgkmcnt(6)
v_mfma_f32_32x32x16_bf16 v[16:31], v[96:99], v[104:107], v[16:31]
ds_read_b64_tr_b16 v[80:81], v128 offset:8192
ds_read_b64_tr_b16 v[82:83], v129 offset:8192
v_mfma_f32_32x32x16_bf16 v[48:63], v[100:103], v[104:107], v[48:63]
ds_read_b128 v[88:91], v132 offset:0
ds_read_b64_tr_b16 v[84:85], v128 offset:10240
v_mfma_f32_32x32x16_bf16 v[32:47], v[96:99], v[108:111], v[32:47]
ds_read_b64_tr_b16 v[86:87], v129 offset:10240
ds_read_b128 v[92:95], v132 offset:4096
v_mfma_f32_32x32x16_bf16 v[64:79], v[100:103], v[108:111], v[64:79]
s_waitcnt lgkmcnt(6)
v_mfma_f32_32x32x16_bf16 v[16:31], v[112:115], v[120:123], v[16:31]
ds_read_b64_tr_b16 v[96:97], v128 offset:8448
ds_read_b64_tr_b16 v[98:99], v129 offset:8448
v_mfma_f32_32x32x16_bf16 v[48:63], v[116:119], v[120:123], v[48:63]
ds_read_b128 v[104:107], v133 offset:0
ds_read_b64_tr_b16 v[100:101], v128 offset:10496
v_mfma_f32_32x32x16_bf16 v[32:47], v[112:115], v[124:127], v[32:47]
ds_read_b64_tr_b16 v[102:103], v129 offset:10496
ds_read_b128 v[108:111], v133 offset:4096
v_mfma_f32_32x32x16_bf16 v[64:79], v[116:119], v[124:127], v[64:79]
s_waitcnt lgkmcnt(0)
s_barrier
v_mfma_f32_32x32x16_bf16 v[16:31], v[80:83], v[88:91], v[16:31]
ds_read_b64_tr_b16 v[112:113], v8 offset:0
ds_read_b64_tr_b16 v[114:115], v9 offset:0
v_mfma_f32_32x32x16_bf16 v[48:63], v[84:87], v[88:91], v[48:63]
ds_read_b128 v[120:123], v10 offset:0
ds_read_b64_tr_b16 v[116:117], v8 offset:2048
v_mfma_f32_32x32x16_bf16 v[32:47], v[80:83], v[92:95], v[32:47]
ds_read_b64_tr_b16 v[118:119], v9 offset:2048
ds_read_b128 v[124:127], v10 offset:4096
v_mfma_f32_32x32x16_bf16 v[64:79], v[84:87], v[92:95], v[64:79]
v_mfma_f32_32x32x16_bf16 v[16:31], v[96:99], v[104:107], v[16:31]
ds_read_b64_tr_b16 v[80:81], v8 offset:256
ds_read_b64_tr_b16 v[82:83], v9 offset:256
v_mfma_f32_32x32x16_bf16 v[48:63], v[100:103], v[104:107], v[48:63]
ds_read_b128 v[88:91], v11 offset:0
ds_read_b64_tr_b16 v[84:85], v8 offset:2304
v_mfma_f32_32x32x16_bf16 v[32:47], v[96:99], v[108:111], v[32:47]
ds_read_b64_tr_b16 v[86:87], v9 offset:2304
ds_read_b128 v[92:95], v11 offset:4096
v_mfma_f32_32x32x16_bf16 v[64:79], v[100:103], v[108:111], v[64:79]
s_waitcnt lgkmcnt(6)
v_mfma_f32_32x32x16_bf16 v[16:31], v[112:115], v[120:123], v[16:31]
ds_read_b64_tr_b16 v[96:97], v8 offset:8192
ds_read_b64_tr_b16 v[98:99], v9 offset:8192
v_mfma_f32_32x32x16_bf16 v[48:63], v[116:119], v[120:123], v[48:63]
ds_read_b128 v[104:107], v12 offset:0
ds_read_b64_tr_b16 v[100:101], v8 offset:10240
v_mfma_f32_32x32x16_bf16 v[32:47], v[112:115], v[124:127], v[32:47]
ds_read_b64_tr_b16 v[102:103], v9 offset:10240
ds_read_b128 v[108:111], v12 offset:4096
v_mfma_f32_32x32x16_bf16 v[64:79], v[116:119], v[124:127], v[64:79]
s_waitcnt lgkmcnt(6)
v_mfma_f32_32x32x16_bf16 v[16:31], v[80:83], v[88:91], v[16:31]
ds_read_b64_tr_b16 v[112:113], v8 offset:8448
ds_read_b64_tr_b16 v[114:115], v9 offset:8448
v_mfma_f32_32x32x16_bf16 v[48:63], v[84:87], v[88:91], v[48:63]
ds_read_b128 v[120:123], v13 offset:0
ds_read_b64_tr_b16 v[116:117], v8 offset:10496
v_mfma_f32_32x32x16_bf16 v[32:47], v[80:83], v[92:95], v[32:47]
ds_read_b64_tr_b16 v[118:119], v9 offset:10496
ds_read_b128 v[124:127], v13 offset:4096
v_mfma_f32_32x32x16_bf16 v[64:79], v[84:87], v[92:95], v[64:79]
s_waitcnt lgkmcnt(0)
s_barrier
v_mfma_f32_32x32x16_bf16 v[16:31], v[96:99], v[104:107], v[16:31]
ds_read_b64_tr_b16 v[80:81], v8 offset:32768
ds_read_b64_tr_b16 v[82:83], v9 offset:32768
v_mfma_f32_32x32x16_bf16 v[48:63], v[100:103], v[104:107], v[48:63]
ds_read_b128 v[88:91], v10 offset:32768
ds_read_b64_tr_b16 v[84:85], v8 offset:34816
v_mfma_f32_32x32x16_bf16 v[32:47], v[96:99], v[108:111], v[32:47]
ds_read_b64_tr_b16 v[86:87], v9 offset:34816
ds_read_b128 v[92:95], v10 offset:36864
v_mfma_f32_32x32x16_bf16 v[64:79], v[100:103], v[108:111], v[64:79]
v_mfma_f32_32x32x16_bf16 v[16:31], v[112:115], v[120:123], v[16:31]
ds_read_b64_tr_b16 v[96:97], v8 offset:33024
ds_read_b64_tr_b16 v[98:99], v9 offset:33024
v_mfma_f32_32x32x16_bf16 v[48:63], v[116:119], v[120:123], v[48:63]
ds_read_b128 v[104:107], v11 offset:32768
ds_read_b64_tr_b16 v[100:101], v8 offset:35072
v_mfma_f32_32x32x16_bf16 v[32:47], v[112:115], v[124:127], v[32:47]
ds_read_b64_tr_b16 v[102:103], v9 offset:35072
ds_read_b128 v[108:111], v11 offset:36864
v_mfma_f32_32x32x16_bf16 v[64:79], v[116:119], v[124:127], v[64:79]
s_waitcnt lgkmcnt(6)
v_mfma_f32_32x32x16_bf16 v[16:31], v[80:83], v[88:91], v[16:31]
ds_read_b64_tr_b16 v[112:113], v8 offset:40960
ds_read_b64_tr_b16 v[114:115], v9 offset:40960
v_mfma_f32_32x32x16_bf16 v[48:63], v[84:87], v[88:91], v[48:63]
ds_read_b128 v[120:123], v12 offset:32768
ds_read_b64_tr_b16 v[116:117], v8 offset:43008
v_mfma_f32_32x32x16_bf16 v[32:47], v[80:83], v[92:95], v[32:47]
ds_read_b64_tr_b16 v[118:119], v9 offset:43008
ds_read_b128 v[124:127], v12 offset:36864
v_mfma_f32_32x32x16_bf16 v[64:79], v[84:87], v[92:95], v[64:79]
s_waitcnt vmcnt(0)
v_cndmask_b32 v232, 0, v232, s[44:45]
v_cndmask_b32 v237, 0, v237, s[44:45]
v_mov_b32 v233, 0
s_waitcnt lgkmcnt(6)
v_mfma_f32_32x32x16_bf16 v[16:31], v[96:99], v[104:107], v[16:31]
ds_read_b64_tr_b16 v[80:81], v8 offset:41216
ds_read_b64_tr_b16 v[82:83], v9 offset:41216
v_mfma_f32_32x32x16_bf16 v[48:63], v[100:103], v[104:107], v[48:63]
ds_read_b128 v[88:91], v13 offset:32768
ds_read_b64_tr_b16 v[84:85], v8 offset:43264
v_mfma_f32_32x32x16_bf16 v[32:47], v[96:99], v[108:111], v[32:47]
ds_read_b64_tr_b16 v[86:87], v9 offset:43264
ds_read_b128 v[92:95], v13 offset:36864
v_mfma_f32_32x32x16_bf16 v[64:79], v[100:103], v[108:111], v[64:79]
s_waitcnt lgkmcnt(0)
s_barrier
v_mfma_f32_32x32x16_bf16 v[16:31], v[112:115], v[120:123], v[16:31]
ds_read_b64_tr_b16 v[96:97], v2 offset:0
ds_read_b64_tr_b16 v[98:99], v3 offset:0
v_mfma_f32_32x32x16_bf16 v[48:63], v[116:119], v[120:123], v[48:63]
ds_read_b128 v[104:107], v4 offset:0
ds_read_b64_tr_b16 v[100:101], v2 offset:2048
v_mfma_f32_32x32x16_bf16 v[32:47], v[112:115], v[124:127], v[32:47]
ds_read_b64_tr_b16 v[102:103], v3 offset:2048
ds_read_b128 v[108:111], v4 offset:4096
v_mfma_f32_32x32x16_bf16 v[64:79], v[116:119], v[124:127], v[64:79]
v_mfma_f32_32x32x16_bf16 v[16:31], v[80:83], v[88:91], v[16:31]
ds_read_b64_tr_b16 v[112:113], v2 offset:256
ds_read_b64_tr_b16 v[114:115], v3 offset:256
v_mfma_f32_32x32x16_bf16 v[48:63], v[84:87], v[88:91], v[48:63]
ds_read_b128 v[120:123], v5 offset:0
ds_read_b64_tr_b16 v[116:117], v2 offset:2304
v_mfma_f32_32x32x16_bf16 v[32:47], v[80:83], v[92:95], v[32:47]
ds_read_b64_tr_b16 v[118:119], v3 offset:2304
ds_read_b128 v[124:127], v5 offset:4096
v_mfma_f32_32x32x16_bf16 v[64:79], v[84:87], v[92:95], v[64:79]
s_waitcnt lgkmcnt(6)
v_mfma_f32_32x32x16_bf16 v[16:31], v[96:99], v[104:107], v[16:31]
ds_read_b64_tr_b16 v[80:81], v2 offset:8192
ds_read_b64_tr_b16 v[82:83], v3 offset:8192
v_mfma_f32_32x32x16_bf16 v[48:63], v[100:103], v[104:107], v[48:63]
ds_read_b128 v[88:91], v6 offset:0
ds_read_b64_tr_b16 v[84:85], v2 offset:10240
v_mfma_f32_32x32x16_bf16 v[32:47], v[96:99], v[108:111], v[32:47]
ds_read_b64_tr_b16 v[86:87], v3 offset:10240
ds_read_b128 v[92:95], v6 offset:4096
v_mfma_f32_32x32x16_bf16 v[64:79], v[100:103], v[108:111], v[64:79]
v_add_u32 v228, s73, v14
s_add_u32 s73, s73, 1024
v_lshrrev_b32 v137, s74, v228
v_mul_u32_u24 v137, 9363, v137
v_lshrrev_b32 v137, 16, v137
v_mad_u32_u24 v228, v137, s75, v228
s_waitcnt lgkmcnt(6)
v_mfma_f32_32x32x16_bf16 v[16:31], v[112:115], v[120:123], v[16:31]
ds_read_b64_tr_b16 v[96:97], v2 offset:8448
ds_read_b64_tr_b16 v[98:99], v3 offset:8448
v_mfma_f32_32x32x16_bf16 v[48:63], v[116:119], v[120:123], v[48:63]
ds_read_b128 v[104:107], v7 offset:0
ds_read_b64_tr_b16 v[100:101], v2 offset:10496
v_mfma_f32_32x32x16_bf16 v[32:47], v[112:115], v[124:127], v[32:47]
ds_read_b64_tr_b16 v[102:103], v3 offset:10496
ds_read_b128 v[108:111], v7 offset:4096
v_mfma_f32_32x32x16_bf16 v[64:79], v[116:119], v[124:127], v[64:79]
v_mfma_f32_32x32x16_bf16 v[48:63], v[240:243], v[232:235], v[48:63]
v_add_u32 v229, s73, v14
s_add_u32 s73, s73, 1024
v_lshrrev_b32 v137, s74, v229
v_mul_u32_u24 v137, 9363, v137
v_lshrrev_b32 v137, 16, v137
v_mad_u32_u24 v229, v137, s75, v229
s_waitcnt lgkmcnt(0)
s_barrier
v_mfma_f32_32x32x16_bf16 v[16:31], v[80:83], v[88:91], v[16:31]
ds_read_b64_tr_b16 v[112:113], v128 offset:0
ds_read_b64_tr_b16 v[114:115], v129 offset:0
v_mfma_f32_32x32x16_bf16 v[48:63], v[84:87], v[88:91], v[48:63]
ds_read_b128 v[120:123], v130 offset:0
ds_read_b64_tr_b16 v[116:117], v128 offset:2048
v_mfma_f32_32x32x16_bf16 v[32:47], v[80:83], v[92:95], v[32:47]
ds_read_b64_tr_b16 v[118:119], v129 offset:2048
ds_read_b128 v[124:127], v130 offset:4096
v_mfma_f32_32x32x16_bf16 v[64:79], v[84:87], v[92:95], v[64:79]
v_add_u32 v230, s73, v14
s_add_u32 s73, s73, 1024
v_lshrrev_b32 v137, s74, v230
v_mul_u32_u24 v137, 9363, v137
v_lshrrev_b32 v137, 16, v137
v_mad_u32_u24 v230, v137, s75, v230
v_mfma_f32_32x32x16_bf16 v[16:31], v[96:99], v[104:107], v[16:31]
ds_read_b64_tr_b16 v[80:81], v128 offset:256
ds_read_b64_tr_b16 v[82:83], v129 offset:256
v_mfma_f32_32x32x16_bf16 v[48:63], v[100:103], v[104:107], v[48:63]
ds_read_b128 v[88:91], v131 offset:0
ds_read_b64_tr_b16 v[84:85], v128 offset:2304
v_mfma_f32_32x32x16_bf16 v[32:47], v[96:99], v[108:111], v[32:47]
ds_read_b64_tr_b16 v[86:87], v129 offset:2304
ds_read_b128 v[92:95], v131 offset:4096
v_mfma_f32_32x32x16_bf16 v[64:79], v[100:103], v[108:111], v[64:79]
v_add_u32 v252, s73, v14
s_add_u32 s73, s73, 1024
v_lshrrev_b32 v137, s74, v252
v_mul_u32_u24 v137, 9363, v137
v_lshrrev_b32 v137, 16, v137
v_mad_u32_u24 v252, v137, s75, v252
s_waitcnt lgkmcnt(6)
v_mfma_f32_32x32x16_bf16 v[16:31], v[112:115], v[120:123], v[16:31]
ds_read_b64_tr_b16 v[96:97], v128 offset:8192
ds_read_b64_tr_b16 v[98:99], v129 offset:8192
v_mfma_f32_32x32x16_bf16 v[48:63], v[116:119], v[120:123], v[48:63]
ds_read_b128 v[104:107], v132 offset:0
ds_read_b64_tr_b16 v[100:101], v128 offset:10240
v_mfma_f32_32x32x16_bf16 v[32:47], v[112:115], v[124:127], v[32:47]
ds_read_b64_tr_b16 v[102:103], v129 offset:10240
ds_read_b128 v[108:111], v132 offset:4096
v_mfma_f32_32x32x16_bf16 v[64:79], v[116:119], v[124:127], v[64:79]
s_mov_b32 s73, 1.0
s_brev_b32 s74, -2
s_waitcnt lgkmcnt(6)
v_mfma_f32_32x32x16_bf16 v[16:31], v[80:83], v[88:91], v[16:31]
ds_read_b64_tr_b16 v[112:113], v128 offset:8448
ds_read_b64_tr_b16 v[114:115], v129 offset:8448
v_mfma_f32_32x32x16_bf16 v[48:63], v[84:87], v[88:91], v[48:63]
ds_read_b128 v[120:123], v133 offset:0
ds_read_b64_tr_b16 v[116:117], v128 offset:10496
v_mfma_f32_32x32x16_bf16 v[32:47], v[80:83], v[92:95], v[32:47]
ds_read_b64_tr_b16 v[118:119], v129 offset:10496
ds_read_b128 v[124:127], v133 offset:4096
v_mfma_f32_32x32x16_bf16 v[64:79], v[84:87], v[92:95], v[64:79]
s_waitcnt lgkmcnt(0)
s_barrier
v_mfma_f32_32x32x16_bf16 v[16:31], v[96:99], v[104:107], v[16:31]
ds_read_b64_tr_b16 v[80:81], v8 offset:0
ds_read_b64_tr_b16 v[82:83], v9 offset:0
v_mfma_f32_32x32x16_bf16 v[48:63], v[100:103], v[104:107], v[48:63]
ds_read_b128 v[88:91], v10 offset:0
ds_read_b64_tr_b16 v[84:85], v8 offset:2048
v_mfma_f32_32x32x16_bf16 v[32:47], v[96:99], v[108:111], v[32:47]
ds_read_b64_tr_b16 v[86:87], v9 offset:2048
ds_read_b128 v[92:95], v10 offset:4096
v_mfma_f32_32x32x16_bf16 v[64:79], v[100:103], v[108:111], v[64:79]
v_mfma_f32_32x32x16_bf16 v[16:31], v[112:115], v[120:123], v[16:31]
ds_read_b64_tr_b16 v[96:97], v8 offset:256
ds_read_b64_tr_b16 v[98:99], v9 offset:256
v_mfma_f32_32x32x16_bf16 v[48:63], v[116:119], v[120:123], v[48:63]
ds_read_b128 v[104:107], v11 offset:0
ds_read_b64_tr_b16 v[100:101], v8 offset:2304
v_mfma_f32_32x32x16_bf16 v[32:47], v[112:115], v[124:127], v[32:47]
ds_read_b64_tr_b16 v[102:103], v9 offset:2304
ds_read_b128 v[108:111], v11 offset:4096
v_mfma_f32_32x32x16_bf16 v[64:79], v[116:119], v[124:127], v[64:79]
s_waitcnt lgkmcnt(6)
v_mfma_f32_32x32x16_bf16 v[16:31], v[80:83], v[88:91], v[16:31]
ds_read_b64_tr_b16 v[112:113], v8 offset:8192
ds_read_b64_tr_b16 v[114:115], v9 offset:8192
v_mfma_f32_32x32x16_bf16 v[48:63], v[84:87], v[88:91], v[48:63]
ds_read_b128 v[120:123], v12 offset:0
ds_read_b64_tr_b16 v[116:117], v8 offset:10240
v_mfma_f32_32x32x16_bf16 v[32:47], v[80:83], v[92:95], v[32:47]
ds_read_b64_tr_b16 v[118:119], v9 offset:10240
ds_read_b128 v[124:127], v12 offset:4096
v_mfma_f32_32x32x16_bf16 v[64:79], v[84:87], v[92:95], v[64:79]
s_waitcnt lgkmcnt(6)
v_mfma_f32_32x32x16_bf16 v[16:31], v[96:99], v[104:107], v[16:31]
ds_read_b64_tr_b16 v[80:81], v8 offset:8448
ds_read_b64_tr_b16 v[82:83], v9 offset:8448
v_mfma_f32_32x32x16_bf16 v[48:63], v[100:103], v[104:107], v[48:63]
ds_read_b128 v[88:91], v13 offset:0
ds_read_b64_tr_b16 v[84:85], v8 offset:10496
v_mfma_f32_32x32x16_bf16 v[64:79], v[240:243], v[234:237], v[64:79]
v_mfma_f32_32x32x16_bf16 v[32:47], v[96:99], v[108:111], v[32:47]
ds_read_b64_tr_b16 v[86:87], v9 offset:10496
ds_read_b128 v[92:95], v13 offset:4096
v_mfma_f32_32x32x16_bf16 v[64:79], v[100:103], v[108:111], v[64:79]
s_waitcnt lgkmcnt(0)
s_barrier
v_mfma_f32_32x32x16_bf16 v[16:31], v[112:115], v[120:123], v[16:31]
ds_read_b64_tr_b16 v[96:97], v8 offset:32768
ds_read_b64_tr_b16 v[98:99], v9 offset:32768
v_mfma_f32_32x32x16_bf16 v[48:63], v[116:119], v[120:123], v[48:63]
ds_read_b128 v[104:107], v10 offset:32768
ds_read_b64_tr_b16 v[100:101], v8 offset:34816
v_mfma_f32_32x32x16_bf16 v[32:47], v[112:115], v[124:127], v[32:47]
ds_read_b64_tr_b16 v[102:103], v9 offset:34816
ds_read_b128 v[108:111], v10 offset:36864
v_mfma_f32_32x32x16_bf16 v[64:79], v[116:119], v[124:127], v[64:79]
v_mfma_f32_32x32x16_bf16 v[16:31], v[80:83], v[88:91], v[16:31]
ds_read_b64_tr_b16 v[112:113], v8 offset:33024
ds_read_b64_tr_b16 v[114:115], v9 offset:33024
v_mfma_f32_32x32x16_bf16 v[48:63], v[84:87], v[88:91], v[48:63]
ds_read_b128 v[120:123], v11 offset:32768
ds_read_b64_tr_b16 v[116:117], v8 offset:35072
v_mfma_f32_32x32x16_bf16 v[32:47], v[80:83], v[92:95], v[32:47]
ds_read_b64_tr_b16 v[118:119], v9 offset:35072
ds_read_b128 v[124:127], v11 offset:36864
v_mfma_f32_32x32x16_bf16 v[64:79], v[84:87], v[92:95], v[64:79]
s_waitcnt lgkmcnt(6)
v_mfma_f32_32x32x16_bf16 v[16:31], v[96:99], v[104:107], v[16:31]
ds_read_b64_tr_b16 v[80:81], v8 offset:40960
ds_read_b64_tr_b16 v[82:83], v9 offset:40960
v_mfma_f32_32x32x16_bf16 v[48:63], v[100:103], v[104:107], v[48:63]
ds_read_b128 v[88:91], v12 offset:32768
ds_read_b64_tr_b16 v[84:85], v8 offset:43008
v_mfma_f32_32x32x16_bf16 v[32:47], v[96:99], v[108:111], v[32:47]
ds_read_b64_tr_b16 v[86:87], v9 offset:43008
ds_read_b128 v[92:95], v12 offset:36864
v_mfma_f32_32x32x16_bf16 v[64:79], v[100:103], v[108:111], v[64:79]
s_waitcnt lgkmcnt(6)
v_mfma_f32_32x32x16_bf16 v[16:31], v[112:115], v[120:123], v[16:31]
ds_read_b64_tr_b16 v[96:97], v8 offset:41216
ds_read_b64_tr_b16 v[98:99], v9 offset:41216
v_mfma_f32_32x32x16_bf16 v[48:63], v[116:119], v[120:123], v[48:63]
ds_read_b128 v[104:107], v13 offset:32768
ds_read_b64_tr_b16 v[100:101], v8 offset:43264
v_mfma_f32_32x32x16_bf16 v[32:47], v[112:115], v[124:127], v[32:47]
ds_read_b64_tr_b16 v[102:103], v9 offset:43264
ds_read_b128 v[108:111], v13 offset:36864
v_mfma_f32_32x32x16_bf16 v[64:79], v[116:119], v[124:127], v[64:79]
s_waitcnt lgkmcnt(0)
s_barrier
v_mfma_f32_32x32x16_bf16 v[16:31], v[80:83], v[88:91], v[16:31]
ds_read_b64_tr_b16 v[112:113], v2 offset:0
ds_read_b64_tr_b16 v[114:115], v3 offset:0
v_mfma_f32_32x32x16_bf16 v[48:63], v[84:87], v[88:91], v[48:63]
ds_read_b128 v[120:123], v4 offset:0
ds_read_b64_tr_b16 v[116:117], v2 offset:2048
v_mfma_f32_32x32x16_bf16 v[32:47], v[80:83], v[92:95], v[32:47]
ds_read_b64_tr_b16 v[118:119], v3 offset:2048
ds_read_b128 v[124:127], v4 offset:4096
v_mfma_f32_32x32x16_bf16 v[64:79], v[84:87], v[92:95], v[64:79]
v_mfma_f32_32x32x16_bf16 v[16:31], v[96:99], v[104:107], v[16:31]
ds_read_b64_tr_b16 v[80:81], v2 offset:256
ds_read_b64_tr_b16 v[82:83], v3 offset:256
v_mfma_f32_32x32x16_bf16 v[48:63], v[100:103], v[104:107], v[48:63]
ds_read_b128 v[88:91], v5 offset:0
ds_read_b64_tr_b16 v[84:85], v2 offset:2304
v_mfma_f32_32x32x16_bf16 v[32:47], v[96:99], v[108:111], v[32:47]
ds_read_b64_tr_b16 v[86:87], v3 offset:2304
ds_read_b128 v[92:95], v5 offset:4096
v_mfma_f32_32x32x16_bf16 v[64:79], v[100:103], v[108:111], v[64:79]
s_waitcnt lgkmcnt(6)
v_mfma_f32_32x32x16_bf16 v[16:31], v[112:115], v[120:123], v[16:31]
ds_read_b64_tr_b16 v[96:97], v2 offset:8192
ds_read_b64_tr_b16 v[98:99], v3 offset:8192
v_mfma_f32_32x32x16_bf16 v[48:63], v[116:119], v[120:123], v[48:63]
ds_read_b128 v[104:107], v6 offset:0
ds_read_b64_tr_b16 v[100:101], v2 offset:10240
v_mfma_f32_32x32x16_bf16 v[32:47], v[112:115], v[124:127], v[32:47]
ds_read_b64_tr_b16 v[102:103], v3 offset:10240
ds_read_b128 v[108:111], v6 offset:4096
v_mfma_f32_32x32x16_bf16 v[64:79], v[116:119], v[124:127], v[64:79]
s_waitcnt lgkmcnt(6)
v_mfma_f32_32x32x16_bf16 v[16:31], v[80:83], v[88:91], v[16:31]
ds_read_b64_tr_b16 v[112:113], v2 offset:8448
ds_read_b64_tr_b16 v[114:115], v3 offset:8448
v_mfma_f32_32x32x16_bf16 v[48:63], v[84:87], v[88:91], v[48:63]
ds_read_b128 v[120:123], v7 offset:0
ds_read_b64_tr_b16 v[116:117], v2 offset:10496
v_mfma_f32_32x32x16_bf16 v[32:47], v[80:83], v[92:95], v[32:47]
ds_read_b64_tr_b16 v[118:119], v3 offset:10496
ds_read_b128 v[124:127], v7 offset:4096
v_mfma_f32_32x32x16_bf16 v[64:79], v[84:87], v[92:95], v[64:79]
s_waitcnt lgkmcnt(0)
s_barrier
v_mfma_f32_32x32x16_bf16 v[16:31], v[96:99], v[104:107], v[16:31]
ds_read_b64_tr_b16 v[176:177], v128 offset:0
ds_read_b64_tr_b16 v[178:179], v129 offset:0
v_mfma_f32_32x32x16_bf16 v[48:63], v[100:103], v[104:107], v[48:63]
ds_read_b128 v[180:183], v130 offset:0
ds_read_b128 v[184:187], v130 offset:4096
v_mfma_f32_32x32x16_bf16 v[32:47], v[96:99], v[108:111], v[32:47]
ds_read_b64_tr_b16 v[188:189], v128 offset:256
ds_read_b64_tr_b16 v[190:191], v129 offset:256
v_mfma_f32_32x32x16_bf16 v[64:79], v[100:103], v[108:111], v[64:79]
ds_read_b128 v[192:195], v131 offset:0
ds_read_b128 v[196:199], v131 offset:4096
v_mfma_f32_32x32x16_bf16 v[16:31], v[112:115], v[120:123], v[16:31]
ds_read_b64_tr_b16 v[80:81], v128 offset:8192
ds_read_b64_tr_b16 v[82:83], v129 offset:8192
v_mfma_f32_32x32x16_bf16 v[48:63], v[116:119], v[120:123], v[48:63]
ds_read_b128 v[84:87], v132 offset:0
ds_read_b128 v[88:91], v132 offset:4096
v_mfma_f32_32x32x16_bf16 v[32:47], v[112:115], v[124:127], v[32:47]
ds_read_b64_tr_b16 v[92:93], v128 offset:8448
ds_read_b64_tr_b16 v[94:95], v129 offset:8448
v_mfma_f32_32x32x16_bf16 v[64:79], v[116:119], v[124:127], v[64:79]
ds_read_b128 v[96:99], v133 offset:0
ds_read_b128 v[100:103], v133 offset:4096
s_barrier
s_waitcnt lgkmcnt(8)
v_mfma_f32_32x32x16_bf16 v[16:31], v[176:179], v[180:183], v[16:31]
ds_read_b64_tr_b16 v[104:105], v8 offset:0
ds_read_b64_tr_b16 v[106:107], v9 offset:0
v_mfma_f32_32x32x16_bf16 v[32:47], v[176:179], v[184:187], v[32:47]
ds_read_b128 v[108:111], v10 offset:0
ds_read_b128 v[112:115], v10 offset:4096
v_mfma_f32_32x32x16_bf16 v[16:31], v[188:191], v[192:195], v[16:31]
ds_read_b64_tr_b16 v[116:117], v8 offset:256
ds_read_b64_tr_b16 v[118:119], v9 offset:256
v_mfma_f32_32x32x16_bf16 v[32:47], v[188:191], v[196:199], v[32:47]
ds_read_b128 v[120:123], v11 offset:0
ds_read_b128 v[124:127], v11 offset:4096
s_waitcnt lgkmcnt(8)
v_mfma_f32_32x32x16_bf16 v[16:31], v[80:83], v[84:87], v[16:31]
ds_read_b64_tr_b16 v[176:177], v8 offset:8192
ds_read_b64_tr_b16 v[178:179], v9 offset:8192
v_mfma_f32_32x32x16_bf16 v[32:47], v[80:83], v[88:91], v[32:47]
ds_read_b128 v[180:183], v12 offset:0
ds_read_b128 v[184:187], v12 offset:4096
v_mfma_f32_32x32x16_bf16 v[16:31], v[92:95], v[96:99], v[16:31]
ds_read_b64_tr_b16 v[188:189], v8 offset:8448
ds_read_b64_tr_b16 v[190:191], v9 offset:8448
v_mfma_f32_32x32x16_bf16 v[32:47], v[92:95], v[100:103], v[32:47]
ds_read_b128 v[192:195], v13 offset:0
ds_read_b128 v[196:199], v13 offset:4096
s_barrier
s_waitcnt lgkmcnt(8)
v_mfma_f32_32x32x16_bf16 v[16:31], v[104:107], v[108:111], v[16:31]
ds_read_b64_tr_b16 v[80:81], v8 offset:32768
ds_read_b64_tr_b16 v[82:83], v9 offset:32768
v_mfma_f32_32x32x16_bf16 v[32:47], v[104:107], v[112:115], v[32:47]
ds_read_b128 v[84:87], v10 offset:32768
ds_read_b128 v[88:91], v10 offset:36864
v_mfma_f32_32x32x16_bf16 v[16:31], v[116:119], v[120:123], v[16:31]
ds_read_b64_tr_b16 v[92:93], v8 offset:33024
ds_read_b64_tr_b16 v[94:95], v9 offset:33024
v_mfma_f32_32x32x16_bf16 v[32:47], v[116:119], v[124:127], v[32:47]
ds_read_b128 v[96:99], v11 offset:32768
ds_read_b128 v[100:103], v11 offset:36864
s_waitcnt lgkmcnt(8)
v_mfma_f32_32x32x16_bf16 v[16:31], v[176:179], v[180:183], v[16:31]
ds_read_b64_tr_b16 v[104:105], v8 offset:40960
ds_read_b64_tr_b16 v[106:107], v9 offset:40960
v_mfma_f32_32x32x16_bf16 v[32:47], v[176:179], v[184:187], v[32:47]
ds_read_b128 v[108:111], v12 offset:32768
ds_read_b128 v[112:115], v12 offset:36864
v_mfma_f32_32x32x16_bf16 v[16:31], v[188:191], v[192:195], v[16:31]
ds_read_b64_tr_b16 v[116:117], v8 offset:41216
ds_read_b64_tr_b16 v[118:119], v9 offset:41216
v_mfma_f32_32x32x16_bf16 v[32:47], v[188:191], v[196:199], v[32:47]
ds_read_b128 v[120:123], v13 offset:32768
ds_read_b128 v[124:127], v13 offset:36864
s_waitcnt lgkmcnt(8)
v_mfma_f32_32x32x16_bf16 v[16:31], v[80:83], v[84:87], v[16:31]
ds_read_b64_tr_b16 v[176:177], v128 offset:2048
ds_read_b64_tr_b16 v[178:179], v129 offset:2048
v_mfma_f32_32x32x16_bf16 v[32:47], v[80:83], v[88:91], v[32:47]
ds_read_b128 v[180:183], v130 offset:0
ds_read_b128 v[184:187], v130 offset:4096
v_mfma_f32_32x32x16_bf16 v[16:31], v[92:95], v[96:99], v[16:31]
ds_read_b64_tr_b16 v[188:189], v128 offset:2304
ds_read_b64_tr_b16 v[190:191], v129 offset:2304
v_mfma_f32_32x32x16_bf16 v[32:47], v[92:95], v[100:103], v[32:47]
ds_read_b128 v[192:195], v131 offset:0
ds_read_b128 v[196:199], v131 offset:4096
s_waitcnt lgkmcnt(8)
v_mfma_f32_32x32x16_bf16 v[16:31], v[104:107], v[108:111], v[16:31]
ds_read_b64_tr_b16 v[80:81], v128 offset:10240
ds_read_b64_tr_b16 v[82:83], v129 offset:10240
v_mfma_f32_32x32x16_bf16 v[32:47], v[104:107], v[112:115], v[32:47]
ds_read_b128 v[84:87], v132 offset:0
ds_read_b128 v[88:91], v132 offset:4096
v_mfma_f32_32x32x16_bf16 v[16:31], v[116:119], v[120:123], v[16:31]
ds_read_b64_tr_b16 v[92:93], v128 offset:10496
ds_read_b64_tr_b16 v[94:95], v129 offset:10496
v_mfma_f32_32x32x16_bf16 v[32:47], v[116:119], v[124:127], v[32:47]
ds_read_b128 v[96:99], v133 offset:0
ds_read_b128 v[100:103], v133 offset:4096
s_waitcnt lgkmcnt(8)
v_mfma_f32_32x32x16_bf16 v[48:63], v[176:179], v[180:183], v[48:63]
ds_read_b64_tr_b16 v[104:105], v8 offset:2048
ds_read_b64_tr_b16 v[106:107], v9 offset:2048
v_mfma_f32_32x32x16_bf16 v[64:79], v[176:179], v[184:187], v[64:79]
ds_read_b128 v[108:111], v10 offset:0
ds_read_b128 v[112:115], v10 offset:4096
v_fma_f32 v23, v23, s72, 4.0
v_mul_f32 v21, s71, v21
v_cvt_pk_bf16_f32 v16, v16, v17
v_cvt_pk_bf16_f32 v17, v18, v19
v_cvt_pk_bf16_f32 v18, v20, v21
v_cvt_pk_bf16_f32 v19, v22, v23
v_alignbit_b32 v19, v19, v19, 31
v_alignbit_b32 v18, v18, v18, 31
buffer_store_dwordx4 v[16:19], v228, s[24:27], s42 offen sc1
v_mfma_f32_32x32x16_bf16 v[48:63], v[188:191], v[192:195], v[48:63]
ds_read_b64_tr_b16 v[116:117], v8 offset:2304
ds_read_b64_tr_b16 v[118:119], v9 offset:2304
v_fma_f32 v31, v31, s72, 4.0
v_mul_f32 v29, s71, v29
v_cvt_pk_bf16_f32 v24, v24, v25
v_cvt_pk_bf16_f32 v25, v26, v27
v_cvt_pk_bf16_f32 v26, v28, v29
v_cvt_pk_bf16_f32 v27, v30, v31
v_alignbit_b32 v27, v27, v27, 31
v_alignbit_b32 v26, v26, v26, 31
buffer_store_dwordx4 v[24:27], v229, s[24:27], s42 offen sc1
v_mfma_f32_32x32x16_bf16 v[64:79], v[188:191], v[196:199], v[64:79]
ds_read_b128 v[120:123], v11 offset:0
ds_read_b128 v[124:127], v11 offset:4096
v_fma_f32 v39, v39, s72, 4.0
v_mul_f32 v37, s71, v37
v_cvt_pk_bf16_f32 v32, v32, v33
v_cvt_pk_bf16_f32 v33, v34, v35
v_cvt_pk_bf16_f32 v34, v36, v37
v_cvt_pk_bf16_f32 v35, v38, v39
v_alignbit_b32 v35, v35, v35, 31
v_alignbit_b32 v34, v34, v34, 31
buffer_store_dwordx4 v[32:35], v230, s[24:27], s42 offen sc1
s_waitcnt lgkmcnt(8)
v_mfma_f32_32x32x16_bf16 v[48:63], v[80:83], v[84:87], v[48:63]
ds_read_b64_tr_b16 v[176:177], v8 offset:10240
ds_read_b64_tr_b16 v[178:179], v9 offset:10240
v_fma_f32 v47, v47, s72, 4.0
v_mul_f32 v45, s71, v45
v_cvt_pk_bf16_f32 v40, v40, v41
v_cvt_pk_bf16_f32 v41, v42, v43
v_cvt_pk_bf16_f32 v42, v44, v45
v_cvt_pk_bf16_f32 v43, v46, v47
v_alignbit_b32 v43, v43, v43, 31
v_alignbit_b32 v42, v42, v42, 31
buffer_store_dwordx4 v[40:43], v252, s[24:27], s42 offen sc1
v_mfma_f32_32x32x16_bf16 v[64:79], v[80:83], v[88:91], v[64:79]
ds_read_b128 v[180:183], v12 offset:0
ds_read_b128 v[184:187], v12 offset:4096
v_mfma_f32_32x32x16_bf16 v[48:63], v[92:95], v[96:99], v[48:63]
ds_read_b64_tr_b16 v[188:189], v8 offset:10496
ds_read_b64_tr_b16 v[190:191], v9 offset:10496
v_mfma_f32_32x32x16_bf16 v[64:79], v[92:95], v[100:103], v[64:79]
ds_read_b128 v[192:195], v13 offset:0
ds_read_b128 v[196:199], v13 offset:4096
s_waitcnt lgkmcnt(8)
v_mfma_f32_32x32x16_bf16 v[48:63], v[104:107], v[108:111], v[48:63]
ds_read_b64_tr_b16 v[80:81], v8 offset:34816
ds_read_b64_tr_b16 v[82:83], v9 offset:34816
v_mfma_f32_32x32x16_bf16 v[64:79], v[104:107], v[112:115], v[64:79]
ds_read_b128 v[84:87], v10 offset:32768
ds_read_b128 v[88:91], v10 offset:36864
v_mfma_f32_32x32x16_bf16 v[48:63], v[116:119], v[120:123], v[48:63]
ds_read_b64_tr_b16 v[92:93], v8 offset:35072
ds_read_b64_tr_b16 v[94:95], v9 offset:35072
v_mfma_f32_32x32x16_bf16 v[64:79], v[116:119], v[124:127], v[64:79]
ds_read_b128 v[96:99], v11 offset:32768
ds_read_b128 v[100:103], v11 offset:36864
s_waitcnt lgkmcnt(8)
v_mfma_f32_32x32x16_bf16 v[48:63], v[176:179], v[180:183], v[48:63]
ds_read_b64_tr_b16 v[104:105], v8 offset:43008
ds_read_b64_tr_b16 v[106:107], v9 offset:43008
v_mfma_f32_32x32x16_bf16 v[64:79], v[176:179], v[184:187], v[64:79]
ds_read_b128 v[108:111], v12 offset:32768
ds_read_b128 v[112:115], v12 offset:36864
v_mfma_f32_32x32x16_bf16 v[48:63], v[188:191], v[192:195], v[48:63]
ds_read_b64_tr_b16 v[116:117], v8 offset:43264
ds_read_b64_tr_b16 v[118:119], v9 offset:43264
v_mfma_f32_32x32x16_bf16 v[64:79], v[188:191], v[196:199], v[64:79]
ds_read_b128 v[120:123], v13 offset:32768
ds_read_b128 v[124:127], v13 offset:36864
s_waitcnt lgkmcnt(8)
v_mfma_f32_32x32x16_bf16 v[48:63], v[80:83], v[84:87], v[48:63]
ds_read_b64_tr_b16 v[216:217], v246 offset:0
ds_read_b64_tr_b16 v[218:219], v246 offset:1024
v_mfma_f32_32x32x16_bf16 v[64:79], v[80:83], v[88:91], v[64:79]
ds_read_b64_tr_b16 v[220:221], v247 offset:0
ds_read_b64_tr_b16 v[222:223], v247 offset:1024
v_mfma_f32_32x32x16_bf16 v[48:63], v[92:95], v[96:99], v[48:63]
v_mfma_f32_32x32x16_bf16 v[64:79], v[92:95], v[100:103], v[64:79]
s_waitcnt lgkmcnt(4)
s_waitcnt lgkmcnt(0)
v_mfma_f32_32x32x16_bf16 v[48:63], v[104:107], v[108:111], v[48:63]
v_mfma_f32_32x32x16_bf16 v[64:79], v[104:107], v[112:115], v[64:79]
v_mfma_f32_32x32x16_bf16 v[48:63], v[116:119], v[120:123], v[48:63]
v_mfma_f32_32x32x16_bf16 v[64:79], v[116:119], v[124:127], v[64:79]
s_setprio 3
s_nop 2
s_mov_b32 s12, s64
s_and_b32 s13, s65, 0xffff
s_mov_b32 s14, 1835008
s_mov_b32 s15, 0x20000
s_mov_b32 s4, s60
s_and_b32 s5, s61, 0xffff
s_mov_b32 s6, 1835008
s_mov_b32 s7, 0x20000
s_lshl_b32 s33, s46, 1
s_add_u32 s33, s33, s32
s_mul_i32 s48, s33, 28672
s_lshl_b32 s34, s29, 2
s_add_u32 s34, s34, s31
s_lshl_b32 s34, s34, 5
s_add_u32 s48, s48, s34
s_mul_i32 s33, s33, 147456
s_add_u32 s33, s33, 16777216
s_and_b32 s34, s46, 0
s_add_u32 s34, s34, s31
s_and_b32 s34, s34, 3
s_lshl_b32 s34, s34, 13
s_add_u32 s47, s33, s34
s_mul_i32 s34, s31, 14336
s_add_u32 s41, s33, s34
s_add_u32 s41, s41, 32768
v_and_b32 v250, 31, v1
v_mul_u32_u24 v250, 896, v250
v_lshrrev_b32 v251, 5, v1
v_lshl_add_u32 v250, v251, 4, v250
v_add_u32 v251, 57344, v14
s_mov_b32 s41, 8388608
s_add_u32 s42, s38, 147456
s_barrier
buffer_load_dwordx4 v[176:179], v14, s[24:27], s47 offen offset:0
buffer_load_dwordx4 v[180:183], v14, s[24:27], s47 offen offset:1024
buffer_load_dwordx4 v[184:187], v14, s[24:27], s47 offen offset:2048
buffer_load_dwordx4 v[188:191], v14, s[24:27], s47 offen offset:3072
s_add_u32 s47, s47, 4096
buffer_load_dwordx4 v[192:195], v14, s[24:27], s47 offen offset:0
buffer_load_dwordx4 v[196:199], v14, s[24:27], s47 offen offset:1024
buffer_load_dwordx4 v[200:203], v14, s[24:27], s47 offen offset:2048
buffer_load_dwordx4 v[204:207], v14, s[24:27], s47 offen offset:3072
buffer_load_dwordx4 v[208:211], v228, s[24:27], s63 offen sc1
buffer_load_dwordx4 v[212:215], v229, s[24:27], s63 offen sc1
buffer_load_dwordx4 v[224:227], v230, s[24:27], s63 offen sc1
buffer_load_dwordx4 v[236:239], v252, s[24:27], s63 offen sc1
ds_read_b64_tr_b16 v[80:81], v244 offset:0
ds_read_b64_tr_b16 v[82:83], v244 offset:1024
ds_read_b64_tr_b16 v[84:85], v245 offset:0
ds_read_b64_tr_b16 v[86:87], v245 offset:1024
ds_read_b64_tr_b16 v[88:89], v244 offset:2048
ds_read_b64_tr_b16 v[90:91], v244 offset:3072
ds_read_b64_tr_b16 v[92:93], v245 offset:2048
ds_read_b64_tr_b16 v[94:95], v245 offset:3072
ds_read_b64_tr_b16 v[96:97], v244 offset:3584
ds_read_b64_tr_b16 v[98:99], v244 offset:4608
ds_read_b64_tr_b16 v[100:101], v245 offset:3584
ds_read_b64_tr_b16 v[102:103], v245 offset:4608
ds_read_b64_tr_b16 v[104:105], v244 offset:5632
ds_read_b64_tr_b16 v[106:107], v244 offset:6656
ds_read_b64_tr_b16 v[108:109], v245 offset:5632
ds_read_b64_tr_b16 v[110:111], v245 offset:6656
ds_read_b64_tr_b16 v[112:113], v244 offset:7168
ds_read_b64_tr_b16 v[114:115], v244 offset:8192
ds_read_b64_tr_b16 v[116:117], v245 offset:7168
ds_read_b64_tr_b16 v[118:119], v245 offset:8192
ds_read_b64_tr_b16 v[120:121], v244 offset:9216
ds_read_b64_tr_b16 v[122:123], v244 offset:10240
ds_read_b64_tr_b16 v[124:125], v245 offset:9216
ds_read_b64_tr_b16 v[126:127], v245 offset:10240
ds_read_b64_tr_b16 v[128:129], v244 offset:10752
ds_read_b64_tr_b16 v[130:131], v244 offset:11776
ds_read_b64_tr_b16 v[132:133], v245 offset:10752
ds_read_b64_tr_b16 v[134:135], v245 offset:11776
ds_read_b64_tr_b16 v[136:137], v244 offset:12800
ds_read_b64_tr_b16 v[138:139], v244 offset:13824
ds_read_b64_tr_b16 v[140:141], v245 offset:12800
ds_read_b64_tr_b16 v[142:143], v245 offset:13824
s_waitcnt lgkmcnt(0)
s_waitcnt vmcnt(11)
v_mfma_f32_32x32x16_bf16 v[16:31], v[80:83], v[176:179], 0
v_mfma_f32_32x32x16_bf16 v[32:47], v[84:87], v[176:179], 0
s_waitcnt vmcnt(10)
v_mfma_f32_32x32x16_bf16 v[16:31], v[88:91], v[180:183], v[16:31]
v_mfma_f32_32x32x16_bf16 v[32:47], v[92:95], v[180:183], v[32:47]
s_waitcnt vmcnt(9)
v_mfma_f32_32x32x16_bf16 v[16:31], v[96:99], v[184:187], v[16:31]
v_mfma_f32_32x32x16_bf16 v[32:47], v[100:103], v[184:187], v[32:47]
s_waitcnt vmcnt(8)
v_mfma_f32_32x32x16_bf16 v[16:31], v[104:107], v[188:191], v[16:31]
v_mfma_f32_32x32x16_bf16 v[32:47], v[108:111], v[188:191], v[32:47]
s_waitcnt vmcnt(7)
v_mfma_f32_32x32x16_bf16 v[16:31], v[112:115], v[192:195], v[16:31]
v_mfma_f32_32x32x16_bf16 v[32:47], v[116:119], v[192:195], v[32:47]
s_waitcnt vmcnt(6)
v_mfma_f32_32x32x16_bf16 v[16:31], v[120:123], v[196:199], v[16:31]
v_mfma_f32_32x32x16_bf16 v[32:47], v[124:127], v[196:199], v[32:47]
s_waitcnt vmcnt(5)
v_mfma_f32_32x32x16_bf16 v[16:31], v[128:131], v[200:203], v[16:31]
v_mfma_f32_32x32x16_bf16 v[32:47], v[132:135], v[200:203], v[32:47]
s_waitcnt vmcnt(4)
v_mfma_f32_32x32x16_bf16 v[16:31], v[136:139], v[204:207], v[16:31]
v_mfma_f32_32x32x16_bf16 v[32:47], v[140:143], v[204:207], v[32:47]
C_X_R:
s_waitcnt vmcnt(0)
C_X_C:
v_and_b32 v240, v211, v215
v_and_b32 v241, v227, v239
v_and_b32 v240, v240, v241
v_cmp_le_i32 vcc, 0, v240
s_cbranch_vccz C_X_X
s_sleep 1
s_addk_i32 s53, -1
s_cmp_lt_i32 s53, 0
s_cbranch_scc1 C_X_X
buffer_load_dwordx4 v[208:211], v228, s[24:27], s63 offen sc1
buffer_load_dwordx4 v[212:215], v229, s[24:27], s63 offen sc1
buffer_load_dwordx4 v[224:227], v230, s[24:27], s63 offen sc1
buffer_load_dwordx4 v[236:239], v252, s[24:27], s63 offen sc1
s_branch C_X_R
C_X_X:
v_alignbit_b32 v211, v211, v211, 1
v_alignbit_b32 v210, v210, v210, 1
v_lshlrev_b32 v240, 16, v208
v_and_b32 v241, 0xffff0000, v208
v_pk_add_f32 v[48:49], v[48:49], v[240:241]
v_lshlrev_b32 v242, 16, v209
v_and_b32 v243, 0xffff0000, v209
v_pk_add_f32 v[50:51], v[50:51], v[242:243]
v_lshlrev_b32 v240, 16, v210
v_and_b32 v241, 0xffff0000, v210
v_pk_fma_f32 v[52:53], v[240:241], s[72:73], v[52:53] op_sel:[0,1,0] op_sel_hi:[1,0,1]
v_lshlrev_b32 v242, 16, v211
v_and_b32 v243, 0xffff0000, v211
v_pk_fma_f32 v[54:55], v[242:243], s[70:71], v[54:55]
v_pk_mul_f32 v[48:49], v[48:49], v[144:145]
v_pk_mul_f32 v[50:51], v[50:51], v[146:147]
v_pk_mul_f32 v[52:53], v[52:53], v[148:149]
v_pk_mul_f32 v[54:55], v[54:55], v[150:151]
v_fma_f32 v240, |v53|, s72, 4.0
v_bfi_b32 v53, s74, v240, v53
v_cvt_pk_bf16_f32 v48, v48, v49
v_cvt_pk_bf16_f32 v49, v50, v51
v_cvt_pk_bf16_f32 v50, v52, v53
v_cvt_pk_bf16_f32 v51, v54, v55
v_alignbit_b32 v50, v50, v50, 31
buffer_store_dwordx4 v[48:51], v228, s[24:27], s63 offen sc1
v_alignbit_b32 v215, v215, v215, 1
v_alignbit_b32 v214, v214, v214, 1
v_lshlrev_b32 v240, 16, v212
v_and_b32 v241, 0xffff0000, v212
v_pk_add_f32 v[56:57], v[56:57], v[240:241]
v_lshlrev_b32 v242, 16, v213
v_and_b32 v243, 0xffff0000, v213
v_pk_add_f32 v[58:59], v[58:59], v[242:243]
v_lshlrev_b32 v240, 16, v214
v_and_b32 v241, 0xffff0000, v214
v_pk_fma_f32 v[60:61], v[240:241], s[72:73], v[60:61] op_sel:[0,1,0] op_sel_hi:[1,0,1]
v_lshlrev_b32 v242, 16, v215
v_and_b32 v243, 0xffff0000, v215
v_pk_fma_f32 v[62:63], v[242:243], s[70:71], v[62:63]
v_pk_mul_f32 v[56:57], v[56:57], v[152:153]
v_pk_mul_f32 v[58:59], v[58:59], v[154:155]
v_pk_mul_f32 v[60:61], v[60:61], v[156:157]
v_pk_mul_f32 v[62:63], v[62:63], v[158:159]
v_fma_f32 v240, |v61|, s72, 4.0
v_bfi_b32 v61, s74, v240, v61
v_cvt_pk_bf16_f32 v56, v56, v57
v_cvt_pk_bf16_f32 v57, v58, v59
v_cvt_pk_bf16_f32 v58, v60, v61
v_cvt_pk_bf16_f32 v59, v62, v63
v_alignbit_b32 v58, v58, v58, 31
buffer_store_dwordx4 v[56:59], v229, s[24:27], s63 offen sc1
v_alignbit_b32 v227, v227, v227, 1
v_alignbit_b32 v226, v226, v226, 1
v_lshlrev_b32 v240, 16, v224
v_and_b32 v241, 0xffff0000, v224
v_pk_add_f32 v[64:65], v[64:65], v[240:241]
v_lshlrev_b32 v242, 16, v225
v_and_b32 v243, 0xffff0000, v225
v_pk_add_f32 v[66:67], v[66:67], v[242:243]
v_lshlrev_b32 v240, 16, v226
v_and_b32 v241, 0xffff0000, v226
v_pk_fma_f32 v[68:69], v[240:241], s[72:73], v[68:69] op_sel:[0,1,0] op_sel_hi:[1,0,1]
v_lshlrev_b32 v242, 16, v227
v_and_b32 v243, 0xffff0000, v227
v_pk_fma_f32 v[70:71], v[242:243], s[70:71], v[70:71]
v_pk_mul_f32 v[64:65], v[64:65], v[160:161]
v_pk_mul_f32 v[66:67], v[66:67], v[162:163]
v_pk_mul_f32 v[68:69], v[68:69], v[164:165]
v_pk_mul_f32 v[70:71], v[70:71], v[166:167]
v_fma_f32 v240, |v69|, s72, 4.0
v_bfi_b32 v69, s74, v240, v69
v_cvt_pk_bf16_f32 v64, v64, v65
v_cvt_pk_bf16_f32 v65, v66, v67
v_cvt_pk_bf16_f32 v66, v68, v69
v_cvt_pk_bf16_f32 v67, v70, v71
v_alignbit_b32 v66, v66, v66, 31
buffer_store_dwordx4 v[64:67], v230, s[24:27], s63 offen sc1
v_alignbit_b32 v239, v239, v239, 1
v_alignbit_b32 v238, v238, v238, 1
v_lshlrev_b32 v240, 16, v236
v_and_b32 v241, 0xffff0000, v236
v_pk_add_f32 v[72:73], v[72:73], v[240:241]
v_lshlrev_b32 v242, 16, v237
v_and_b32 v243, 0xffff0000, v237
v_pk_add_f32 v[74:75], v[74:75], v[242:243]
v_lshlrev_b32 v240, 16, v238
v_and_b32 v241, 0xffff0000, v238
v_pk_fma_f32 v[76:77], v[240:241], s[72:73], v[76:77] op_sel:[0,1,0] op_sel_hi:[1,0,1]
v_lshlrev_b32 v242, 16, v239
v_and_b32 v243, 0xffff0000, v239
v_pk_fma_f32 v[78:79], v[242:243], s[70:71], v[78:79]
v_pk_mul_f32 v[72:73], v[72:73], v[168:169]
v_pk_mul_f32 v[74:75], v[74:75], v[170:171]
v_pk_mul_f32 v[76:77], v[76:77], v[172:173]
v_pk_mul_f32 v[78:79], v[78:79], v[174:175]
v_fma_f32 v240, |v77|, s72, 4.0
v_bfi_b32 v77, s74, v240, v77
v_cvt_pk_bf16_f32 v72, v72, v73
v_cvt_pk_bf16_f32 v73, v74, v75
v_cvt_pk_bf16_f32 v74, v76, v77
v_cvt_pk_bf16_f32 v75, v78, v79
v_alignbit_b32 v74, v74, v74, 31
buffer_store_dwordx4 v[72:75], v252, s[24:27], s63 offen sc1
v_mov_b32 v240, 1
s_mov_b64 exec, 1
s_waitcnt vmcnt(4)
buffer_store_dword v240, v234, s[24:27], s40 offen sc1
s_mov_b64 exec, -1
s_setprio 0
s_cmp_lg_u32 s31, 0
s_cbranch_scc1 L_H_S
s_lshl_b32 s33, s46, 9
s_add_u32 s33, s33, 15761408
s_add_u32 s34, s33, 128
s_add_u32 s35, s33, 256
s_add_u32 s36, s33, 384
s_buffer_load_dwordx8 s[56:63], s[24:27], s33 glc
s_buffer_load_dwordx8 s[64:71], s[24:27], s34 glc
s_buffer_load_dwordx8 s[72:79], s[24:27], s35 glc
s_buffer_load_dwordx4 s[8:11], s[24:27], s36 glc
L_H_S:
s_mul_i32 s47, s31, 14
s_bfe_u32 s51, s46, 0x20002
s_lshl_b32 s51, s51, 1
s_and_b32 s52, s46, 1
s_add_u32 s51, s51, s52
s_lshl2_add_u32 s51, s51, s32
s_lshl_b32 s51, s51, 1
s_lshr_b32 s52, s46, 4
s_and_b32 s38, s46, 2
s_lshl2_add_u32 s52, s52, s38
s_or_b32 s52, s52, 1
v_min_u32 v176, 13, v1
v_add_u32 v176, s47, v176
v_lshrrev_b32 v177, 3, v176
v_lshl_add_u32 v177, v177, 6, s51
v_and_b32 v178, 2, v176
v_lshl_add_u32 v177, v178, 1, v177
v_and_b32 v178, 1, v176
v_add_u32 v177, v177, v178
v_bfe_u32 v178, v176, 2, 1
v_xor_b32 v178, s52, v178
v_cmp_le_u32 vcc, 224, v177
v_subrev_u32 v176, 224, v177
s_nop 0
v_cndmask_b32 v177, v177, v176, vcc
v_cndmask_b32 v179, 14, 7, vcc
v_cndmask_b32 v176, 1, 2, vcc
v_lshlrev_b32 v180, v176, v177
v_mul_u32_u24 v180, 9363, v180
v_lshrrev_b32 v180, 16, v180
v_lshlrev_b32 v177, 2, v177
v_mad_u32_u24 v191, v180, v179, v179
v_sub_u32 v191, v191, v177
v_min_u32 v191, 4, v191
v_sub_u32 v191, 4, v191
v_lshlrev_b32 v191, 8, v191
v_mul_u32_u24 v189, 1792, v179
v_mad_u32_u24 v178, v180, 7, v178
v_mad_u32_u24 v190, v178, v179, v177
v_lshrrev_b32 v176, 1, v176
v_lshl_add_u32 v190, v176, 13, v190
v_lshlrev_b32 v190, 8, v190
s_nop 0
v_readlane_b32 s38, v191, 1
v_readlane_b32 s39, v189, 1
v_readlane_b32 s42, v190, 1
v_readlane_b32 s43, v191, 2
v_readlane_b32 s44, v189, 2
v_readlane_b32 s45, v190, 2
v_add_u32 v176, s38, v14
v_lshrrev_b32 v176, 10, v176
v_mad_u32_u24 v176, v176, s39, v14
v_add_u32 v176, s42, v176
v_readlane_b32 s38, v191, 3
v_readlane_b32 s39, v189, 3
v_readlane_b32 s42, v190, 3
v_add_u32 v177, s43, v14
v_lshrrev_b32 v177, 10, v177
v_mad_u32_u24 v177, v177, s44, v14
v_add_u32 v177, s45, v177
v_readlane_b32 s43, v191, 4
v_readlane_b32 s44, v189, 4
v_readlane_b32 s45, v190, 4
v_add_u32 v178, s38, v14
v_lshrrev_b32 v178, 10, v178
v_mad_u32_u24 v178, v178, s39, v14
v_add_u32 v178, s42, v178
v_readlane_b32 s38, v191, 5
v_readlane_b32 s39, v189, 5
v_readlane_b32 s42, v190, 5
v_add_u32 v179, s43, v14
v_lshrrev_b32 v179, 10, v179
v_mad_u32_u24 v179, v179, s44, v14
v_add_u32 v179, s45, v179
v_readlane_b32 s43, v191, 6
v_readlane_b32 s44, v189, 6
v_readlane_b32 s45, v190, 6
v_add_u32 v180, s38, v14
v_lshrrev_b32 v180, 10, v180
v_mad_u32_u24 v180, v180, s39, v14
v_add_u32 v180, s42, v180
v_readlane_b32 s38, v191, 7
v_readlane_b32 s39, v189, 7
v_readlane_b32 s42, v190, 7
v_add_u32 v181, s43, v14
v_lshrrev_b32 v181, 10, v181
v_mad_u32_u24 v181, v181, s44, v14
v_add_u32 v181, s45, v181
v_readlane_b32 s43, v191, 8
v_readlane_b32 s44, v189, 8
v_readlane_b32 s45, v190, 8
v_add_u32 v182, s38, v14
v_lshrrev_b32 v182, 10, v182
v_mad_u32_u24 v182, v182, s39, v14
v_add_u32 v182, s42, v182
v_readlane_b32 s38, v191, 9
v_readlane_b32 s39, v189, 9
v_readlane_b32 s42, v190, 9
v_add_u32 v183, s43, v14
v_lshrrev_b32 v183, 10, v183
v_mad_u32_u24 v183, v183, s44, v14
v_add_u32 v183, s45, v183
v_readlane_b32 s43, v191, 10
v_readlane_b32 s44, v189, 10
v_readlane_b32 s45, v190, 10
v_add_u32 v184, s38, v14
v_lshrrev_b32 v184, 10, v184
v_mad_u32_u24 v184, v184, s39, v14
v_add_u32 v184, s42, v184
v_readlane_b32 s38, v191, 11
v_readlane_b32 s39, v189, 11
v_readlane_b32 s42, v190, 11
v_add_u32 v185, s43, v14
v_lshrrev_b32 v185, 10, v185
v_mad_u32_u24 v185, v185, s44, v14
v_add_u32 v185, s45, v185
v_readlane_b32 s43, v191, 12
v_readlane_b32 s44, v189, 12
v_readlane_b32 s45, v190, 12
v_add_u32 v186, s38, v14
v_lshrrev_b32 v186, 10, v186
v_mad_u32_u24 v186, v186, s39, v14
v_add_u32 v186, s42, v186
v_readlane_b32 s38, v191, 13
v_readlane_b32 s39, v189, 13
v_readlane_b32 s42, v190, 13
v_add_u32 v187, s43, v14
v_lshrrev_b32 v187, 10, v187
v_mad_u32_u24 v187, v187, s44, v14
v_add_u32 v187, s45, v187
v_readlane_b32 s43, v191, 0
v_readlane_b32 s44, v189, 0
v_readlane_b32 s45, v190, 0
v_add_u32 v188, s38, v14
v_lshrrev_b32 v188, 10, v188
v_mad_u32_u24 v188, v188, s39, v14
v_add_u32 v188, s42, v188
s_nop 1
v_add_u32 v189, s43, v14
v_lshrrev_b32 v189, 10, v189
v_mad_u32_u24 v189, v189, s44, v14
v_add_u32 v189, s45, v189
s_cmp_lg_u32 s31, 0
s_cbranch_scc1 L_H_X
s_branch L_H_C
L_H_R:
s_buffer_load_dwordx8 s[56:63], s[24:27], s33 glc
s_buffer_load_dwordx8 s[64:71], s[24:27], s34 glc
s_buffer_load_dwordx8 s[72:79], s[24:27], s35 glc
s_buffer_load_dwordx4 s[8:11], s[24:27], s36 glc
L_H_C:
s_waitcnt lgkmcnt(0)
s_and_b64 s[56:57], s[56:57], s[58:59]
s_and_b64 s[56:57], s[56:57], s[60:61]
s_and_b64 s[56:57], s[56:57], s[62:63]
s_and_b64 s[56:57], s[56:57], s[64:65]
s_and_b64 s[56:57], s[56:57], s[66:67]
s_and_b64 s[56:57], s[56:57], s[68:69]
s_and_b64 s[56:57], s[56:57], s[70:71]
s_and_b64 s[56:57], s[56:57], s[72:73]
s_and_b64 s[56:57], s[56:57], s[74:75]
s_and_b64 s[56:57], s[56:57], s[76:77]
s_and_b64 s[56:57], s[56:57], s[78:79]
s_and_b64 s[56:57], s[56:57], s[8:9]
s_and_b64 s[56:57], s[56:57], s[10:11]
s_and_b32 s56, s56, s57
s_cbranch_scc1 L_H_X

s_addk_i32 s53, -1
s_cmp_lt_i32 s53, 0
s_cbranch_scc0 L_H_R
L_H_X:
P3_GO:
s_barrier
buffer_load_dwordx4 v[80:83], v176, s[24:27], s41 offen sc1
buffer_load_dwordx4 v[84:87], v177, s[24:27], s41 offen sc1
buffer_load_dwordx4 v[88:91], v178, s[24:27], s41 offen sc1
buffer_load_dwordx4 v[92:95], v179, s[24:27], s41 offen sc1
s_waitcnt vmcnt(4)
s_barrier
ds_read_b64_tr_b16 v[192:193], v248 offset:8192
ds_read_b64_tr_b16 v[194:195], v248 offset:9216
ds_read_b64_tr_b16 v[196:197], v249 offset:8192
ds_read_b64_tr_b16 v[198:199], v249 offset:9216
ds_read_b64_tr_b16 v[200:201], v248 offset:16384
ds_read_b64_tr_b16 v[202:203], v248 offset:17408
ds_read_b64_tr_b16 v[204:205], v249 offset:16384
ds_read_b64_tr_b16 v[206:207], v249 offset:17408
buffer_load_dwordx4 v[96:99], v180, s[24:27], s41 offen sc1
buffer_load_dwordx4 v[100:103], v181, s[24:27], s41 offen sc1
buffer_load_dwordx4 v[104:107], v182, s[24:27], s41 offen sc1
buffer_load_dwordx4 v[108:111], v183, s[24:27], s41 offen sc1
s_waitcnt lgkmcnt(4)
s_waitcnt vmcnt(7)
P3_R0:
v_cmp_le_i32 vcc, 0, v82
v_alignbit_b32 v82, v82, v82, 1
v_subrev_u32 v82, 0x20000000, v82
s_cbranch_vccnz P3_W0
P3_X0:
s_nop 0
v_mfma_f32_32x32x16_bf16 v[16:31], v[192:195], v[80:83], v[16:31]
ds_read_b64_tr_b16 v[208:209], v248 offset:24576
ds_read_b64_tr_b16 v[210:211], v248 offset:25600
buffer_load_dwordx4 v[112:115], v184, s[24:27], s41 offen sc1
s_waitcnt vmcnt(7)
P3_R1:
v_cmp_le_i32 vcc, 0, v86
v_alignbit_b32 v86, v86, v86, 1
v_subrev_u32 v86, 0x20000000, v86
s_cbranch_vccnz P3_W1
P3_X1:
v_mfma_f32_32x32x16_bf16 v[32:47], v[196:199], v[80:83], v[32:47]
ds_read_b64_tr_b16 v[212:213], v249 offset:24576
ds_read_b64_tr_b16 v[214:215], v249 offset:25600
s_waitcnt lgkmcnt(4)
v_mfma_f32_32x32x16_bf16 v[16:31], v[200:203], v[84:87], v[16:31]
ds_read_b64_tr_b16 v[192:193], v248 offset:32768
ds_read_b64_tr_b16 v[194:195], v248 offset:33792
buffer_load_dwordx4 v[116:119], v185, s[24:27], s41 offen sc1
s_waitcnt vmcnt(7)
P3_R2:
v_cmp_le_i32 vcc, 0, v90
v_alignbit_b32 v90, v90, v90, 1
v_subrev_u32 v90, 0x20000000, v90
s_cbranch_vccnz P3_W2
P3_X2:
v_mfma_f32_32x32x16_bf16 v[32:47], v[204:207], v[84:87], v[32:47]
ds_read_b64_tr_b16 v[196:197], v249 offset:32768
ds_read_b64_tr_b16 v[198:199], v249 offset:33792
s_waitcnt lgkmcnt(4)
v_mfma_f32_32x32x16_bf16 v[16:31], v[208:211], v[88:91], v[16:31]
ds_read_b64_tr_b16 v[200:201], v246 offset:8192
ds_read_b64_tr_b16 v[202:203], v246 offset:9216
buffer_load_dwordx4 v[120:123], v186, s[24:27], s41 offen sc1
s_waitcnt vmcnt(7)
P3_R3:
v_cmp_le_i32 vcc, 0, v94
v_alignbit_b32 v94, v94, v94, 1
v_subrev_u32 v94, 0x20000000, v94
s_cbranch_vccnz P3_W3
P3_X3:
v_mfma_f32_32x32x16_bf16 v[32:47], v[212:215], v[88:91], v[32:47]
ds_read_b64_tr_b16 v[204:205], v247 offset:8192
ds_read_b64_tr_b16 v[206:207], v247 offset:9216
s_waitcnt lgkmcnt(4)
v_mfma_f32_32x32x16_bf16 v[16:31], v[192:195], v[92:95], v[16:31]
ds_read_b64_tr_b16 v[208:209], v246 offset:16384
ds_read_b64_tr_b16 v[210:211], v246 offset:17408
buffer_load_dwordx4 v[124:127], v187, s[24:27], s41 offen sc1
s_waitcnt vmcnt(7)
P3_R4:
v_cmp_le_i32 vcc, 0, v98
v_alignbit_b32 v98, v98, v98, 1
v_subrev_u32 v98, 0x20000000, v98
s_cbranch_vccnz P3_W4
P3_X4:
v_mfma_f32_32x32x16_bf16 v[32:47], v[196:199], v[92:95], v[32:47]
ds_read_b64_tr_b16 v[212:213], v247 offset:16384
ds_read_b64_tr_b16 v[214:215], v247 offset:17408
s_waitcnt lgkmcnt(4)
v_mfma_f32_32x32x16_bf16 v[16:31], v[200:203], v[96:99], v[16:31]
ds_read_b64_tr_b16 v[192:193], v246 offset:24576
ds_read_b64_tr_b16 v[194:195], v246 offset:25600
buffer_load_dwordx4 v[128:131], v188, s[24:27], s41 offen sc1
s_waitcnt vmcnt(7)
P3_R5:
v_cmp_le_i32 vcc, 0, v102
v_alignbit_b32 v102, v102, v102, 1
v_subrev_u32 v102, 0x20000000, v102
s_cbranch_vccnz P3_W5
P3_X5:
v_mfma_f32_32x32x16_bf16 v[32:47], v[204:207], v[96:99], v[32:47]
ds_read_b64_tr_b16 v[196:197], v247 offset:24576
ds_read_b64_tr_b16 v[198:199], v247 offset:25600
s_waitcnt lgkmcnt(4)
v_mfma_f32_32x32x16_bf16 v[16:31], v[208:211], v[100:103], v[16:31]
ds_read_b64_tr_b16 v[200:201], v246 offset:32768
ds_read_b64_tr_b16 v[202:203], v246 offset:33792
buffer_load_dwordx4 v[132:135], v189, s[24:27], s41 offen sc1
s_waitcnt vmcnt(7)
P3_R6:
v_cmp_le_i32 vcc, 0, v106
v_alignbit_b32 v106, v106, v106, 1
v_subrev_u32 v106, 0x20000000, v106
s_cbranch_vccnz P3_W6
P3_X6:
v_mfma_f32_32x32x16_bf16 v[32:47], v[212:215], v[100:103], v[32:47]
ds_read_b64_tr_b16 v[204:205], v247 offset:32768
ds_read_b64_tr_b16 v[206:207], v247 offset:33792
s_waitcnt lgkmcnt(4)
v_mfma_f32_32x32x16_bf16 v[16:31], v[192:195], v[104:107], v[16:31]
ds_read_b64_tr_b16 v[208:209], v246 offset:40960
ds_read_b64_tr_b16 v[210:211], v246 offset:41984
s_waitcnt vmcnt(6)
P3_R7:
v_cmp_le_i32 vcc, 0, v110
v_alignbit_b32 v110, v110, v110, 1
v_subrev_u32 v110, 0x20000000, v110
s_cbranch_vccnz P3_W7
P3_X7:
v_mfma_f32_32x32x16_bf16 v[32:47], v[196:199], v[104:107], v[32:47]
ds_read_b64_tr_b16 v[212:213], v247 offset:40960
ds_read_b64_tr_b16 v[214:215], v247 offset:41984
s_waitcnt lgkmcnt(4)
v_mfma_f32_32x32x16_bf16 v[16:31], v[200:203], v[108:111], v[16:31]
ds_read_b64_tr_b16 v[192:193], v246 offset:49152
ds_read_b64_tr_b16 v[194:195], v246 offset:50176
s_waitcnt vmcnt(5)
P3_R8:
v_cmp_le_i32 vcc, 0, v114
v_alignbit_b32 v114, v114, v114, 1
v_subrev_u32 v114, 0x20000000, v114
s_cbranch_vccnz P3_W8
P3_X8:
v_mfma_f32_32x32x16_bf16 v[32:47], v[204:207], v[108:111], v[32:47]
ds_read_b64_tr_b16 v[196:197], v247 offset:49152
ds_read_b64_tr_b16 v[198:199], v247 offset:50176
s_waitcnt lgkmcnt(4)
v_mfma_f32_32x32x16_bf16 v[16:31], v[208:211], v[112:115], v[16:31]
ds_read_b64_tr_b16 v[200:201], v246 offset:57344
ds_read_b64_tr_b16 v[202:203], v246 offset:58368
s_waitcnt vmcnt(4)
P3_R9:
v_cmp_le_i32 vcc, 0, v118
v_alignbit_b32 v118, v118, v118, 1
v_subrev_u32 v118, 0x20000000, v118
s_cbranch_vccnz P3_W9
P3_X9:
v_mfma_f32_32x32x16_bf16 v[32:47], v[212:215], v[112:115], v[32:47]
ds_read_b64_tr_b16 v[204:205], v247 offset:57344
ds_read_b64_tr_b16 v[206:207], v247 offset:58368
s_waitcnt lgkmcnt(4)
v_mfma_f32_32x32x16_bf16 v[16:31], v[192:195], v[116:119], v[16:31]
ds_read_b64_tr_b16 v[208:209], v248 offset:0
ds_read_b64_tr_b16 v[210:211], v248 offset:1024
s_waitcnt vmcnt(3)
P3_R10:
v_cmp_le_i32 vcc, 0, v122
v_alignbit_b32 v122, v122, v122, 1
v_subrev_u32 v122, 0x20000000, v122
s_cbranch_vccnz P3_W10
P3_X10:
v_mfma_f32_32x32x16_bf16 v[32:47], v[196:199], v[116:119], v[32:47]
ds_read_b64_tr_b16 v[212:213], v249 offset:0
ds_read_b64_tr_b16 v[214:215], v249 offset:1024
buffer_load_dwordx4 v[224:227], v250, s[12:15], s48 offen
s_waitcnt lgkmcnt(4)
v_mfma_f32_32x32x16_bf16 v[16:31], v[200:203], v[120:123], v[16:31]
ds_read_b64_tr_b16 v[192:193], v246 offset:0
ds_read_b64_tr_b16 v[194:195], v246 offset:1024
s_waitcnt vmcnt(3)
P3_R11:
v_cmp_le_i32 vcc, 0, v126
v_alignbit_b32 v126, v126, v126, 1
v_subrev_u32 v126, 0x20000000, v126
s_cbranch_vccnz P3_W11
P3_X11:
v_mfma_f32_32x32x16_bf16 v[32:47], v[204:207], v[120:123], v[32:47]
ds_read_b64_tr_b16 v[196:197], v247 offset:0
ds_read_b64_tr_b16 v[198:199], v247 offset:1024
s_waitcnt lgkmcnt(4)
v_mfma_f32_32x32x16_bf16 v[16:31], v[208:211], v[124:127], v[16:31]
s_waitcnt vmcnt(2)
P3_R12:
v_cmp_le_i32 vcc, 0, v130
v_alignbit_b32 v130, v130, v130, 1
v_subrev_u32 v130, 0x20000000, v130
s_cbranch_vccnz P3_W12
P3_X12:
v_mfma_f32_32x32x16_bf16 v[32:47], v[212:215], v[124:127], v[32:47]
s_waitcnt lgkmcnt(0)
v_mfma_f32_32x32x16_bf16 v[16:31], v[192:195], v[128:131], v[16:31]
s_waitcnt vmcnt(1)
P3_R13:
v_cmp_le_i32 vcc, 0, v134
v_alignbit_b32 v134, v134, v134, 1
v_subrev_u32 v134, 0x20000000, v134
s_cbranch_vccnz P3_W13
P3_X13:
v_mfma_f32_32x32x16_bf16 v[32:47], v[196:199], v[128:131], v[32:47]
v_mfma_f32_32x32x16_bf16 v[16:31], v[216:219], v[132:135], v[16:31]
v_mfma_f32_32x32x16_bf16 v[32:47], v[220:223], v[132:135], v[32:47]
s_waitcnt vmcnt(0)
s_xor_b32 s33, s30, 1
s_mul_i32 s33, s33, 6144
v_add_u32 v193, s33, v14
s_xor_b32 s33, s30, 2
s_mul_i32 s33, s33, 6144
v_add_u32 v194, s33, v14
s_xor_b32 s33, s30, 3
s_mul_i32 s33, s33, 6144
v_add_u32 v195, s33, v14
s_mul_i32 s33, s30, 6144
v_add_u32 v192, s33, v14
v_lshlrev_b32 v48, 16, v224
v_and_b32 v49, 0xffff0000, v224
v_lshlrev_b32 v50, 16, v225
v_and_b32 v51, 0xffff0000, v225
v_lshlrev_b32 v52, 16, v226
v_and_b32 v53, 0xffff0000, v226
v_lshlrev_b32 v54, 16, v227
v_and_b32 v55, 0xffff0000, v227
ds_write_b128 v193, v[24:27] offset:0
ds_write_b128 v193, v[28:31] offset:1024
ds_write_b128 v194, v[32:35] offset:2048
ds_write_b128 v194, v[36:39] offset:3072
ds_write_b128 v195, v[40:43] offset:4096
ds_write_b128 v195, v[44:47] offset:5120
s_waitcnt lgkmcnt(0)
s_barrier
ds_read_b128 v[24:27], v192 offset:0
ds_read_b128 v[28:31], v192 offset:1024
ds_read_b128 v[32:35], v192 offset:2048
ds_read_b128 v[36:39], v192 offset:3072
ds_read_b128 v[40:43], v192 offset:4096
ds_read_b128 v[44:47], v192 offset:5120
s_waitcnt lgkmcnt(4)
v_pk_add_f32 v[16:17], v[16:17], v[24:25]
v_pk_add_f32 v[18:19], v[18:19], v[26:27]
v_pk_add_f32 v[20:21], v[20:21], v[28:29]
v_pk_add_f32 v[22:23], v[22:23], v[30:31]
s_waitcnt lgkmcnt(2)
v_pk_add_f32 v[16:17], v[16:17], v[32:33]
v_pk_add_f32 v[18:19], v[18:19], v[34:35]
v_pk_add_f32 v[20:21], v[20:21], v[36:37]
v_pk_add_f32 v[22:23], v[22:23], v[38:39]
s_waitcnt lgkmcnt(0)
v_pk_add_f32 v[16:17], v[16:17], v[40:41]
v_pk_add_f32 v[18:19], v[18:19], v[42:43]
v_pk_add_f32 v[20:21], v[20:21], v[44:45]
v_pk_add_f32 v[22:23], v[22:23], v[46:47]
s_nop 1
v_permlane32_swap_b32 v16, v20
v_permlane32_swap_b32 v17, v21
v_permlane32_swap_b32 v18, v22
v_permlane32_swap_b32 v19, v23
v_pk_add_f32 v[16:17], v[16:17], v[48:49]
v_pk_add_f32 v[18:19], v[18:19], v[50:51]
v_pk_add_f32 v[20:21], v[20:21], v[52:53]
v_pk_add_f32 v[22:23], v[22:23], v[54:55]
v_cvt_pk_bf16_f32 v224, v16, v17
v_cvt_pk_bf16_f32 v225, v18, v19
v_cvt_pk_bf16_f32 v226, v20, v21
v_cvt_pk_bf16_f32 v227, v22, v23
buffer_store_dwordx4 v[224:227], v250, s[4:7], s48 offen
s_endpgm
L_T1_W:
s_sleep 2
s_buffer_load_dwordx4 s[72:75], s[24:27], s52 glc
s_addk_i32 s53, -1
s_cmp_lt_i32 s53, 0
s_cbranch_scc0 L_T1_R
s_waitcnt lgkmcnt(0)
s_branch L_T1_G
L_Z2_W:
s_sleep 2
s_buffer_load_dwordx2 s[72:73], s[24:27], s41 glc
s_waitcnt lgkmcnt(0)
s_and_b32 s72, s72, s73
s_cbranch_scc1 L_Z2_X
s_addk_i32 s53, -1
s_cmp_lt_i32 s53, 0
s_cbranch_scc0 L_Z2_W
s_branch L_Z2_X
L_Z3_W:
s_sleep 2
s_buffer_load_dwordx2 s[72:73], s[24:27], s41 glc
s_waitcnt lgkmcnt(0)
s_and_b32 s72, s72, s73
s_cbranch_scc1 L_Z3_X
s_addk_i32 s53, -1
s_cmp_lt_i32 s53, 0
s_cbranch_scc0 L_Z3_W
s_branch L_Z3_X
L_Z4_W:
s_sleep 2
s_buffer_load_dwordx2 s[72:73], s[24:27], s41 glc
s_waitcnt lgkmcnt(0)
s_and_b32 s72, s72, s73
s_cbranch_scc1 L_Z4_X
s_addk_i32 s53, -1
s_cmp_lt_i32 s53, 0
s_cbranch_scc0 L_Z4_W
s_branch L_Z4_X
L_Z5_W:
s_sleep 2
s_buffer_load_dwordx2 s[72:73], s[24:27], s41 glc
s_waitcnt lgkmcnt(0)
s_and_b32 s72, s72, s73
s_cbranch_scc1 L_Z5_X
s_addk_i32 s53, -1
s_cmp_lt_i32 s53, 0
s_cbranch_scc0 L_Z5_W
s_branch L_Z5_X
L_Z6_W:
s_sleep 2
s_buffer_load_dwordx2 s[72:73], s[24:27], s41 glc
s_waitcnt lgkmcnt(0)
s_and_b32 s72, s72, s73
s_cbranch_scc1 L_Z6_X
s_addk_i32 s53, -1
s_cmp_lt_i32 s53, 0
s_cbranch_scc0 L_Z6_W
s_branch L_Z6_X
L_Z7_W:
s_sleep 2
s_buffer_load_dwordx2 s[72:73], s[24:27], s41 glc
s_waitcnt lgkmcnt(0)
s_and_b32 s72, s72, s73
s_cbranch_scc1 L_Z7_X
s_addk_i32 s53, -1
s_cmp_lt_i32 s53, 0
s_cbranch_scc0 L_Z7_W
s_branch L_Z7_X
L_4_W:
s_addk_i32 s53, -1
s_cmp_lt_i32 s53, 0
s_cbranch_scc1 L_4_X
buffer_load_dword v10, v13, s[24:27], s43 offen sc1
s_waitcnt vmcnt(0)
s_branch L_4_R
P3_W0:
s_addk_i32 s53, -1
s_cmp_lt_i32 s53, 0
s_cbranch_scc1 P3_X0
buffer_load_dwordx4 v[80:83], v176, s[24:27], s41 offen sc1
s_waitcnt vmcnt(0)
s_branch P3_R0
P3_W1:
s_addk_i32 s53, -1
s_cmp_lt_i32 s53, 0
s_cbranch_scc1 P3_X1
buffer_load_dwordx4 v[84:87], v177, s[24:27], s41 offen sc1
s_waitcnt vmcnt(0)
s_branch P3_R1
P3_W2:
s_addk_i32 s53, -1
s_cmp_lt_i32 s53, 0
s_cbranch_scc1 P3_X2
buffer_load_dwordx4 v[88:91], v178, s[24:27], s41 offen sc1
s_waitcnt vmcnt(0)
s_branch P3_R2
P3_W3:
s_addk_i32 s53, -1
s_cmp_lt_i32 s53, 0
s_cbranch_scc1 P3_X3
buffer_load_dwordx4 v[92:95], v179, s[24:27], s41 offen sc1
s_waitcnt vmcnt(0)
s_branch P3_R3
P3_W4:
s_addk_i32 s53, -1
s_cmp_lt_i32 s53, 0
s_cbranch_scc1 P3_X4
buffer_load_dwordx4 v[96:99], v180, s[24:27], s41 offen sc1
s_waitcnt vmcnt(0)
s_branch P3_R4
P3_W5:
s_addk_i32 s53, -1
s_cmp_lt_i32 s53, 0
s_cbranch_scc1 P3_X5
buffer_load_dwordx4 v[100:103], v181, s[24:27], s41 offen sc1
s_waitcnt vmcnt(0)
s_branch P3_R5
P3_W6:
s_addk_i32 s53, -1
s_cmp_lt_i32 s53, 0
s_cbranch_scc1 P3_X6
buffer_load_dwordx4 v[104:107], v182, s[24:27], s41 offen sc1
s_waitcnt vmcnt(0)
s_branch P3_R6
P3_W7:
s_addk_i32 s53, -1
s_cmp_lt_i32 s53, 0
s_cbranch_scc1 P3_X7
buffer_load_dwordx4 v[108:111], v183, s[24:27], s41 offen sc1
s_waitcnt vmcnt(0)
s_branch P3_R7
P3_W8:
s_addk_i32 s53, -1
s_cmp_lt_i32 s53, 0
s_cbranch_scc1 P3_X8
buffer_load_dwordx4 v[112:115], v184, s[24:27], s41 offen sc1
s_waitcnt vmcnt(0)
s_branch P3_R8
P3_W9:
s_addk_i32 s53, -1
s_cmp_lt_i32 s53, 0
s_cbranch_scc1 P3_X9
buffer_load_dwordx4 v[116:119], v185, s[24:27], s41 offen sc1
s_waitcnt vmcnt(0)
s_branch P3_R9
P3_W10:
s_addk_i32 s53, -1
s_cmp_lt_i32 s53, 0
s_cbranch_scc1 P3_X10
buffer_load_dwordx4 v[120:123], v186, s[24:27], s41 offen sc1
s_waitcnt vmcnt(0)
s_branch P3_R10
P3_W11:
s_addk_i32 s53, -1
s_cmp_lt_i32 s53, 0
s_cbranch_scc1 P3_X11
buffer_load_dwordx4 v[124:127], v187, s[24:27], s41 offen sc1
s_waitcnt vmcnt(0)
s_branch P3_R11
P3_W12:
s_addk_i32 s53, -1
s_cmp_lt_i32 s53, 0
s_cbranch_scc1 P3_X12
buffer_load_dwordx4 v[128:131], v188, s[24:27], s41 offen sc1
s_waitcnt vmcnt(0)
s_branch P3_R12
P3_W13:
s_addk_i32 s53, -1
s_cmp_lt_i32 s53, 0
s_cbranch_scc1 P3_X13
buffer_load_dwordx4 v[132:135], v189, s[24:27], s41 offen sc1
s_waitcnt vmcnt(0)
s_branch P3_R13
P1_A_CW:
s_addk_i32 s53, -1
s_cmp_lt_i32 s53, 0
s_cbranch_scc1 P1_A_CX
v_lshrrev_b32 v2, 1, v253
buffer_load_dword v2, v2, s[4:7], 0 offen sc1
s_waitcnt vmcnt(0)
s_branch P1_A_CR
P1_A_PW:
s_sleep 3
s_addk_i32 s53, -1
s_cmp_lt_i32 s53, 0
s_cbranch_scc1 P1_A_PX
v_cmp_eq_u32 vcc, -1, v3
s_cbranch_vccz P1_A_PS0
s_mov_b64 exec, vcc
buffer_load_dwordx2 v[2:3], v253, s[24:27], s10 offen offset:0 sc1
s_mov_b64 exec, -1
P1_A_PS0:
v_cmp_eq_u32 vcc, -1, v5
s_cbranch_vccz P1_A_PS1
s_mov_b64 exec, vcc
buffer_load_dwordx2 v[4:5], v253, s[24:27], s10 offen offset:512 sc1
s_mov_b64 exec, -1
P1_A_PS1:
v_cmp_eq_u32 vcc, -1, v7
s_cbranch_vccz P1_A_PS2
s_mov_b64 exec, vcc
buffer_load_dwordx2 v[6:7], v253, s[24:27], s10 offen offset:1024 sc1
s_mov_b64 exec, -1
P1_A_PS2:
v_cmp_eq_u32 vcc, -1, v9
s_cbranch_vccz P1_A_PS3
s_mov_b64 exec, vcc
buffer_load_dwordx2 v[8:9], v253, s[24:27], s10 offen offset:1536 sc1
s_mov_b64 exec, -1
P1_A_PS3:
v_cmp_eq_u32 vcc, -1, v245
s_cbranch_vccz P1_A_PS4
s_mov_b64 exec, vcc
buffer_load_dwordx2 v[244:245], v253, s[24:27], s10 offen offset:2048 sc1
s_mov_b64 exec, -1
P1_A_PS4:
v_cmp_eq_u32 vcc, -1, v247
s_cbranch_vccz P1_A_PS5
s_mov_b64 exec, vcc
buffer_load_dwordx2 v[246:247], v253, s[24:27], s10 offen offset:2560 sc1
s_mov_b64 exec, -1
P1_A_PS5:
v_cmp_eq_u32 vcc, -1, v229
s_cbranch_vccz P1_A_PS6
s_mov_b64 exec, vcc
buffer_load_dwordx2 v[228:229], v253, s[24:27], s10 offen offset:3072 sc1
s_mov_b64 exec, -1
P1_A_PS6:
s_waitcnt vmcnt(0)
s_branch P1_A_PR
P1_AL:
s_mov_b32 s12, s74
s_and_b32 s13, s75, 0xffff
s_mov_b32 s14, 8388608
s_mov_b32 s15, 0x20000
s_waitcnt lgkmcnt(6)
v_mfma_f32_32x32x16_bf16 v[144:159], v[176:179], v[16:19], 0
ds_read_b64_tr_b16 v[192:193], v10 offset:8192
ds_read_b64_tr_b16 v[194:195], v10 offset:8704
v_lshrrev_b32 v2, 1, v253
buffer_load_dword v2, v2, s[4:7], 0 offen sc1
buffer_load_dword v255, v0, s[12:15], s8 offen offset:0
v_mfma_f32_16x16x32_bf16 v[220:223], v[232:235], v[176:179], 0
v_add_f32 v245, v225, v227
s_lshl_b32 s33, s30, 9
s_add_u32 s33, s33, 118784
v_add_u32 v15, s33, v253
ds_write_b64 v15, v[244:245]
ds_write_b32 v254, v240 offset:0
v_xor_b32 v15, 2048, v15
s_waitcnt lgkmcnt(8)
v_mfma_f32_32x32x16_bf16 v[144:159], v[180:183], v[20:23], v[144:159]
ds_read_b64_tr_b16 v[176:177], v11 offset:8192
ds_read_b64_tr_b16 v[178:179], v11 offset:8704
s_add_u32 m0, s45, 57344
s_nop 0
buffer_load_dwordx4 v4, s[16:19], s41 offen lds
s_add_u32 s41, s41, s43
s_waitcnt lgkmcnt(8)
v_mfma_f32_32x32x16_bf16 v[144:159], v[184:187], v[24:27], v[144:159]
ds_read_b64_tr_b16 v[180:181], v12 offset:8192
ds_read_b64_tr_b16 v[182:183], v12 offset:8704
s_add_u32 m0, s45, 65536
s_nop 0
buffer_load_dwordx4 v4, s[16:19], s41 offen lds
s_add_u32 s41, s41, s43
s_waitcnt lgkmcnt(4)
s_barrier
v_mfma_f32_32x32x16_bf16 v[144:159], v[188:191], v[28:31], v[144:159]
ds_read_b64_tr_b16 v[184:185], v13 offset:8192
ds_read_b64_tr_b16 v[186:187], v13 offset:8704
s_add_u32 m0, s45, 73728
s_nop 0
buffer_load_dwordx4 v4, s[16:19], s41 offen lds
s_add_u32 s41, s41, s43
ds_read_b64 v[196:197], v15
v_and_b32 v15, 0xfffffff0, v254
ds_read_b128 v[200:203], v15 offset:0
v_mfma_f32_32x32x16_bf16 v[144:159], v[192:195], v[32:35], v[144:159]
ds_read_b64_tr_b16 v[188:189], v10 offset:16384
ds_read_b64_tr_b16 v[190:191], v10 offset:16896
s_add_u32 m0, s45, 81920
s_nop 0
buffer_load_dwordx4 v4, s[16:19], s41 offen lds
s_add_u32 s41, s41, s43
s_waitcnt lgkmcnt(3)
v_add_f32 v224, v244, v196
v_add_f32 v225, v245, v197
v_mov_b32 v196, v224
v_mov_b32 v197, v225
v_mov_b32 v241, 0
v_mov_b32 v242, 0
v_permlane32_swap_b32 v197, v225
v_add_f32 v225, v225, v197
v_mul_f32 v224, 0xbb124925, v224
v_mfma_f32_16x16x32_bf16 v[220:223], v[232:235], v[192:195], v[220:223]
v_mfma_f32_32x32x16_bf16 v[144:159], v[176:179], v[36:39], v[144:159]
ds_read_b64_tr_b16 v[192:193], v11 offset:16384
ds_read_b64_tr_b16 v[194:195], v11 offset:16896
s_add_u32 m0, s45, 90112
s_nop 0
buffer_load_dwordx4 v4, s[16:19], s41 offen lds
s_add_u32 s41, s41, s43
buffer_load_dword v255, v0, s[12:15], s8 offen offset:512
v_mul_f32 v225, 0x3b124925, v225
v_and_b32 v196, 0xffff0000, v224
v_fma_f32 v225, -v224, v224, v225
v_sub_f32 v197, v224, v196
v_max_f32 v225, 0, v225
v_cndmask_b32 v196, v196, v197, s[54:55]
v_add_f32 v225, 0x3727c5ac, v225
v_cvt_pk_bf16_f32 v236, v196, v196
v_rsq_f32 v226, v225
v_mov_b32 v243, 0
v_mfma_f32_32x32x16_bf16 v[144:159], v[180:183], v[40:43], v[144:159]
ds_read_b64_tr_b16 v[176:177], v12 offset:16384
ds_read_b64_tr_b16 v[178:179], v12 offset:16896
s_add_u32 m0, s45, 98304
s_nop 0
buffer_load_dwordx4 v4, s[16:19], s41 offen lds
s_add_u32 s41, s41, s43
s_waitcnt lgkmcnt(6)
v_add_f32 v200, v200, v201
v_add_f32 v202, v202, v203
v_add_f32 v200, v200, v202
v_and_b32 v201, 0xffff0000, v200
v_sub_f32 v200, v200, v201
v_cvt_pk_bf16_f32 v240, v201, v200
v_mul_f32 v229, v225, v226
v_mul_f32 v227, 0xc0135761, v226
v_mfma_f32_32x32x16_bf16 v[128:143], v[240:243], v[236:239], v[128:143]
v_mfma_f32_32x32x16_bf16 v[144:159], v[184:187], v[44:47], v[144:159]
ds_read_b64_tr_b16 v[180:181], v13 offset:16384
ds_read_b64_tr_b16 v[182:183], v13 offset:16896
s_add_u32 m0, s45, 106496
s_nop 0
buffer_load_dwordx4 v4, s[16:19], s41 offen lds
s_add_u32 s41, s41, s43
v_mul_f32 v228, v226, v226
v_mul_f32 v228, v228, v226
v_mul_f32 v228, 0xbdd2d3e8, v228
s_waitcnt vmcnt(10)
s_barrier
s_waitcnt lgkmcnt(6)
v_mfma_f32_32x32x16_bf16 v[144:159], v[188:191], v[48:51], v[144:159]
ds_read_b64_tr_b16 v[184:185], v10 offset:24576
ds_read_b64_tr_b16 v[186:187], v10 offset:25088
s_mov_b32 s16, s68
s_and_b32 s17, s69, 0xffff
s_mov_b32 s18, 401408
s_mov_b32 s19, 0x20000
s_mov_b32 s20, s78
s_and_b32 s21, s79, 0xffff
s_mov_b32 s22, 802816
s_mov_b32 s23, 0x20000
s_mov_b32 s40, 0x33333333
s_mov_b32 s41, 0x33333333
v_mfma_f32_16x16x32_bf16 v[220:223], v[232:235], v[188:191], v[220:223]
s_waitcnt lgkmcnt(6)
v_mfma_f32_32x32x16_bf16 v[144:159], v[192:195], v[52:55], v[144:159]
ds_read_b64_tr_b16 v[188:189], v11 offset:24576
ds_read_b64_tr_b16 v[190:191], v11 offset:25088
s_waitcnt lgkmcnt(6)
v_mfma_f32_32x32x16_bf16 v[144:159], v[176:179], v[56:59], v[144:159]
ds_read_b64_tr_b16 v[192:193], v12 offset:24576
ds_read_b64_tr_b16 v[194:195], v12 offset:25088
buffer_load_dword v255, v0, s[12:15], s8 offen offset:1024
v_mul_f32 v196, v128, v128
v_mul_f32 v197, v129, v129
v_mul_f32 v198, v130, v130
v_mul_f32 v199, v131, v131
v_mul_f32 v200, v132, v132
v_mul_f32 v201, v133, v133
v_mul_f32 v202, v134, v134
v_mul_f32 v203, v135, v135
v_fma_f32 v196, v196, v228, v227
v_fma_f32 v197, v197, v228, v227
v_fma_f32 v198, v198, v228, v227
v_fma_f32 v199, v199, v228, v227
s_waitcnt lgkmcnt(6)
v_mfma_f32_32x32x16_bf16 v[144:159], v[180:183], v[60:63], v[144:159]
ds_read_b64_tr_b16 v[176:177], v13 offset:24576
ds_read_b64_tr_b16 v[178:179], v13 offset:25088
v_fma_f32 v200, v200, v228, v227
v_fma_f32 v201, v201, v228, v227
v_fma_f32 v202, v202, v228, v227
v_fma_f32 v203, v203, v228, v227
v_mul_f32 v196, v196, v128
v_mul_f32 v197, v197, v129
v_mul_f32 v198, v198, v130
v_mul_f32 v199, v199, v131
v_mul_f32 v200, v200, v132
v_mul_f32 v201, v201, v133
v_mul_f32 v202, v202, v134
v_mul_f32 v203, v203, v135
s_waitcnt lgkmcnt(6)
v_mfma_f32_32x32x16_bf16 v[144:159], v[184:187], v[64:67], v[144:159]
ds_read_b64_tr_b16 v[180:181], v10 offset:32768
ds_read_b64_tr_b16 v[182:183], v10 offset:33280
v_exp_f32 v196, v196
v_exp_f32 v197, v197
v_exp_f32 v198, v198
v_exp_f32 v199, v199
v_exp_f32 v200, v200
v_exp_f32 v201, v201
v_exp_f32 v202, v202
v_exp_f32 v203, v203
v_fma_f32 v196, v196, v229, v229
v_fma_f32 v197, v197, v229, v229
v_fma_f32 v198, v198, v229, v229
v_fma_f32 v199, v199, v229, v229
v_mfma_f32_16x16x32_bf16 v[220:223], v[232:235], v[184:187], v[220:223]
s_waitcnt lgkmcnt(6)
v_mfma_f32_32x32x16_bf16 v[144:159], v[188:191], v[68:71], v[144:159]
ds_read_b64_tr_b16 v[184:185], v11 offset:32768
ds_read_b64_tr_b16 v[186:187], v11 offset:33280
s_mul_i32 s33, s37, 392
s_lshl_b32 s34, s33, 1
buffer_load_dword v255, v253, s[16:19], s33 offen
buffer_load_dword v255, v14, s[20:23], s34 offen
v_fma_f32 v200, v200, v229, v229
v_fma_f32 v201, v201, v229, v229
v_fma_f32 v202, v202, v229, v229
v_fma_f32 v203, v203, v229, v229
v_rcp_f32 v196, v196
v_rcp_f32 v197, v197
v_rcp_f32 v198, v198
v_rcp_f32 v199, v199
v_rcp_f32 v200, v200
v_rcp_f32 v201, v201
v_rcp_f32 v202, v202
v_rcp_f32 v203, v203
s_waitcnt lgkmcnt(6)
v_mfma_f32_32x32x16_bf16 v[144:159], v[192:195], v[72:75], v[144:159]
ds_read_b64_tr_b16 v[188:189], v12 offset:32768
ds_read_b64_tr_b16 v[190:191], v12 offset:33280
v_mul_f32 v128, v196, v128
v_mul_f32 v129, v197, v129
v_mul_f32 v130, v198, v130
v_mul_f32 v131, v199, v131
v_mul_f32 v132, v200, v132
v_mul_f32 v133, v201, v133
v_mul_f32 v134, v202, v134
v_mul_f32 v135, v203, v135
v_mov_b32 v224, v128
v_mul_f32 v225, v128, v128
v_add_f32 v224, v224, v129
v_fmac_f32 v225, v129, v129
s_waitcnt lgkmcnt(6)
v_mfma_f32_32x32x16_bf16 v[144:159], v[176:179], v[76:79], v[144:159]
ds_read_b64_tr_b16 v[192:193], v13 offset:32768
ds_read_b64_tr_b16 v[194:195], v13 offset:33280
buffer_load_dword v255, v0, s[12:15], s8 offen offset:1536
v_add_f32 v224, v224, v130
v_fmac_f32 v225, v130, v130
v_add_f32 v224, v224, v131
v_fmac_f32 v225, v131, v131
v_add_f32 v224, v224, v132
v_fmac_f32 v225, v132, v132
v_add_f32 v224, v224, v133
v_fmac_f32 v225, v133, v133
v_add_f32 v224, v224, v134
v_fmac_f32 v225, v134, v134
v_add_f32 v224, v224, v135
v_fmac_f32 v225, v135, v135
s_waitcnt lgkmcnt(6)
v_mfma_f32_32x32x16_bf16 v[144:159], v[180:183], v[80:83], v[144:159]
ds_read_b64_tr_b16 v[176:177], v10 offset:40960
ds_read_b64_tr_b16 v[178:179], v10 offset:41472
v_mul_f32 v204, v136, v136
v_mul_f32 v205, v137, v137
v_mul_f32 v206, v138, v138
v_mul_f32 v207, v139, v139
v_mul_f32 v208, v140, v140
v_mul_f32 v209, v141, v141
v_mul_f32 v210, v142, v142
v_mul_f32 v211, v143, v143
v_fma_f32 v204, v204, v228, v227
v_fma_f32 v205, v205, v228, v227
v_fma_f32 v206, v206, v228, v227
v_fma_f32 v207, v207, v228, v227
v_mfma_f32_16x16x32_bf16 v[220:223], v[232:235], v[180:183], v[220:223]
s_waitcnt lgkmcnt(6)
v_mfma_f32_32x32x16_bf16 v[144:159], v[184:187], v[84:87], v[144:159]
ds_read_b64_tr_b16 v[180:181], v11 offset:40960
ds_read_b64_tr_b16 v[182:183], v11 offset:41472
v_fma_f32 v208, v208, v228, v227
v_fma_f32 v209, v209, v228, v227
v_fma_f32 v210, v210, v228, v227
v_fma_f32 v211, v211, v228, v227
v_mul_f32 v204, v204, v136
v_mul_f32 v205, v205, v137
v_mul_f32 v206, v206, v138
v_mul_f32 v207, v207, v139
v_mul_f32 v208, v208, v140
v_mul_f32 v209, v209, v141
v_mul_f32 v210, v210, v142
v_mul_f32 v211, v211, v143
s_waitcnt lgkmcnt(6)
v_mfma_f32_32x32x16_bf16 v[144:159], v[188:191], v[88:91], v[144:159]
ds_read_b64_tr_b16 v[184:185], v12 offset:40960
ds_read_b64_tr_b16 v[186:187], v12 offset:41472
v_exp_f32 v204, v204
v_exp_f32 v205, v205
v_exp_f32 v206, v206
v_exp_f32 v207, v207
v_exp_f32 v208, v208
v_exp_f32 v209, v209
v_exp_f32 v210, v210
v_exp_f32 v211, v211
v_fma_f32 v204, v204, v229, v229
v_fma_f32 v205, v205, v229, v229
v_fma_f32 v206, v206, v229, v229
v_fma_f32 v207, v207, v229, v229
s_waitcnt lgkmcnt(6)
v_mfma_f32_32x32x16_bf16 v[144:159], v[192:195], v[92:95], v[144:159]
ds_read_b64_tr_b16 v[188:189], v13 offset:40960
ds_read_b64_tr_b16 v[190:191], v13 offset:41472
v_fma_f32 v208, v208, v229, v229
v_fma_f32 v209, v209, v229, v229
v_fma_f32 v210, v210, v229, v229
v_fma_f32 v211, v211, v229, v229
v_rcp_f32 v204, v204
v_rcp_f32 v205, v205
v_rcp_f32 v206, v206
v_rcp_f32 v207, v207
v_rcp_f32 v208, v208
v_rcp_f32 v209, v209
v_rcp_f32 v210, v210
v_rcp_f32 v211, v211
s_waitcnt lgkmcnt(6)
v_mfma_f32_32x32x16_bf16 v[144:159], v[176:179], v[96:99], v[144:159]
ds_read_b64_tr_b16 v[192:193], v10 offset:49152
ds_read_b64_tr_b16 v[194:195], v10 offset:49664
v_mul_f32 v136, v204, v136
v_mul_f32 v137, v205, v137
v_mul_f32 v138, v206, v138
v_mul_f32 v139, v207, v139
v_mul_f32 v140, v208, v140
v_mul_f32 v141, v209, v141
v_mul_f32 v142, v210, v142
v_mul_f32 v143, v211, v143
v_add_f32 v224, v224, v136
v_fmac_f32 v225, v136, v136
v_add_f32 v224, v224, v137
v_fmac_f32 v225, v137, v137
v_mfma_f32_16x16x32_bf16 v[220:223], v[232:235], v[176:179], v[220:223]
s_waitcnt lgkmcnt(6)
v_mfma_f32_32x32x16_bf16 v[144:159], v[180:183], v[100:103], v[144:159]
ds_read_b64_tr_b16 v[176:177], v11 offset:49152
ds_read_b64_tr_b16 v[178:179], v11 offset:49664
v_add_f32 v224, v224, v138
v_fmac_f32 v225, v138, v138
v_add_f32 v224, v224, v139
v_fmac_f32 v225, v139, v139
v_add_f32 v224, v224, v140
v_fmac_f32 v225, v140, v140
v_add_f32 v224, v224, v141
v_fmac_f32 v225, v141, v141
v_add_f32 v224, v224, v142
v_fmac_f32 v225, v142, v142
v_add_f32 v224, v224, v143
s_waitcnt lgkmcnt(6)
v_mfma_f32_32x32x16_bf16 v[144:159], v[184:187], v[104:107], v[144:159]
ds_read_b64_tr_b16 v[180:181], v12 offset:49152
ds_read_b64_tr_b16 v[182:183], v12 offset:49664
v_fmac_f32 v225, v143, v143
v_mov_b32 v196, v224
v_mov_b32 v197, v225
s_lshl_b32 s33, s30, 9
s_add_u32 s33, s33, 118784
v_add_u32 v8, s33, v253
v_mov_b32 v227, 1
v_permlane32_swap_b32 v196, v224
v_permlane32_swap_b32 v197, v225
v_add_f32 v224, v224, v196
v_add_f32 v225, v225, v197
ds_write_b64 v8, v[224:225]
v_xor_b32 v8, 2048, v8
s_waitcnt lgkmcnt(7)
v_mfma_f32_32x32x16_bf16 v[144:159], v[188:191], v[108:111], v[144:159]
ds_read_b64_tr_b16 v[184:185], v13 offset:49152
ds_read_b64_tr_b16 v[186:187], v13 offset:49664
s_waitcnt vmcnt(4)
s_waitcnt lgkmcnt(2)
s_barrier
v_mfma_f32_32x32x16_bf16 v[144:159], v[192:195], v[112:115], v[144:159]
v_add_u32 v10, 57344, v10
v_add_u32 v11, 57344, v11
v_add_u32 v12, 57344, v12
v_add_u32 v13, 57344, v13
ds_read_b64_tr_b16 v[188:189], v10 offset:0
ds_read_b64_tr_b16 v[190:191], v10 offset:512
ds_read_b64 v[196:197], v8
P1_AL_CR:
v_cmp_eq_u32 vcc, 0, v2
s_and_b64 vcc, vcc, s[40:41]
s_cbranch_vccnz P1_AL_CW
P1_AL_CX:
v_mfma_f32_16x16x32_bf16 v[220:223], v[232:235], v[192:195], v[220:223]
v_mfma_f32_32x32x16_bf16 v[144:159], v[176:179], v[116:119], v[144:159]
ds_read_b64_tr_b16 v[192:193], v11 offset:0
ds_read_b64_tr_b16 v[194:195], v11 offset:512
s_waitcnt lgkmcnt(2)
v_add_f32 v224, v224, v196
v_add_f32 v225, v225, v197
s_lshl_b32 s33, s32, 4
s_lshl_b32 exec_lo, 0xffff, s33
s_mov_b32 exec_hi, 0
buffer_store_dwordx2 v[224:225], v253, s[24:27], s10 offen sc1
s_mov_b64 exec, -1
s_and_b32 s10, s10, 0xfffff000
v_mfma_f32_32x32x16_bf16 v[144:159], v[180:183], v[120:123], v[144:159]
ds_read_b64_tr_b16 v[176:177], v12 offset:0
ds_read_b64_tr_b16 v[178:179], v12 offset:512
v_mfma_f32_32x32x16_bf16 v[144:159], v[184:187], v[124:127], v[144:159]
ds_read_b64_tr_b16 v[180:181], v13 offset:0
ds_read_b64_tr_b16 v[182:183], v13 offset:512
ds_write_b32 v254, v220 offset:2048
v_mfma_f32_32x32x16_bf16 v[160:175], v[188:191], v[16:19], 0
ds_read_b64_tr_b16 v[184:185], v10 offset:8192
ds_read_b64_tr_b16 v[186:187], v10 offset:8704
v_mfma_f32_16x16x32_bf16 v[220:223], v[232:235], v[188:191], 0
s_waitcnt lgkmcnt(7)
v_mfma_f32_32x32x16_bf16 v[160:175], v[192:195], v[20:23], v[160:175]
ds_read_b64_tr_b16 v[188:189], v11 offset:8192
ds_read_b64_tr_b16 v[190:191], v11 offset:8704
s_waitcnt lgkmcnt(4)
s_barrier
v_mfma_f32_32x32x16_bf16 v[160:175], v[176:179], v[24:27], v[160:175]
ds_read_b64_tr_b16 v[192:193], v12 offset:8192
ds_read_b64_tr_b16 v[194:195], v12 offset:8704
ds_read_b128 v[248:251], v15 offset:2048
v_mfma_f32_32x32x16_bf16 v[160:175], v[180:183], v[28:31], v[160:175]
ds_read_b64_tr_b16 v[176:177], v13 offset:8192
ds_read_b64_tr_b16 v[178:179], v13 offset:8704
s_waitcnt lgkmcnt(2)
v_add_f32 v248, v248, v249
v_add_f32 v250, v250, v251
v_add_f32 v248, v248, v250
v_and_b32 v249, 0xffff0000, v248
v_sub_f32 v248, v248, v249
v_cvt_pk_bf16_f32 v240, v249, v248
s_nop 1
v_mfma_f32_32x32x16_bf16 v[160:175], v[184:187], v[32:35], v[160:175]
ds_read_b64_tr_b16 v[180:181], v10 offset:16384
ds_read_b64_tr_b16 v[182:183], v10 offset:16896
v_mfma_f32_32x32x16_bf16 v[144:159], v[240:243], v[236:239], v[144:159]
v_mfma_f32_16x16x32_bf16 v[220:223], v[232:235], v[184:187], v[220:223]
v_mfma_f32_32x32x16_bf16 v[160:175], v[188:191], v[36:39], v[160:175]
ds_read_b64_tr_b16 v[184:185], v11 offset:16384
ds_read_b64_tr_b16 v[186:187], v11 offset:16896
v_mfma_f32_32x32x16_bf16 v[160:175], v[192:195], v[40:43], v[160:175]
ds_read_b64_tr_b16 v[188:189], v12 offset:16384
ds_read_b64_tr_b16 v[190:191], v12 offset:16896
s_waitcnt lgkmcnt(6)
v_mfma_f32_32x32x16_bf16 v[160:175], v[176:179], v[44:47], v[160:175]
ds_read_b64_tr_b16 v[192:193], v13 offset:16384
ds_read_b64_tr_b16 v[194:195], v13 offset:16896
v_fmaak_f32 v144, v144, v226, 0x358637bd
v_fmaak_f32 v145, v145, v226, 0x358637bd
v_fmaak_f32 v146, v146, v226, 0x358637bd
v_fmaak_f32 v147, v147, v226, 0x358637bd
v_fmaak_f32 v148, v148, v226, 0x358637bd
v_fmaak_f32 v149, v149, v226, 0x358637bd
v_fmaak_f32 v150, v150, v226, 0x358637bd
v_fmaak_f32 v151, v151, v226, 0x358637bd
v_fmaak_f32 v196, v144, v230, 0xb5c1a2a0
v_fmaak_f32 v197, v145, v230, 0xb5c1a2a0
v_fmaak_f32 v198, v146, v230, 0xb5c1a2a0
s_waitcnt lgkmcnt(6)
v_mfma_f32_32x32x16_bf16 v[160:175], v[180:183], v[48:51], v[160:175]
ds_read_b64_tr_b16 v[176:177], v10 offset:24576
ds_read_b64_tr_b16 v[178:179], v10 offset:25088
v_fmaak_f32 v199, v147, v230, 0xb5c1a2a0
v_fmaak_f32 v200, v148, v230, 0xb5c1a2a0
v_fmaak_f32 v201, v149, v230, 0xb5c1a2a0
v_fmaak_f32 v202, v150, v230, 0xb5c1a2a0
v_fmaak_f32 v203, v151, v230, 0xb5c1a2a0
v_exp_f32_e64 v196, v196 clamp
v_exp_f32_e64 v197, v197 clamp
v_exp_f32_e64 v198, v198 clamp
v_exp_f32_e64 v199, v199 clamp
v_exp_f32_e64 v200, v200 clamp
v_exp_f32_e64 v201, v201 clamp
v_mfma_f32_16x16x32_bf16 v[220:223], v[232:235], v[180:183], v[220:223]
s_waitcnt lgkmcnt(6)
v_mfma_f32_32x32x16_bf16 v[160:175], v[184:187], v[52:55], v[160:175]
ds_read_b64_tr_b16 v[180:181], v11 offset:24576
ds_read_b64_tr_b16 v[182:183], v11 offset:25088
v_exp_f32_e64 v202, v202 clamp
v_exp_f32_e64 v203, v203 clamp
v_max_f32 v144, 0x358637bd, v144
v_max_f32 v145, 0x358637bd, v145
v_max_f32 v146, 0x358637bd, v146
v_max_f32 v147, 0x358637bd, v147
v_max_f32 v148, 0x358637bd, v148
v_max_f32 v149, 0x358637bd, v149
v_max_f32 v150, 0x358637bd, v150
v_max_f32 v151, 0x358637bd, v151
s_waitcnt lgkmcnt(6)
v_mfma_f32_32x32x16_bf16 v[160:175], v[188:191], v[56:59], v[160:175]
ds_read_b64_tr_b16 v[184:185], v12 offset:24576
ds_read_b64_tr_b16 v[186:187], v12 offset:25088
v_add_f32 v144, v144, v196
v_add_f32 v145, v145, v197
v_add_f32 v146, v146, v198
v_add_f32 v147, v147, v199
v_add_f32 v148, v148, v200
v_add_f32 v149, v149, v201
v_add_f32 v150, v150, v202
v_add_f32 v151, v151, v203
v_fmaak_f32 v152, v152, v226, 0x358637bd
v_fmaak_f32 v153, v153, v226, 0x358637bd
s_waitcnt lgkmcnt(6)
v_mfma_f32_32x32x16_bf16 v[160:175], v[192:195], v[60:63], v[160:175]
ds_read_b64_tr_b16 v[188:189], v13 offset:24576
ds_read_b64_tr_b16 v[190:191], v13 offset:25088
v_fmaak_f32 v154, v154, v226, 0x358637bd
v_fmaak_f32 v155, v155, v226, 0x358637bd
v_fmaak_f32 v156, v156, v226, 0x358637bd
v_fmaak_f32 v157, v157, v226, 0x358637bd
v_fmaak_f32 v158, v158, v226, 0x358637bd
v_fmaak_f32 v159, v159, v226, 0x358637bd
v_fmaak_f32 v204, v152, v230, 0xb5c1a2a0
v_fmaak_f32 v205, v153, v230, 0xb5c1a2a0
v_fmaak_f32 v206, v154, v230, 0xb5c1a2a0
v_fmaak_f32 v207, v155, v230, 0xb5c1a2a0
s_waitcnt lgkmcnt(6)
v_mfma_f32_32x32x16_bf16 v[160:175], v[176:179], v[64:67], v[160:175]
ds_read_b64_tr_b16 v[192:193], v10 offset:32768
ds_read_b64_tr_b16 v[194:195], v10 offset:33280
v_fmaak_f32 v208, v156, v230, 0xb5c1a2a0
v_fmaak_f32 v209, v157, v230, 0xb5c1a2a0
v_fmaak_f32 v210, v158, v230, 0xb5c1a2a0
v_fmaak_f32 v211, v159, v230, 0xb5c1a2a0
v_exp_f32_e64 v204, v204 clamp
v_exp_f32_e64 v205, v205 clamp
v_exp_f32_e64 v206, v206 clamp
v_exp_f32_e64 v207, v207 clamp
v_exp_f32_e64 v208, v208 clamp
v_exp_f32_e64 v209, v209 clamp
v_mfma_f32_16x16x32_bf16 v[220:223], v[232:235], v[176:179], v[220:223]
s_waitcnt lgkmcnt(6)
v_mfma_f32_32x32x16_bf16 v[160:175], v[180:183], v[68:71], v[160:175]
ds_read_b64_tr_b16 v[176:177], v11 offset:32768
ds_read_b64_tr_b16 v[178:179], v11 offset:33280
v_exp_f32_e64 v210, v210 clamp
v_exp_f32_e64 v211, v211 clamp
v_max_f32 v152, 0x358637bd, v152
v_max_f32 v153, 0x358637bd, v153
v_max_f32 v154, 0x358637bd, v154
v_max_f32 v155, 0x358637bd, v155
v_max_f32 v156, 0x358637bd, v156
v_max_f32 v157, 0x358637bd, v157
v_max_f32 v158, 0x358637bd, v158
v_max_f32 v159, 0x358637bd, v159
s_waitcnt lgkmcnt(6)
v_mfma_f32_32x32x16_bf16 v[160:175], v[184:187], v[72:75], v[160:175]
ds_read_b64_tr_b16 v[180:181], v12 offset:32768
ds_read_b64_tr_b16 v[182:183], v12 offset:33280
v_add_f32 v152, v152, v204
v_add_f32 v153, v153, v205
v_add_f32 v154, v154, v206
v_add_f32 v155, v155, v207
v_add_f32 v156, v156, v208
v_add_f32 v157, v157, v209
v_add_f32 v158, v158, v210
v_add_f32 v159, v159, v211
v_cvt_pk_bf16_f32 v212, v144, v145
v_cvt_pk_bf16_f32 v213, v146, v147
s_waitcnt lgkmcnt(6)
v_mfma_f32_32x32x16_bf16 v[160:175], v[188:191], v[76:79], v[160:175]
ds_read_b64_tr_b16 v[184:185], v13 offset:32768
ds_read_b64_tr_b16 v[186:187], v13 offset:33280
v_cvt_pk_bf16_f32 v214, v148, v149
v_cvt_pk_bf16_f32 v215, v150, v151
v_cvt_pk_bf16_f32 v216, v152, v153
v_cvt_pk_bf16_f32 v217, v154, v155
v_cvt_pk_bf16_f32 v218, v156, v157
v_cvt_pk_bf16_f32 v219, v158, v159
buffer_store_dwordx2 v[212:213], v253, s[24:27], s48 offen offset:0 sc1
buffer_store_dwordx2 v[214:215], v253, s[24:27], s48 offen offset:512 sc1
buffer_store_dwordx2 v[216:217], v253, s[24:27], s48 offen offset:1024 sc1
buffer_store_dwordx2 v[218:219], v253, s[24:27], s48 offen offset:1536 sc1
s_waitcnt lgkmcnt(6)
v_mfma_f32_32x32x16_bf16 v[160:175], v[192:195], v[80:83], v[160:175]
ds_read_b64_tr_b16 v[188:189], v10 offset:40960
ds_read_b64_tr_b16 v[190:191], v10 offset:41472
v_mfma_f32_16x16x32_bf16 v[220:223], v[232:235], v[192:195], v[220:223]
s_waitcnt lgkmcnt(6)
v_mfma_f32_32x32x16_bf16 v[160:175], v[176:179], v[84:87], v[160:175]
ds_read_b64_tr_b16 v[192:193], v11 offset:40960
ds_read_b64_tr_b16 v[194:195], v11 offset:41472
buffer_load_dwordx2 v[2:3], v253, s[24:27], s10 offen offset:0 sc1
buffer_load_dwordx2 v[4:5], v253, s[24:27], s10 offen offset:512 sc1
buffer_load_dwordx2 v[6:7], v253, s[24:27], s10 offen offset:1024 sc1
buffer_load_dwordx2 v[8:9], v253, s[24:27], s10 offen offset:1536 sc1
buffer_load_dwordx2 v[244:245], v253, s[24:27], s10 offen offset:2048 sc1
buffer_load_dwordx2 v[246:247], v253, s[24:27], s10 offen offset:2560 sc1
buffer_load_dwordx2 v[228:229], v253, s[24:27], s10 offen offset:3072 sc1
s_waitcnt lgkmcnt(6)
v_mfma_f32_32x32x16_bf16 v[160:175], v[180:183], v[88:91], v[160:175]
ds_read_b64_tr_b16 v[176:177], v12 offset:40960
ds_read_b64_tr_b16 v[178:179], v12 offset:41472
s_waitcnt lgkmcnt(6)
v_mfma_f32_32x32x16_bf16 v[160:175], v[184:187], v[92:95], v[160:175]
ds_read_b64_tr_b16 v[180:181], v13 offset:40960
ds_read_b64_tr_b16 v[182:183], v13 offset:41472
s_waitcnt lgkmcnt(6)
v_mfma_f32_32x32x16_bf16 v[160:175], v[188:191], v[96:99], v[160:175]
ds_read_b64_tr_b16 v[184:185], v10 offset:49152
ds_read_b64_tr_b16 v[186:187], v10 offset:49664
v_mfma_f32_16x16x32_bf16 v[220:223], v[232:235], v[188:191], v[220:223]
s_waitcnt lgkmcnt(6)
v_mfma_f32_32x32x16_bf16 v[160:175], v[192:195], v[100:103], v[160:175]
ds_read_b64_tr_b16 v[188:189], v11 offset:49152
ds_read_b64_tr_b16 v[190:191], v11 offset:49664
s_waitcnt lgkmcnt(6)
v_mfma_f32_32x32x16_bf16 v[160:175], v[176:179], v[104:107], v[160:175]
ds_read_b64_tr_b16 v[192:193], v12 offset:49152
ds_read_b64_tr_b16 v[194:195], v12 offset:49664
s_waitcnt vmcnt(0)
P1_AL_PR:
v_max3_u32 v224, v3, v5, v7
v_max3_u32 v225, v9, v245, v247
v_max3_u32 v224, v224, v225, v229
v_cmp_eq_u32 vcc, -1, v224
s_cbranch_vccnz P1_AL_PW
P1_AL_PX:
v_add_f32 v2, v2, v4
v_add_f32 v3, v3, v5
v_add_f32 v6, v6, v8
v_add_f32 v7, v7, v9
v_add_f32 v244, v244, v246
v_add_f32 v245, v245, v247
v_add_f32 v2, v2, v6
v_add_f32 v3, v3, v7
s_waitcnt lgkmcnt(6)
v_mfma_f32_32x32x16_bf16 v[160:175], v[180:183], v[108:111], v[160:175]
ds_read_b64_tr_b16 v[176:177], v13 offset:49152
ds_read_b64_tr_b16 v[178:179], v13 offset:49664
v_add_f32 v244, v244, v228
v_add_f32 v245, v245, v229
v_add_f32 v2, v2, v244
v_add_f32 v3, v3, v245
v_mov_b32 v4, v2
v_mov_b32 v5, v3
s_nop 0
v_permlane32_swap_b32 v4, v2
v_permlane32_swap_b32 v5, v3
s_waitcnt lgkmcnt(6)
v_mfma_f32_32x32x16_bf16 v[160:175], v[184:187], v[112:115], v[160:175]
v_add_f32 v2, v2, v4
v_add_f32 v3, v3, v5
v_mul_f32 v2, 0xba924925, v2
v_mul_f32 v3, 0x3a924925, v3
v_fma_f32 v3, -v2, v2, v3
v_max_f32 v3, 0, v3
v_add_f32 v3, 0x3727c5ac, v3
v_rsq_f32 v3, v3
s_nop 0
v_mfma_f32_16x16x32_bf16 v[220:223], v[232:235], v[184:187], v[220:223]
s_waitcnt lgkmcnt(4)
v_mfma_f32_32x32x16_bf16 v[160:175], v[188:191], v[116:119], v[160:175]
v_mul_f32 v2, v2, v3
v_fma_f32 v128, v128, v3, v2
v_fma_f32 v129, v129, v3, v2
v_fma_f32 v130, v130, v3, v2
v_fma_f32 v131, v131, v3, v2
v_fma_f32 v132, v132, v3, v2
v_fma_f32 v133, v133, v3, v2
v_fma_f32 v134, v134, v3, v2
v_fma_f32 v135, v135, v3, v2
s_waitcnt lgkmcnt(2)
v_mfma_f32_32x32x16_bf16 v[160:175], v[192:195], v[120:123], v[160:175]
v_cvt_pk_bf16_f32 v128, v128, v129
v_cvt_pk_bf16_f32 v129, v130, v131
v_cvt_pk_bf16_f32 v130, v132, v133
v_cvt_pk_bf16_f32 v131, v134, v135
buffer_store_dwordx4 v[128:131], v14, s[24:27], s47 offen sc1
v_fma_f32 v136, v136, v3, v2
v_fma_f32 v137, v137, v3, v2
v_fma_f32 v138, v138, v3, v2
v_fma_f32 v139, v139, v3, v2
s_waitcnt lgkmcnt(0)
v_mfma_f32_32x32x16_bf16 v[160:175], v[176:179], v[124:127], v[160:175]
v_fma_f32 v140, v140, v3, v2
v_fma_f32 v141, v141, v3, v2
v_fma_f32 v142, v142, v3, v2
v_fma_f32 v143, v143, v3, v2
v_cvt_pk_bf16_f32 v132, v136, v137
v_cvt_pk_bf16_f32 v133, v138, v139
v_cvt_pk_bf16_f32 v134, v140, v141
v_cvt_pk_bf16_f32 v135, v142, v143
buffer_store_dwordx4 v[132:135], v14, s[24:27], s47 offen offset:1024 sc1
ds_write_b32 v254, v220
s_branch P1_GT
P1_AL_CW:
s_addk_i32 s53, -1
s_cmp_lt_i32 s53, 0
s_cbranch_scc1 P1_AL_CX
v_lshrrev_b32 v2, 1, v253
buffer_load_dword v2, v2, s[4:7], 0 offen sc1
s_waitcnt vmcnt(0)
s_branch P1_AL_CR
P1_AL_PW:
s_sleep 3
s_addk_i32 s53, -1
s_cmp_lt_i32 s53, 0
s_cbranch_scc1 P1_AL_PX
v_cmp_eq_u32 vcc, -1, v3
s_cbranch_vccz P1_AL_PS0
s_mov_b64 exec, vcc
buffer_load_dwordx2 v[2:3], v253, s[24:27], s10 offen offset:0 sc1
s_mov_b64 exec, -1
P1_AL_PS0:
v_cmp_eq_u32 vcc, -1, v5
s_cbranch_vccz P1_AL_PS1
s_mov_b64 exec, vcc
buffer_load_dwordx2 v[4:5], v253, s[24:27], s10 offen offset:512 sc1
s_mov_b64 exec, -1
P1_AL_PS1:
v_cmp_eq_u32 vcc, -1, v7
s_cbranch_vccz P1_AL_PS2
s_mov_b64 exec, vcc
buffer_load_dwordx2 v[6:7], v253, s[24:27], s10 offen offset:1024 sc1
s_mov_b64 exec, -1
P1_AL_PS2:
v_cmp_eq_u32 vcc, -1, v9
s_cbranch_vccz P1_AL_PS3
s_mov_b64 exec, vcc
buffer_load_dwordx2 v[8:9], v253, s[24:27], s10 offen offset:1536 sc1
s_mov_b64 exec, -1
P1_AL_PS3:
v_cmp_eq_u32 vcc, -1, v245
s_cbranch_vccz P1_AL_PS4
s_mov_b64 exec, vcc
buffer_load_dwordx2 v[244:245], v253, s[24:27], s10 offen offset:2048 sc1
s_mov_b64 exec, -1
P1_AL_PS4:
v_cmp_eq_u32 vcc, -1, v247
s_cbranch_vccz P1_AL_PS5
s_mov_b64 exec, vcc
buffer_load_dwordx2 v[246:247], v253, s[24:27], s10 offen offset:2560 sc1
s_mov_b64 exec, -1
P1_AL_PS5:
v_cmp_eq_u32 vcc, -1, v229
s_cbranch_vccz P1_AL_PS6
s_mov_b64 exec, vcc
buffer_load_dwordx2 v[228:229], v253, s[24:27], s10 offen offset:3072 sc1
s_mov_b64 exec, -1
P1_AL_PS6:
s_waitcnt vmcnt(0)
s_branch P1_AL_PR
P1_KB:
s_mul_i32 s44, s30, 3072
v_add_u32 v3, 5120, v3
s_mul_i32 s35, s30, 28672
s_lshl_b32 s36, s29, 7
s_add_u32 s41, s35, s36
s_add_u32 s39, s41, 768
s_add_u32 s40, s34, s36
s_mov_b32 s43, 229376
v_mul_u32_u24 v4, 3584, v248
v_add_u32 v4, v4, v250
s_waitcnt lgkmcnt(0)
s_mov_b32 s16, s72
s_and_b32 s17, s73, 0xffff
s_mov_b32 s18, 1605632
s_mov_b32 s19, 0x20000
s_mov_b32 s12, s64
s_and_b32 s13, s65, 0xffff
s_mov_b32 s14, 1835008
s_mov_b32 s15, 0x20000
s_add_u32 m0, s44, 57344
s_add_u32 s33, s38, 0
buffer_load_dwordx4 v2, s[12:15], s33 offen lds
buffer_load_dwordx4 v3, s[12:15], s33 offen offset:2048 lds
buffer_load_dwordx4 v4, s[16:19], s39 offen offset:1024 lds
s_add_u32 s39, s39, s43
s_barrier
s_add_u32 m0, s44, 81920
s_add_u32 s33, s38, 128
buffer_load_dwordx4 v2, s[12:15], s33 offen lds
buffer_load_dwordx4 v3, s[12:15], s33 offen offset:2048 lds
buffer_load_dwordx4 v4, s[16:19], s39 offen offset:1024 lds
s_add_u32 s39, s39, s43
s_add_u32 m0, s44, 106496
s_add_u32 s33, s38, 256
buffer_load_dwordx4 v2, s[12:15], s33 offen lds
buffer_load_dwordx4 v3, s[12:15], s33 offen offset:2048 lds
buffer_load_dwordx4 v4, s[16:19], s39 offen offset:1024 lds
s_add_u32 s39, s39, s43
s_mov_b32 s20, s66
s_and_b32 s21, s67, 0xffff
s_mov_b32 s22, 1204224
s_mov_b32 s23, 0x20000
s_mov_b32 s24, s58
s_and_b32 s25, s59, 0xffff
s_mov_b32 s26, 50331648
s_mov_b32 s27, 0x20000
s_mov_b32 s4, s56
s_and_b32 s5, s57, 0xffff
s_mov_b32 s6, 256
s_mov_b32 s7, 0x20000
s_lshl_b32 s33, s32, 1
s_xor_b32 s46, s33, s31
v_and_b32 v248, 31, v1
v_lshrrev_b32 v249, 5, v1
v_bfe_u32 v250, v1, 1, 3
v_xor_b32 v250, v250, v249
s_lshl_b32 s34, s46, 1
v_xor_b32 v250, s34, v250
v_lshlrev_b32 v250, 4, v250
v_and_b32 v251, 7, v1
v_lshl_add_u32 v250, v251, 7, v250
v_bfe_u32 v251, v1, 3, 1
v_mul_u32_u24 v6, 2048, v251
v_bfe_u32 v251, v1, 4, 1
v_mul_u32_u24 v251, 3072, v251
s_mul_i32 s34, s31, 6144
s_add_u32 s34, s34, 57344
v_add3_u32 v251, v251, v6, s34
v_xor_b32 v6, 0, v250
v_add_u32 v6, v251, v6
v_xor_b32 v7, 32, v250
v_add_u32 v7, v251, v7
v_xor_b32 v8, 64, v250
v_add_u32 v8, v251, v8
v_xor_b32 v9, 96, v250
v_add_u32 v9, v251, v9
v_lshlrev_b32 v252, 5, v248
v_lshl_add_u32 v252, v249, 4, v252
s_lshl_b32 s34, s32, 6
v_and_b32 v248, 3, v1
v_lshlrev_b32 v248, 3, v248
v_and_b32 v250, 16, v1
v_lshl_add_u32 v248, v250, 1, v248
v_and_b32 v250, 8, v1
v_lshlrev_b32 v250, 3, v250
v_xor_b32 v250, s34, v250
v_or_b32 v248, v248, v250
v_bfe_u32 v250, v1, 2, 2
v_lshl_add_u32 v248, v250, 7, v248
v_lshl_add_u32 v15, v249, 10, v248
v_mul_u32_u24 v249, 3072, v249
v_add_u32 v248, v248, v249
s_xor_b32 s35, s46, 0
s_mul_i32 s35, s35, 6144
s_add_u32 s35, s35, 58368
v_add_u32 v10, s35, v248
s_xor_b32 s35, s46, 1
s_mul_i32 s35, s35, 6144
s_add_u32 s35, s35, 58368
v_add_u32 v11, s35, v248
s_xor_b32 s35, s46, 2
s_mul_i32 s35, s35, 6144
s_add_u32 s35, s35, 58368
v_add_u32 v12, s35, v248
s_xor_b32 s35, s46, 3
s_mul_i32 s35, s35, 6144
s_add_u32 s35, s35, 58368
v_add_u32 v13, s35, v248
v_lshlrev_b32 v14, 4, v1
v_lshlrev_b32 v253, 3, v1
s_lshl_b32 s33, s32, 10
s_lshl_b32 s34, s31, 2
s_add_u32 s33, s33, s34
s_add_u32 s33, s33, 114688
v_add_u32 v254, s33, v14
v_mov_b32 v224, 0
v_mov_b32 v225, 0
v_mov_b32 v226, 0
v_mov_b32 v227, 0
s_mov_b32 s54, 0xf0f00f0f
s_mov_b32 s55, 0xf0f00f0f
v_mov_b32 v248, 0x3f803f80
v_cndmask_b32 v232, 0, v248, s[54:55]
v_cndmask_b32 v233, 0, v248, s[54:55]
v_cndmask_b32 v234, 0, v248, s[54:55]
v_cndmask_b32 v235, 0, v248, s[54:55]
s_mov_b32 s54, 0
s_mov_b32 s55, -1
v_mov_b32 v237, 0
v_mov_b32 v238, 0
v_mov_b32 v239, 0
v_mov_b32 v255, 1
s_lshl_b32 s45, s30, 10
s_mov_b32 s53, 0x8000
s_lshl_b32 s33, s28, 2
s_add_u32 s33, s33, s31
s_mul_i32 s35, s33, 28672
s_lshr_b32 s34, s2, 5
s_add_u32 s36, s34, 14
s_lshl_b32 s34, s34, 1
s_bfe_u32 s37, s2, 0x10003
s_add_u32 s34, s34, s37
s_and_b32 s37, s2, 0xd8
s_cmp_eq_u32 s37, 0x8
s_cselect_b32 s37, s36, 0x20000
s_bitcmp1_b32 s2, 4
s_cselect_b32 s37, s34, s37
s_lshl_b32 s37, s37, 3
s_add_u32 s37, s37, s30
s_min_u32 s34, s37, 0x8000
s_and_b32 s36, s34, 0xffe0
s_add_u32 s34, s34, s36
s_lshl_b32 s34, s34, 14
v_lshrrev_b32 v248, 4, v1
v_bfe_u32 v0, v1, 2, 2
v_lshlrev_b32 v0, 7, v0
v_lshl_add_u32 v0, v248, 12, v0
v_add_u32 v0, s34, v0
s_and_b32 s34, s2, 7
s_lshl_b32 s34, s34, 7
s_add_u32 s37, s37, s34
s_and_b32 s34, s2, 4
s_lshl_b32 s8, s34, 20
s_and_b32 s34, s2, 2
s_lshl_b32 s34, s34, 18
s_add_u32 s8, s8, s34
s_and_b32 s34, s2, 1
s_lshl_b32 s34, s34, 11
s_add_u32 s8, s8, s34
v_mov_b32 v230, 0x3fb8aa3b
s_lshl_b32 s36, s29, 1
s_add_u32 s36, s36, s32
s_lshl_b32 s47, s36, 17
s_lshl_b32 s34, s33, 11
s_add_u32 s47, s47, s34
s_lshl_b32 s34, s36, 10
s_add_u32 s34, s34, s35
s_mul_i32 s49, s33, 72
s_add_u32 s49, s49, s36
s_lshl_b32 s49, s49, 11
s_add_u32 s49, s49, 16867328
s_add_u32 s48, s34, 10471424
s_lshl_b32 s33, s33, 4
s_add_u32 s33, s33, s29
s_lshl_b32 s33, s33, 8
s_add_u32 s10, s33, 14680064
s_and_b32 s33, s29, 14
s_lshr_b32 s34, s28, 3
s_add_u32 s33, s33, s34
s_lshl_b32 s33, s33, 6
s_and_b32 s34, s28, 7
s_add_u32 s33, s33, s34
s_lshl_b32 s33, s33, 1
s_and_b32 s34, s29, 1
s_add_u32 s33, s33, s34
s_lshl_b32 s33, s33, 2
s_add_u32 s9, s33, 15781888
s_lshl_b32 s11, s28, 9
s_add_u32 s11, s11, s29
s_lshl_b32 s11, s11, 2
s_add_u32 s11, s11, 15728640
s_waitcnt vmcnt(6)
s_barrier
ds_read_b128 v[16:19], v6 offset:0
ds_read_b64_tr_b16 v[160:161], v10 offset:0
ds_read_b64_tr_b16 v[162:163], v10 offset:512
ds_read_b128 v[20:23], v7 offset:0
ds_read_b64_tr_b16 v[164:165], v11 offset:0
ds_read_b64_tr_b16 v[166:167], v11 offset:512
ds_read_b128 v[24:27], v8 offset:0
ds_read_b64_tr_b16 v[168:169], v12 offset:0
ds_read_b64_tr_b16 v[170:171], v12 offset:512
ds_read_b128 v[28:31], v9 offset:0
ds_read_b64_tr_b16 v[172:173], v13 offset:0
ds_read_b64_tr_b16 v[174:175], v13 offset:512
s_add_u32 m0, s44, 131072
s_add_u32 s33, s38, 384
buffer_load_dwordx4 v2, s[12:15], s33 offen lds
buffer_load_dwordx4 v3, s[12:15], s33 offen offset:2048 lds
buffer_load_dwordx4 v4, s[16:19], s39 offen offset:1024 lds
s_add_u32 s39, s39, s43
s_waitcnt lgkmcnt(0)
s_waitcnt vmcnt(6)
s_barrier
v_mfma_f32_32x32x16_bf16 v[128:143], v[160:163], v[16:19], 0
ds_read_b128 v[32:35], v6 offset:24576
ds_read_b64_tr_b16 v[176:177], v10 offset:24576
ds_read_b64_tr_b16 v[178:179], v10 offset:25088
v_lshlrev_b32 v248, 16, v16
v_and_b32 v249, 0xffff0000, v16
v_fmac_f32 v225, v248, v248
v_fmac_f32 v227, v249, v249
v_lshlrev_b32 v250, 16, v17
v_and_b32 v251, 0xffff0000, v17
v_fmac_f32 v225, v250, v250
v_fmac_f32 v227, v251, v251
v_mfma_f32_32x32x16_bf16 v[128:143], v[164:167], v[20:23], v[128:143]
ds_read_b128 v[36:39], v7 offset:24576
ds_read_b64_tr_b16 v[180:181], v11 offset:24576
ds_read_b64_tr_b16 v[182:183], v11 offset:25088
s_add_u32 m0, s44, 57344
s_add_u32 s33, s38, 512
buffer_load_dwordx4 v2, s[12:15], s33 offen lds
v_lshlrev_b32 v248, 16, v18
v_and_b32 v249, 0xffff0000, v18
v_fmac_f32 v225, v248, v248
v_fmac_f32 v227, v249, v249
v_lshlrev_b32 v250, 16, v19
v_and_b32 v251, 0xffff0000, v19
v_fmac_f32 v225, v250, v250
v_fmac_f32 v227, v251, v251
v_mfma_f32_16x16x32_bf16 v[240:243], v[232:235], v[160:163], 0
v_mfma_f32_32x32x16_bf16 v[128:143], v[168:171], v[24:27], v[128:143]
ds_read_b128 v[40:43], v8 offset:24576
ds_read_b64_tr_b16 v[184:185], v12 offset:24576
ds_read_b64_tr_b16 v[186:187], v12 offset:25088
buffer_load_dwordx4 v3, s[12:15], s33 offen offset:2048 lds
v_lshlrev_b32 v248, 16, v20
v_and_b32 v249, 0xffff0000, v20
v_fmac_f32 v225, v248, v248
v_fmac_f32 v227, v249, v249
v_lshlrev_b32 v250, 16, v21
v_and_b32 v251, 0xffff0000, v21
v_fmac_f32 v225, v250, v250
v_fmac_f32 v227, v251, v251
v_mfma_f32_16x16x32_bf16 v[244:247], v[232:235], v[16:19], 0
v_mfma_f32_32x32x16_bf16 v[128:143], v[172:175], v[28:31], v[128:143]
ds_read_b128 v[44:47], v9 offset:24576
ds_read_b64_tr_b16 v[188:189], v13 offset:24576
ds_read_b64_tr_b16 v[190:191], v13 offset:25088
buffer_load_dwordx4 v4, s[16:19], s39 offen offset:1024 lds
s_add_u32 s39, s39, s43
v_lshlrev_b32 v248, 16, v22
v_and_b32 v249, 0xffff0000, v22
v_fmac_f32 v225, v248, v248
v_fmac_f32 v227, v249, v249
v_lshlrev_b32 v250, 16, v23
v_and_b32 v251, 0xffff0000, v23
v_fmac_f32 v225, v250, v250
v_fmac_f32 v227, v251, v251
v_mfma_f32_16x16x32_bf16 v[244:247], v[232:235], v[20:23], v[244:247]
s_waitcnt lgkmcnt(0)
s_waitcnt vmcnt(6)
s_barrier
v_add_u32 v6, 49152, v6
v_add_u32 v7, 49152, v7
v_add_u32 v8, 49152, v8
v_add_u32 v9, 49152, v9
v_add_u32 v10, 49152, v10
v_add_u32 v11, 49152, v11
v_add_u32 v12, 49152, v12
v_add_u32 v13, 49152, v13
v_mfma_f32_32x32x16_bf16 v[128:143], v[176:179], v[32:35], v[128:143]
ds_read_b128 v[48:51], v6 offset:0
ds_read_b64_tr_b16 v[160:161], v10 offset:0
ds_read_b64_tr_b16 v[162:163], v10 offset:512
v_lshlrev_b32 v248, 16, v32
v_and_b32 v249, 0xffff0000, v32
v_fmac_f32 v225, v248, v248
v_fmac_f32 v227, v249, v249
v_lshlrev_b32 v250, 16, v33
v_and_b32 v251, 0xffff0000, v33
v_fmac_f32 v225, v250, v250
v_fmac_f32 v227, v251, v251
v_mfma_f32_32x32x16_bf16 v[128:143], v[180:183], v[36:39], v[128:143]
ds_read_b128 v[52:55], v7 offset:0
ds_read_b64_tr_b16 v[164:165], v11 offset:0
ds_read_b64_tr_b16 v[166:167], v11 offset:512
s_add_u32 m0, s44, 81920
s_add_u32 s33, s38, 640
buffer_load_dwordx4 v2, s[12:15], s33 offen lds
v_lshlrev_b32 v248, 16, v34
v_and_b32 v249, 0xffff0000, v34
v_fmac_f32 v225, v248, v248
v_fmac_f32 v227, v249, v249
v_lshlrev_b32 v250, 16, v35
v_and_b32 v251, 0xffff0000, v35
v_fmac_f32 v225, v250, v250
v_fmac_f32 v227, v251, v251
v_mfma_f32_16x16x32_bf16 v[240:243], v[232:235], v[176:179], v[240:243]
v_mfma_f32_32x32x16_bf16 v[128:143], v[184:187], v[40:43], v[128:143]
ds_read_b128 v[56:59], v8 offset:0
ds_read_b64_tr_b16 v[168:169], v12 offset:0
ds_read_b64_tr_b16 v[170:171], v12 offset:512
buffer_load_dwordx4 v3, s[12:15], s33 offen offset:2048 lds
v_lshlrev_b32 v248, 16, v36
v_and_b32 v249, 0xffff0000, v36
v_fmac_f32 v225, v248, v248
v_fmac_f32 v227, v249, v249
v_lshlrev_b32 v250, 16, v37
v_and_b32 v251, 0xffff0000, v37
v_fmac_f32 v225, v250, v250
v_fmac_f32 v227, v251, v251
v_mfma_f32_16x16x32_bf16 v[244:247], v[232:235], v[32:35], v[244:247]
v_mfma_f32_32x32x16_bf16 v[128:143], v[188:191], v[44:47], v[128:143]
ds_read_b128 v[60:63], v9 offset:0
ds_read_b64_tr_b16 v[172:173], v13 offset:0
ds_read_b64_tr_b16 v[174:175], v13 offset:512
buffer_load_dwordx4 v4, s[16:19], s39 offen offset:1024 lds
s_add_u32 s39, s39, s43
v_lshlrev_b32 v248, 16, v38
v_and_b32 v249, 0xffff0000, v38
v_fmac_f32 v225, v248, v248
v_fmac_f32 v227, v249, v249
v_lshlrev_b32 v250, 16, v39
v_and_b32 v251, 0xffff0000, v39
v_fmac_f32 v225, v250, v250
v_fmac_f32 v227, v251, v251
v_mfma_f32_16x16x32_bf16 v[244:247], v[232:235], v[36:39], v[244:247]
s_waitcnt lgkmcnt(0)
s_waitcnt vmcnt(6)
s_barrier
v_mfma_f32_32x32x16_bf16 v[128:143], v[160:163], v[48:51], v[128:143]
ds_read_b128 v[64:67], v6 offset:24576
ds_read_b64_tr_b16 v[176:177], v10 offset:24576
ds_read_b64_tr_b16 v[178:179], v10 offset:25088
v_lshlrev_b32 v248, 16, v48
v_and_b32 v249, 0xffff0000, v48
v_fmac_f32 v225, v248, v248
v_fmac_f32 v227, v249, v249
v_lshlrev_b32 v250, 16, v49
v_and_b32 v251, 0xffff0000, v49
v_fmac_f32 v225, v250, v250
v_fmac_f32 v227, v251, v251
v_mfma_f32_32x32x16_bf16 v[128:143], v[164:167], v[52:55], v[128:143]
ds_read_b128 v[68:71], v7 offset:24576
ds_read_b64_tr_b16 v[180:181], v11 offset:24576
ds_read_b64_tr_b16 v[182:183], v11 offset:25088
s_add_u32 m0, s44, 106496
s_add_u32 s33, s38, 768
buffer_load_dwordx4 v2, s[12:15], s33 offen lds
v_lshlrev_b32 v248, 16, v50
v_and_b32 v249, 0xffff0000, v50
v_fmac_f32 v225, v248, v248
v_fmac_f32 v227, v249, v249
v_lshlrev_b32 v250, 16, v51
v_and_b32 v251, 0xffff0000, v51
v_fmac_f32 v225, v250, v250
v_fmac_f32 v227, v251, v251
v_mfma_f32_16x16x32_bf16 v[240:243], v[232:235], v[160:163], v[240:243]
v_mfma_f32_32x32x16_bf16 v[128:143], v[168:171], v[56:59], v[128:143]
ds_read_b128 v[72:75], v8 offset:24576
ds_read_b64_tr_b16 v[184:185], v12 offset:24576
ds_read_b64_tr_b16 v[186:187], v12 offset:25088
buffer_load_dwordx4 v3, s[12:15], s33 offen offset:2048 lds
v_lshlrev_b32 v248, 16, v52
v_and_b32 v249, 0xffff0000, v52
v_fmac_f32 v225, v248, v248
v_fmac_f32 v227, v249, v249
v_lshlrev_b32 v250, 16, v53
v_and_b32 v251, 0xffff0000, v53
v_fmac_f32 v225, v250, v250
v_fmac_f32 v227, v251, v251
v_mfma_f32_16x16x32_bf16 v[244:247], v[232:235], v[48:51], v[244:247]
v_mfma_f32_32x32x16_bf16 v[128:143], v[172:175], v[60:63], v[128:143]
ds_read_b128 v[76:79], v9 offset:24576
ds_read_b64_tr_b16 v[188:189], v13 offset:24576
ds_read_b64_tr_b16 v[190:191], v13 offset:25088
buffer_load_dwordx4 v4, s[16:19], s39 offen offset:1024 lds
s_add_u32 s39, s39, s43
v_lshlrev_b32 v248, 16, v54
v_and_b32 v249, 0xffff0000, v54
v_fmac_f32 v225, v248, v248
v_fmac_f32 v227, v249, v249
v_lshlrev_b32 v250, 16, v55
v_and_b32 v251, 0xffff0000, v55
v_fmac_f32 v225, v250, v250
v_fmac_f32 v227, v251, v251
v_mfma_f32_16x16x32_bf16 v[244:247], v[232:235], v[52:55], v[244:247]
s_waitcnt lgkmcnt(0)
s_waitcnt vmcnt(6)
s_barrier
v_subrev_u32 v6, 49152, v6
v_subrev_u32 v7, 49152, v7
v_subrev_u32 v8, 49152, v8
v_subrev_u32 v9, 49152, v9
v_subrev_u32 v10, 49152, v10
v_subrev_u32 v11, 49152, v11
v_subrev_u32 v12, 49152, v12
v_subrev_u32 v13, 49152, v13
v_mfma_f32_32x32x16_bf16 v[128:143], v[176:179], v[64:67], v[128:143]
ds_read_b128 v[80:83], v6 offset:0
ds_read_b64_tr_b16 v[160:161], v10 offset:0
ds_read_b64_tr_b16 v[162:163], v10 offset:512
v_lshlrev_b32 v248, 16, v64
v_and_b32 v249, 0xffff0000, v64
v_fmac_f32 v225, v248, v248
v_fmac_f32 v227, v249, v249
v_lshlrev_b32 v250, 16, v65
v_and_b32 v251, 0xffff0000, v65
v_fmac_f32 v225, v250, v250
v_fmac_f32 v227, v251, v251
v_mfma_f32_32x32x16_bf16 v[128:143], v[180:183], v[68:71], v[128:143]
ds_read_b128 v[84:87], v7 offset:0
ds_read_b64_tr_b16 v[164:165], v11 offset:0
ds_read_b64_tr_b16 v[166:167], v11 offset:512
s_add_u32 m0, s45, 0
s_nop 0
buffer_load_dwordx4 v5, s[20:23], s40 offen lds
s_add_u32 s40, s40, 172032
v_lshlrev_b32 v248, 16, v66
v_and_b32 v249, 0xffff0000, v66
v_fmac_f32 v225, v248, v248
v_fmac_f32 v227, v249, v249
v_lshlrev_b32 v250, 16, v67
v_and_b32 v251, 0xffff0000, v67
v_fmac_f32 v225, v250, v250
v_fmac_f32 v227, v251, v251
v_mfma_f32_16x16x32_bf16 v[240:243], v[232:235], v[176:179], v[240:243]
v_mfma_f32_32x32x16_bf16 v[128:143], v[184:187], v[72:75], v[128:143]
ds_read_b128 v[88:91], v8 offset:0
ds_read_b64_tr_b16 v[168:169], v12 offset:0
ds_read_b64_tr_b16 v[170:171], v12 offset:512
s_add_u32 m0, s45, 8192
s_nop 0
buffer_load_dwordx4 v5, s[20:23], s40 offen lds
s_add_u32 s40, s40, 172032
v_lshlrev_b32 v248, 16, v68
v_and_b32 v249, 0xffff0000, v68
v_fmac_f32 v225, v248, v248
v_fmac_f32 v227, v249, v249
v_lshlrev_b32 v250, 16, v69
v_and_b32 v251, 0xffff0000, v69
v_fmac_f32 v225, v250, v250
v_fmac_f32 v227, v251, v251
v_mfma_f32_16x16x32_bf16 v[244:247], v[232:235], v[64:67], v[244:247]
v_mfma_f32_32x32x16_bf16 v[128:143], v[188:191], v[76:79], v[128:143]
ds_read_b128 v[92:95], v9 offset:0
ds_read_b64_tr_b16 v[172:173], v13 offset:0
ds_read_b64_tr_b16 v[174:175], v13 offset:512
s_add_u32 m0, s45, 16384
s_nop 0
buffer_load_dwordx4 v5, s[20:23], s40 offen lds
s_add_u32 s40, s40, 172032
v_lshlrev_b32 v248, 16, v70
v_and_b32 v249, 0xffff0000, v70
v_fmac_f32 v225, v248, v248
v_fmac_f32 v227, v249, v249
v_lshlrev_b32 v250, 16, v71
v_and_b32 v251, 0xffff0000, v71
v_fmac_f32 v225, v250, v250
v_fmac_f32 v227, v251, v251
v_mfma_f32_16x16x32_bf16 v[244:247], v[232:235], v[68:71], v[244:247]
s_waitcnt lgkmcnt(0)
s_waitcnt vmcnt(6)
s_barrier
v_mfma_f32_32x32x16_bf16 v[128:143], v[160:163], v[80:83], v[128:143]
ds_read_b128 v[96:99], v6 offset:24576
ds_read_b64_tr_b16 v[176:177], v10 offset:24576
ds_read_b64_tr_b16 v[178:179], v10 offset:25088
v_lshlrev_b32 v248, 16, v80
v_and_b32 v249, 0xffff0000, v80
v_fmac_f32 v225, v248, v248
v_fmac_f32 v227, v249, v249
v_lshlrev_b32 v250, 16, v81
v_and_b32 v251, 0xffff0000, v81
v_fmac_f32 v225, v250, v250
v_fmac_f32 v227, v251, v251
v_mfma_f32_32x32x16_bf16 v[128:143], v[164:167], v[84:87], v[128:143]
ds_read_b128 v[100:103], v7 offset:24576
ds_read_b64_tr_b16 v[180:181], v11 offset:24576
ds_read_b64_tr_b16 v[182:183], v11 offset:25088
s_add_u32 m0, s45, 24576
s_nop 0
buffer_load_dwordx4 v5, s[20:23], s40 offen lds
s_add_u32 s40, s40, 172032
v_lshlrev_b32 v248, 16, v82
v_and_b32 v249, 0xffff0000, v82
v_fmac_f32 v225, v248, v248
v_fmac_f32 v227, v249, v249
v_lshlrev_b32 v250, 16, v83
v_and_b32 v251, 0xffff0000, v83
v_fmac_f32 v225, v250, v250
v_fmac_f32 v227, v251, v251
v_mfma_f32_16x16x32_bf16 v[240:243], v[232:235], v[160:163], v[240:243]
v_mfma_f32_32x32x16_bf16 v[128:143], v[168:171], v[88:91], v[128:143]
ds_read_b128 v[104:107], v8 offset:24576
ds_read_b64_tr_b16 v[184:185], v12 offset:24576
ds_read_b64_tr_b16 v[186:187], v12 offset:25088
v_lshlrev_b32 v248, 16, v84
v_and_b32 v249, 0xffff0000, v84
v_fmac_f32 v225, v248, v248
v_fmac_f32 v227, v249, v249
v_lshlrev_b32 v250, 16, v85
v_and_b32 v251, 0xffff0000, v85
v_fmac_f32 v225, v250, v250
v_fmac_f32 v227, v251, v251
v_mfma_f32_16x16x32_bf16 v[244:247], v[232:235], v[80:83], v[244:247]
v_mfma_f32_32x32x16_bf16 v[128:143], v[172:175], v[92:95], v[128:143]
ds_read_b128 v[108:111], v9 offset:24576
ds_read_b64_tr_b16 v[188:189], v13 offset:24576
ds_read_b64_tr_b16 v[190:191], v13 offset:25088
s_add_u32 m0, s45, 32768
s_nop 0
buffer_load_dwordx4 v5, s[20:23], s40 offen lds
s_add_u32 s40, s40, 172032
v_lshlrev_b32 v248, 16, v86
v_and_b32 v249, 0xffff0000, v86
v_fmac_f32 v225, v248, v248
v_fmac_f32 v227, v249, v249
v_lshlrev_b32 v250, 16, v87
v_and_b32 v251, 0xffff0000, v87
v_fmac_f32 v225, v250, v250
v_fmac_f32 v227, v251, v251
v_mfma_f32_16x16x32_bf16 v[244:247], v[232:235], v[84:87], v[244:247]
s_waitcnt lgkmcnt(0)
s_waitcnt vmcnt(5)
s_barrier
v_add_u32 v6, 49152, v6
v_add_u32 v7, 49152, v7
v_add_u32 v8, 49152, v8
v_add_u32 v9, 49152, v9
v_add_u32 v10, 49152, v10
v_add_u32 v11, 49152, v11
v_add_u32 v12, 49152, v12
v_add_u32 v13, 49152, v13
v_mfma_f32_32x32x16_bf16 v[128:143], v[176:179], v[96:99], v[128:143]
ds_read_b128 v[112:115], v6 offset:0
ds_read_b64_tr_b16 v[160:161], v10 offset:0
ds_read_b64_tr_b16 v[162:163], v10 offset:512
v_lshlrev_b32 v248, 16, v96
v_and_b32 v249, 0xffff0000, v96
v_fmac_f32 v225, v248, v248
v_fmac_f32 v227, v249, v249
v_lshlrev_b32 v250, 16, v97
v_and_b32 v251, 0xffff0000, v97
v_fmac_f32 v225, v250, v250
v_fmac_f32 v227, v251, v251
v_mfma_f32_32x32x16_bf16 v[128:143], v[180:183], v[100:103], v[128:143]
ds_read_b128 v[116:119], v7 offset:0
ds_read_b64_tr_b16 v[164:165], v11 offset:0
ds_read_b64_tr_b16 v[166:167], v11 offset:512
s_add_u32 m0, s45, 40960
s_nop 0
buffer_load_dwordx4 v5, s[20:23], s40 offen lds
s_add_u32 s40, s40, 172032
v_lshlrev_b32 v248, 16, v98
v_and_b32 v249, 0xffff0000, v98
v_fmac_f32 v225, v248, v248
v_fmac_f32 v227, v249, v249
v_lshlrev_b32 v250, 16, v99
v_and_b32 v251, 0xffff0000, v99
v_fmac_f32 v225, v250, v250
v_fmac_f32 v227, v251, v251
v_mfma_f32_16x16x32_bf16 v[240:243], v[232:235], v[176:179], v[240:243]
v_mfma_f32_32x32x16_bf16 v[128:143], v[184:187], v[104:107], v[128:143]
ds_read_b128 v[120:123], v8 offset:0
ds_read_b64_tr_b16 v[168:169], v12 offset:0
ds_read_b64_tr_b16 v[170:171], v12 offset:512
v_lshlrev_b32 v248, 16, v100
v_and_b32 v249, 0xffff0000, v100
v_fmac_f32 v225, v248, v248
v_fmac_f32 v227, v249, v249
v_lshlrev_b32 v250, 16, v101
v_and_b32 v251, 0xffff0000, v101
v_fmac_f32 v225, v250, v250
v_fmac_f32 v227, v251, v251
v_mfma_f32_16x16x32_bf16 v[244:247], v[232:235], v[96:99], v[244:247]
v_mfma_f32_32x32x16_bf16 v[128:143], v[188:191], v[108:111], v[128:143]
ds_read_b128 v[124:127], v9 offset:0
ds_read_b64_tr_b16 v[172:173], v13 offset:0
ds_read_b64_tr_b16 v[174:175], v13 offset:512
s_add_u32 m0, s45, 49152
s_nop 0
buffer_load_dwordx4 v5, s[20:23], s40 offen lds
s_add_u32 s40, s40, 172032
v_lshlrev_b32 v248, 16, v102
v_and_b32 v249, 0xffff0000, v102
v_fmac_f32 v225, v248, v248
v_fmac_f32 v227, v249, v249
v_lshlrev_b32 v250, 16, v103
v_and_b32 v251, 0xffff0000, v103
v_fmac_f32 v225, v250, v250
v_fmac_f32 v227, v251, v251
v_mfma_f32_16x16x32_bf16 v[244:247], v[232:235], v[100:103], v[244:247]
s_waitcnt lgkmcnt(0)
s_waitcnt vmcnt(4)
s_barrier
v_mfma_f32_32x32x16_bf16 v[128:143], v[160:163], v[112:115], v[128:143]
s_xor_b32 s35, s46, 0
s_lshl_b32 s35, s35, 11
v_add_u32 v10, s35, v15
s_xor_b32 s35, s46, 1
s_lshl_b32 s35, s35, 11
v_add_u32 v11, s35, v15
s_xor_b32 s35, s46, 2
s_lshl_b32 s35, s35, 11
v_add_u32 v12, s35, v15
s_xor_b32 s35, s46, 3
s_lshl_b32 s35, s35, 11
v_add_u32 v13, s35, v15
ds_read_b64_tr_b16 v[176:177], v10 offset:0
v_lshlrev_b32 v248, 16, v112
v_and_b32 v249, 0xffff0000, v112
v_fmac_f32 v225, v248, v248
v_fmac_f32 v227, v249, v249
v_lshlrev_b32 v250, 16, v113
v_and_b32 v251, 0xffff0000, v113
v_fmac_f32 v225, v250, v250
v_fmac_f32 v227, v251, v251
v_mfma_f32_32x32x16_bf16 v[128:143], v[164:167], v[116:119], v[128:143]
ds_read_b64_tr_b16 v[178:179], v10 offset:512
ds_read_b64_tr_b16 v[180:181], v11 offset:0
v_lshlrev_b32 v248, 16, v114
v_and_b32 v249, 0xffff0000, v114
v_fmac_f32 v225, v248, v248
v_fmac_f32 v227, v249, v249
v_lshlrev_b32 v250, 16, v115
v_and_b32 v251, 0xffff0000, v115
v_fmac_f32 v225, v250, v250
v_fmac_f32 v227, v251, v251
v_mfma_f32_16x16x32_bf16 v[240:243], v[232:235], v[160:163], v[240:243]
v_mfma_f32_32x32x16_bf16 v[128:143], v[168:171], v[120:123], v[128:143]
ds_read_b64_tr_b16 v[182:183], v11 offset:512
ds_read_b64_tr_b16 v[184:185], v12 offset:0
v_lshlrev_b32 v248, 16, v116
v_and_b32 v249, 0xffff0000, v116
v_fmac_f32 v225, v248, v248
v_fmac_f32 v227, v249, v249
v_lshlrev_b32 v250, 16, v117
v_and_b32 v251, 0xffff0000, v117
v_fmac_f32 v225, v250, v250
v_fmac_f32 v227, v251, v251
v_mfma_f32_16x16x32_bf16 v[244:247], v[232:235], v[112:115], v[244:247]
v_mfma_f32_32x32x16_bf16 v[128:143], v[172:175], v[124:127], v[128:143]
ds_read_b64_tr_b16 v[186:187], v12 offset:512
ds_read_b64_tr_b16 v[188:189], v13 offset:0
ds_read_b64_tr_b16 v[190:191], v13 offset:512
v_lshlrev_b32 v248, 16, v118
v_and_b32 v249, 0xffff0000, v118
v_fmac_f32 v225, v248, v248
v_fmac_f32 v227, v249, v249
v_lshlrev_b32 v250, 16, v119
v_and_b32 v251, 0xffff0000, v119
v_fmac_f32 v225, v250, v250
v_fmac_f32 v227, v251, v251
v_mfma_f32_16x16x32_bf16 v[244:247], v[232:235], v[116:119], v[244:247]
s_and_b32 s33, s28, 7
s_cmp_ge_u32 s33, 2
s_cbranch_scc1 P1_BL
s_mov_b32 s12, s74
s_and_b32 s13, s75, 0xffff
s_mov_b32 s14, 8388608
s_mov_b32 s15, 0x20000
s_waitcnt lgkmcnt(6)
v_mfma_f32_32x32x16_bf16 v[144:159], v[16:19], v[176:179], 0
ds_read_b64_tr_b16 v[192:193], v10 offset:8192
ds_read_b64_tr_b16 v[194:195], v10 offset:8704
v_lshrrev_b32 v2, 1, v253
buffer_load_dword v2, v2, s[4:7], 0 offen sc1
v_mfma_f32_16x16x32_bf16 v[220:223], v[232:235], v[176:179], 0
v_add_f32 v245, v225, v227
s_lshl_b32 s33, s30, 9
s_add_u32 s33, s33, 118784
v_add_u32 v15, s33, v253
ds_write_b64 v15, v[244:245]
ds_write_b32 v254, v240 offset:0
v_xor_b32 v15, 2048, v15
s_waitcnt lgkmcnt(8)
v_mfma_f32_32x32x16_bf16 v[144:159], v[20:23], v[180:183], v[144:159]
ds_read_b64_tr_b16 v[176:177], v11 offset:8192
ds_read_b64_tr_b16 v[178:179], v11 offset:8704
s_add_u32 m0, s45, 57344
s_nop 0
buffer_load_dwordx4 v4, s[16:19], s41 offen lds
s_add_u32 s41, s41, s43
s_waitcnt lgkmcnt(8)
v_mfma_f32_32x32x16_bf16 v[144:159], v[24:27], v[184:187], v[144:159]
ds_read_b64_tr_b16 v[180:181], v12 offset:8192
ds_read_b64_tr_b16 v[182:183], v12 offset:8704
s_add_u32 m0, s45, 65536
s_nop 0
buffer_load_dwordx4 v4, s[16:19], s41 offen lds
s_add_u32 s41, s41, s43
s_waitcnt lgkmcnt(4)
s_barrier
v_mfma_f32_32x32x16_bf16 v[144:159], v[28:31], v[188:191], v[144:159]
ds_read_b64_tr_b16 v[184:185], v13 offset:8192
ds_read_b64_tr_b16 v[186:187], v13 offset:8704
s_add_u32 m0, s45, 73728
s_nop 0
buffer_load_dwordx4 v4, s[16:19], s41 offen lds
s_add_u32 s41, s41, s43
ds_read_b64 v[196:197], v15
v_and_b32 v15, 0xfffffff0, v254
ds_read_b128 v[200:203], v15 offset:0
v_mfma_f32_32x32x16_bf16 v[144:159], v[32:35], v[192:195], v[144:159]
ds_read_b64_tr_b16 v[188:189], v10 offset:16384
ds_read_b64_tr_b16 v[190:191], v10 offset:16896
s_add_u32 m0, s45, 81920
s_nop 0
buffer_load_dwordx4 v4, s[16:19], s41 offen lds
s_add_u32 s41, s41, s43
s_waitcnt lgkmcnt(3)
v_add_f32 v224, v244, v196
v_add_f32 v225, v245, v197
v_mov_b32 v196, v224
v_mov_b32 v197, v225
v_mov_b32 v241, 0
v_mov_b32 v242, 0
v_permlane32_swap_b32 v197, v225
v_add_f32 v225, v225, v197
v_mul_f32 v224, 0xbb124925, v224
v_mul_f32 v225, 0x3b124925, v225
v_and_b32 v196, 0xffff0000, v224
v_fma_f32 v225, -v224, v224, v225
v_sub_f32 v197, v224, v196
v_mfma_f32_16x16x32_bf16 v[220:223], v[232:235], v[192:195], v[220:223]
v_mfma_f32_32x32x16_bf16 v[144:159], v[36:39], v[176:179], v[144:159]
ds_read_b64_tr_b16 v[192:193], v11 offset:16384
ds_read_b64_tr_b16 v[194:195], v11 offset:16896
s_add_u32 m0, s45, 90112
s_nop 0
buffer_load_dwordx4 v4, s[16:19], s41 offen lds
s_add_u32 s41, s41, s43
v_max_f32 v225, 0, v225
v_cndmask_b32 v196, v196, v197, s[54:55]
v_add_f32 v225, 0x3727c5ac, v225
v_cvt_pk_bf16_f32 v236, v196, v196
v_rsq_f32 v226, v225
v_mov_b32 v243, 0
s_waitcnt lgkmcnt(4)
v_add_f32 v200, v200, v201
v_add_f32 v202, v202, v203
v_add_f32 v200, v200, v202
v_and_b32 v201, 0xffff0000, v200
v_sub_f32 v200, v200, v201
v_cvt_pk_bf16_f32 v240, v201, v200
v_mul_f32 v229, v225, v226
v_mfma_f32_32x32x16_bf16 v[144:159], v[40:43], v[180:183], v[144:159]
ds_read_b64_tr_b16 v[176:177], v12 offset:16384
ds_read_b64_tr_b16 v[178:179], v12 offset:16896
s_add_u32 m0, s45, 98304
s_nop 0
buffer_load_dwordx4 v4, s[16:19], s41 offen lds
s_add_u32 s41, s41, s43
v_mul_f32 v227, 0xc0135761, v226
v_mfma_f32_32x32x16_bf16 v[128:143], v[240:243], v[236:239], v[128:143]
v_mul_f32 v228, v226, v226
v_mul_f32 v228, v228, v226
v_mul_f32 v228, 0xbdd2d3e8, v228
v_mfma_f32_32x32x16_bf16 v[144:159], v[44:47], v[184:187], v[144:159]
ds_read_b64_tr_b16 v[180:181], v13 offset:16384
ds_read_b64_tr_b16 v[182:183], v13 offset:16896
s_add_u32 m0, s45, 106496
s_nop 0
buffer_load_dwordx4 v4, s[16:19], s41 offen lds
s_add_u32 s41, s41, s43
s_waitcnt vmcnt(8)
s_barrier
s_waitcnt lgkmcnt(6)
v_mfma_f32_32x32x16_bf16 v[144:159], v[48:51], v[188:191], v[144:159]
ds_read_b64_tr_b16 v[184:185], v10 offset:24576
ds_read_b64_tr_b16 v[186:187], v10 offset:25088
s_mov_b32 s16, s68
s_and_b32 s17, s69, 0xffff
s_mov_b32 s18, 401408
s_mov_b32 s19, 0x20000
s_mov_b32 s20, s78
s_and_b32 s21, s79, 0xffff
s_mov_b32 s22, 802816
s_mov_b32 s23, 0x20000
s_mov_b32 s40, 0x33333333
s_mov_b32 s41, 0x33333333
v_mfma_f32_16x16x32_bf16 v[220:223], v[232:235], v[188:191], v[220:223]
s_waitcnt lgkmcnt(6)
v_mfma_f32_32x32x16_bf16 v[144:159], v[52:55], v[192:195], v[144:159]
ds_read_b64_tr_b16 v[188:189], v11 offset:24576
ds_read_b64_tr_b16 v[190:191], v11 offset:25088
v_mul_f32 v196, v128, v128
v_mul_f32 v197, v129, v129
v_mul_f32 v198, v130, v130
v_mul_f32 v199, v131, v131
v_mul_f32 v200, v132, v132
v_mul_f32 v201, v133, v133
v_mul_f32 v202, v134, v134
v_mul_f32 v203, v135, v135
v_fma_f32 v196, v196, v228, v227
v_fma_f32 v197, v197, v228, v227
v_fma_f32 v198, v198, v228, v227
v_fma_f32 v199, v199, v228, v227
v_fma_f32 v200, v200, v228, v227
v_fma_f32 v201, v201, v228, v227
v_fma_f32 v202, v202, v228, v227
v_fma_f32 v203, v203, v228, v227
v_mul_f32 v196, v196, v128
v_mul_f32 v197, v197, v129
s_waitcnt lgkmcnt(6)
v_mfma_f32_32x32x16_bf16 v[144:159], v[56:59], v[176:179], v[144:159]
ds_read_b64_tr_b16 v[192:193], v12 offset:24576
ds_read_b64_tr_b16 v[194:195], v12 offset:25088
v_mul_f32 v198, v198, v130
v_mul_f32 v199, v199, v131
v_mul_f32 v200, v200, v132
v_mul_f32 v201, v201, v133
v_mul_f32 v202, v202, v134
v_mul_f32 v203, v203, v135
v_exp_f32 v196, v196
v_exp_f32 v197, v197
v_exp_f32 v198, v198
v_exp_f32 v199, v199
v_exp_f32 v200, v200
v_exp_f32 v201, v201
v_exp_f32 v202, v202
v_exp_f32 v203, v203
v_fma_f32 v196, v196, v229, v229
v_fma_f32 v197, v197, v229, v229
v_fma_f32 v198, v198, v229, v229
s_waitcnt lgkmcnt(6)
v_mfma_f32_32x32x16_bf16 v[144:159], v[60:63], v[180:183], v[144:159]
ds_read_b64_tr_b16 v[176:177], v13 offset:24576
ds_read_b64_tr_b16 v[178:179], v13 offset:25088
v_fma_f32 v199, v199, v229, v229
v_fma_f32 v200, v200, v229, v229
v_fma_f32 v201, v201, v229, v229
v_fma_f32 v202, v202, v229, v229
v_fma_f32 v203, v203, v229, v229
v_rcp_f32 v196, v196
v_rcp_f32 v197, v197
v_rcp_f32 v198, v198
v_rcp_f32 v199, v199
v_rcp_f32 v200, v200
v_rcp_f32 v201, v201
v_rcp_f32 v202, v202
v_rcp_f32 v203, v203
v_mul_f32 v128, v196, v128
v_mul_f32 v129, v197, v129
v_mul_f32 v130, v198, v130
v_mul_f32 v131, v199, v131
s_waitcnt lgkmcnt(6)
v_mfma_f32_32x32x16_bf16 v[144:159], v[64:67], v[184:187], v[144:159]
ds_read_b64_tr_b16 v[180:181], v10 offset:32768
ds_read_b64_tr_b16 v[182:183], v10 offset:33280
v_mul_f32 v132, v200, v132
v_mul_f32 v133, v201, v133
v_mul_f32 v134, v202, v134
v_mul_f32 v135, v203, v135
v_mov_b32 v224, v128
v_mul_f32 v225, v128, v128
v_add_f32 v224, v224, v129
v_fmac_f32 v225, v129, v129
v_add_f32 v224, v224, v130
v_fmac_f32 v225, v130, v130
v_add_f32 v224, v224, v131
v_fmac_f32 v225, v131, v131
v_add_f32 v224, v224, v132
v_fmac_f32 v225, v132, v132
v_add_f32 v224, v224, v133
v_fmac_f32 v225, v133, v133
v_add_f32 v224, v224, v134
v_mfma_f32_16x16x32_bf16 v[220:223], v[232:235], v[184:187], v[220:223]
s_waitcnt lgkmcnt(6)
v_mfma_f32_32x32x16_bf16 v[144:159], v[68:71], v[188:191], v[144:159]
ds_read_b64_tr_b16 v[184:185], v11 offset:32768
ds_read_b64_tr_b16 v[186:187], v11 offset:33280
v_fmac_f32 v225, v134, v134
v_add_f32 v224, v224, v135
v_fmac_f32 v225, v135, v135
v_mul_f32 v204, v136, v136
v_mul_f32 v205, v137, v137
v_mul_f32 v206, v138, v138
v_mul_f32 v207, v139, v139
v_mul_f32 v208, v140, v140
v_mul_f32 v209, v141, v141
v_mul_f32 v210, v142, v142
v_mul_f32 v211, v143, v143
v_fma_f32 v204, v204, v228, v227
v_fma_f32 v205, v205, v228, v227
v_fma_f32 v206, v206, v228, v227
v_fma_f32 v207, v207, v228, v227
v_fma_f32 v208, v208, v228, v227
v_fma_f32 v209, v209, v228, v227
s_waitcnt lgkmcnt(6)
v_mfma_f32_32x32x16_bf16 v[144:159], v[72:75], v[192:195], v[144:159]
ds_read_b64_tr_b16 v[188:189], v12 offset:32768
ds_read_b64_tr_b16 v[190:191], v12 offset:33280
v_fma_f32 v210, v210, v228, v227
v_fma_f32 v211, v211, v228, v227
v_mul_f32 v204, v204, v136
v_mul_f32 v205, v205, v137
v_mul_f32 v206, v206, v138
v_mul_f32 v207, v207, v139
v_mul_f32 v208, v208, v140
v_mul_f32 v209, v209, v141
v_mul_f32 v210, v210, v142
v_mul_f32 v211, v211, v143
v_exp_f32 v204, v204
v_exp_f32 v205, v205
v_exp_f32 v206, v206
v_exp_f32 v207, v207
v_exp_f32 v208, v208
v_exp_f32 v209, v209
v_exp_f32 v210, v210
s_waitcnt lgkmcnt(6)
v_mfma_f32_32x32x16_bf16 v[144:159], v[76:79], v[176:179], v[144:159]
ds_read_b64_tr_b16 v[192:193], v13 offset:32768
ds_read_b64_tr_b16 v[194:195], v13 offset:33280
v_exp_f32 v211, v211
v_fma_f32 v204, v204, v229, v229
v_fma_f32 v205, v205, v229, v229
v_fma_f32 v206, v206, v229, v229
v_fma_f32 v207, v207, v229, v229
v_fma_f32 v208, v208, v229, v229
v_fma_f32 v209, v209, v229, v229
v_fma_f32 v210, v210, v229, v229
v_fma_f32 v211, v211, v229, v229
v_rcp_f32 v204, v204
v_rcp_f32 v205, v205
v_rcp_f32 v206, v206
v_rcp_f32 v207, v207
v_rcp_f32 v208, v208
v_rcp_f32 v209, v209
v_rcp_f32 v210, v210
v_rcp_f32 v211, v211
s_waitcnt lgkmcnt(6)
v_mfma_f32_32x32x16_bf16 v[144:159], v[80:83], v[180:183], v[144:159]
ds_read_b64_tr_b16 v[176:177], v10 offset:40960
ds_read_b64_tr_b16 v[178:179], v10 offset:41472
v_mul_f32 v136, v204, v136
v_mul_f32 v137, v205, v137
v_mul_f32 v138, v206, v138
v_mul_f32 v139, v207, v139
v_mul_f32 v140, v208, v140
v_mul_f32 v141, v209, v141
v_mul_f32 v142, v210, v142
v_mul_f32 v143, v211, v143
v_add_f32 v224, v224, v136
v_fmac_f32 v225, v136, v136
v_add_f32 v224, v224, v137
v_fmac_f32 v225, v137, v137
v_add_f32 v224, v224, v138
v_fmac_f32 v225, v138, v138
v_add_f32 v224, v224, v139
v_fmac_f32 v225, v139, v139
v_add_f32 v224, v224, v140
v_mfma_f32_16x16x32_bf16 v[220:223], v[232:235], v[180:183], v[220:223]
s_waitcnt lgkmcnt(6)
v_mfma_f32_32x32x16_bf16 v[144:159], v[84:87], v[184:187], v[144:159]
ds_read_b64_tr_b16 v[180:181], v11 offset:40960
ds_read_b64_tr_b16 v[182:183], v11 offset:41472
v_fmac_f32 v225, v140, v140
v_add_f32 v224, v224, v141
v_fmac_f32 v225, v141, v141
v_add_f32 v224, v224, v142
v_fmac_f32 v225, v142, v142
v_add_f32 v224, v224, v143
v_fmac_f32 v225, v143, v143
v_mov_b32 v196, v224
v_mov_b32 v197, v225
s_lshl_b32 s33, s30, 9
s_add_u32 s33, s33, 118784
v_add_u32 v8, s33, v253
v_mov_b32 v227, 1
v_permlane32_swap_b32 v196, v224
v_permlane32_swap_b32 v197, v225
v_add_f32 v224, v224, v196
v_add_f32 v225, v225, v197
ds_write_b64 v8, v[224:225]
v_xor_b32 v8, 2048, v8
s_waitcnt lgkmcnt(0)
s_barrier
v_mfma_f32_32x32x16_bf16 v[144:159], v[88:91], v[188:191], v[144:159]
ds_read_b64_tr_b16 v[184:185], v12 offset:40960
ds_read_b64_tr_b16 v[186:187], v12 offset:41472
ds_read_b64 v[196:197], v8
s_waitcnt vmcnt(7)
P1_B_CR:
v_cmp_eq_u32 vcc, 0, v2
s_and_b64 vcc, vcc, s[40:41]
s_cbranch_vccnz P1_B_CW
P1_B_CX:
v_mfma_f32_32x32x16_bf16 v[144:159], v[92:95], v[192:195], v[144:159]
ds_read_b64_tr_b16 v[188:189], v13 offset:40960
ds_read_b64_tr_b16 v[190:191], v13 offset:41472
s_waitcnt lgkmcnt(2)
v_add_f32 v224, v224, v196
v_add_f32 v225, v225, v197
s_lshl_b32 s33, s32, 4
s_lshl_b32 exec_lo, 0xffff, s33
s_mov_b32 exec_hi, 0
buffer_store_dwordx2 v[224:225], v253, s[24:27], s10 offen sc1
s_mov_b64 exec, -1
s_and_b32 s10, s10, 0xfffff000
v_mfma_f32_32x32x16_bf16 v[144:159], v[96:99], v[176:179], v[144:159]
ds_read_b64_tr_b16 v[192:193], v10 offset:49152
ds_read_b64_tr_b16 v[194:195], v10 offset:49664
v_mfma_f32_16x16x32_bf16 v[220:223], v[232:235], v[176:179], v[220:223]
v_mfma_f32_32x32x16_bf16 v[144:159], v[100:103], v[180:183], v[144:159]
ds_read_b64_tr_b16 v[176:177], v11 offset:49152
ds_read_b64_tr_b16 v[178:179], v11 offset:49664
v_mfma_f32_32x32x16_bf16 v[144:159], v[104:107], v[184:187], v[144:159]
ds_read_b64_tr_b16 v[180:181], v12 offset:49152
ds_read_b64_tr_b16 v[182:183], v12 offset:49664
s_waitcnt lgkmcnt(6)
v_mfma_f32_32x32x16_bf16 v[144:159], v[108:111], v[188:191], v[144:159]
ds_read_b64_tr_b16 v[184:185], v13 offset:49152
ds_read_b64_tr_b16 v[186:187], v13 offset:49664
s_waitcnt vmcnt(1)
s_barrier
s_waitcnt lgkmcnt(6)
v_mfma_f32_32x32x16_bf16 v[144:159], v[112:115], v[192:195], v[144:159]
v_add_u32 v10, 57344, v10
v_add_u32 v11, 57344, v11
v_add_u32 v12, 57344, v12
v_add_u32 v13, 57344, v13
ds_read_b64_tr_b16 v[188:189], v10 offset:0
ds_read_b64_tr_b16 v[190:191], v10 offset:512
v_mfma_f32_16x16x32_bf16 v[220:223], v[232:235], v[192:195], v[220:223]
s_waitcnt lgkmcnt(6)
v_mfma_f32_32x32x16_bf16 v[144:159], v[116:119], v[176:179], v[144:159]
ds_read_b64_tr_b16 v[192:193], v11 offset:0
ds_read_b64_tr_b16 v[194:195], v11 offset:512
s_waitcnt lgkmcnt(6)
v_mfma_f32_32x32x16_bf16 v[144:159], v[120:123], v[180:183], v[144:159]
ds_read_b64_tr_b16 v[176:177], v12 offset:0
ds_read_b64_tr_b16 v[178:179], v12 offset:512
s_waitcnt lgkmcnt(6)
v_mfma_f32_32x32x16_bf16 v[144:159], v[124:127], v[184:187], v[144:159]
ds_read_b64_tr_b16 v[180:181], v13 offset:0
ds_read_b64_tr_b16 v[182:183], v13 offset:512
ds_write_b32 v254, v220 offset:2048
buffer_load_dwordx2 v[2:3], v253, s[24:27], s10 offen offset:0 sc1
buffer_load_dwordx2 v[4:5], v253, s[24:27], s10 offen offset:512 sc1
buffer_load_dwordx2 v[6:7], v253, s[24:27], s10 offen offset:1024 sc1
buffer_load_dwordx2 v[8:9], v253, s[24:27], s10 offen offset:1536 sc1
buffer_load_dwordx2 v[244:245], v253, s[24:27], s10 offen offset:2048 sc1
buffer_load_dwordx2 v[246:247], v253, s[24:27], s10 offen offset:2560 sc1
buffer_load_dwordx2 v[228:229], v253, s[24:27], s10 offen offset:3072 sc1
s_waitcnt lgkmcnt(7)
v_mfma_f32_32x32x16_bf16 v[160:175], v[188:191], v[16:19], 0
ds_read_b64_tr_b16 v[184:185], v10 offset:8192
ds_read_b64_tr_b16 v[186:187], v10 offset:8704
v_mfma_f32_16x16x32_bf16 v[220:223], v[232:235], v[188:191], 0
s_waitcnt lgkmcnt(7)
v_mfma_f32_32x32x16_bf16 v[160:175], v[192:195], v[20:23], v[160:175]
ds_read_b64_tr_b16 v[188:189], v11 offset:8192
ds_read_b64_tr_b16 v[190:191], v11 offset:8704
s_waitcnt lgkmcnt(4)
s_barrier
v_mfma_f32_32x32x16_bf16 v[160:175], v[176:179], v[24:27], v[160:175]
ds_read_b64_tr_b16 v[192:193], v12 offset:8192
ds_read_b64_tr_b16 v[194:195], v12 offset:8704
v_mfma_f32_32x32x16_bf16 v[160:175], v[180:183], v[28:31], v[160:175]
ds_read_b64_tr_b16 v[176:177], v13 offset:8192
ds_read_b64_tr_b16 v[178:179], v13 offset:8704
s_waitcnt lgkmcnt(6)
v_mfma_f32_32x32x16_bf16 v[160:175], v[184:187], v[32:35], v[160:175]
ds_read_b64_tr_b16 v[180:181], v10 offset:16384
ds_read_b64_tr_b16 v[182:183], v10 offset:16896
s_waitcnt vmcnt(0)
P1_B_PR:
v_max3_u32 v224, v3, v5, v7
v_max3_u32 v225, v9, v245, v247
v_max3_u32 v224, v224, v225, v229
v_cmp_eq_u32 vcc, -1, v224
s_cbranch_vccnz P1_B_PW
P1_B_PX:
v_add_f32 v2, v2, v4
v_add_f32 v3, v3, v5
v_add_f32 v6, v6, v8
v_add_f32 v7, v7, v9
v_add_f32 v244, v244, v246
v_add_f32 v245, v245, v247
v_add_f32 v2, v2, v6
v_add_f32 v3, v3, v7
v_mfma_f32_16x16x32_bf16 v[220:223], v[232:235], v[184:187], v[220:223]
s_waitcnt lgkmcnt(6)
v_mfma_f32_32x32x16_bf16 v[160:175], v[188:191], v[36:39], v[160:175]
ds_read_b64_tr_b16 v[184:185], v11 offset:16384
ds_read_b64_tr_b16 v[186:187], v11 offset:16896
v_add_f32 v244, v244, v228
v_add_f32 v245, v245, v229
v_add_f32 v2, v2, v244
v_add_f32 v3, v3, v245
v_mov_b32 v4, v2
v_mov_b32 v5, v3
s_nop 0
v_permlane32_swap_b32 v4, v2
v_permlane32_swap_b32 v5, v3
s_waitcnt lgkmcnt(6)
v_mfma_f32_32x32x16_bf16 v[160:175], v[192:195], v[40:43], v[160:175]
ds_read_b64_tr_b16 v[188:189], v12 offset:16384
ds_read_b64_tr_b16 v[190:191], v12 offset:16896
v_add_f32 v2, v2, v4
v_add_f32 v3, v3, v5
v_mul_f32 v2, 0xba924925, v2
v_mul_f32 v3, 0x3a924925, v3
v_fma_f32 v3, -v2, v2, v3
v_max_f32 v3, 0, v3
v_add_f32 v3, 0x3727c5ac, v3
v_rsq_f32 v3, v3
s_nop 0
s_waitcnt lgkmcnt(6)
v_mfma_f32_32x32x16_bf16 v[160:175], v[176:179], v[44:47], v[160:175]
ds_read_b64_tr_b16 v[192:193], v13 offset:16384
ds_read_b64_tr_b16 v[194:195], v13 offset:16896
v_mul_f32 v2, v2, v3
v_fma_f32 v128, v128, v3, v2
v_fma_f32 v129, v129, v3, v2
v_fma_f32 v130, v130, v3, v2
v_fma_f32 v131, v131, v3, v2
v_fma_f32 v132, v132, v3, v2
v_fma_f32 v133, v133, v3, v2
v_fma_f32 v134, v134, v3, v2
v_fma_f32 v135, v135, v3, v2
s_waitcnt lgkmcnt(6)
v_mfma_f32_32x32x16_bf16 v[160:175], v[180:183], v[48:51], v[160:175]
ds_read_b64_tr_b16 v[176:177], v10 offset:24576
ds_read_b64_tr_b16 v[178:179], v10 offset:25088
v_cvt_pk_bf16_f32 v128, v128, v129
v_cvt_pk_bf16_f32 v129, v130, v131
v_cvt_pk_bf16_f32 v130, v132, v133
v_cvt_pk_bf16_f32 v131, v134, v135
buffer_store_dwordx4 v[128:131], v14, s[24:27], s47 offen sc1
v_fma_f32 v136, v136, v3, v2
v_fma_f32 v137, v137, v3, v2
v_fma_f32 v138, v138, v3, v2
v_fma_f32 v139, v139, v3, v2
v_mfma_f32_16x16x32_bf16 v[220:223], v[232:235], v[180:183], v[220:223]
s_waitcnt lgkmcnt(6)
v_mfma_f32_32x32x16_bf16 v[160:175], v[184:187], v[52:55], v[160:175]
ds_read_b64_tr_b16 v[180:181], v11 offset:24576
ds_read_b64_tr_b16 v[182:183], v11 offset:25088
v_fma_f32 v140, v140, v3, v2
v_fma_f32 v141, v141, v3, v2
v_fma_f32 v142, v142, v3, v2
v_fma_f32 v143, v143, v3, v2
v_cvt_pk_bf16_f32 v132, v136, v137
v_cvt_pk_bf16_f32 v133, v138, v139
v_cvt_pk_bf16_f32 v134, v140, v141
v_cvt_pk_bf16_f32 v135, v142, v143
buffer_store_dwordx4 v[132:135], v14, s[24:27], s47 offen offset:1024 sc1
s_waitcnt lgkmcnt(6)
v_mfma_f32_32x32x16_bf16 v[160:175], v[188:191], v[56:59], v[160:175]
ds_read_b64_tr_b16 v[184:185], v12 offset:24576
ds_read_b64_tr_b16 v[186:187], v12 offset:25088
s_lshl_b32 s35, s30, 8
s_add_u32 s35, s35, 122880
v_lshl_add_u32 v6, v1, 2, s35
ds_write_b32 v6, v226
v_lshrrev_b32 v7, 5, v1
v_lshl_add_u32 v7, v7, 4, s35
ds_read_b128 v[248:251], v15 offset:2048
s_waitcnt lgkmcnt(8)
v_mfma_f32_32x32x16_bf16 v[160:175], v[192:195], v[60:63], v[160:175]
ds_read_b64_tr_b16 v[188:189], v13 offset:24576
ds_read_b64_tr_b16 v[190:191], v13 offset:25088
s_waitcnt lgkmcnt(2)
v_add_f32 v248, v248, v249
v_add_f32 v250, v250, v251
v_add_f32 v248, v248, v250
v_and_b32 v249, 0xffff0000, v248
v_sub_f32 v248, v248, v249
v_cvt_pk_bf16_f32 v240, v249, v248
s_nop 1
v_mfma_f32_32x32x16_bf16 v[160:175], v[176:179], v[64:67], v[160:175]
ds_read_b64_tr_b16 v[192:193], v10 offset:32768
ds_read_b64_tr_b16 v[194:195], v10 offset:33280
v_mfma_f32_32x32x16_bf16 v[144:159], v[236:239], v[240:243], v[144:159]
ds_read_b128 v[16:19], v7 offset:0
ds_read_b128 v[20:23], v7 offset:32
ds_read_b128 v[24:27], v7 offset:64
ds_read_b128 v[28:31], v7 offset:96
v_mfma_f32_16x16x32_bf16 v[220:223], v[232:235], v[176:179], v[220:223]
v_mfma_f32_32x32x16_bf16 v[160:175], v[180:183], v[68:71], v[160:175]
ds_read_b64_tr_b16 v[176:177], v11 offset:32768
ds_read_b64_tr_b16 v[178:179], v11 offset:33280
v_mfma_f32_32x32x16_bf16 v[160:175], v[184:187], v[72:75], v[160:175]
ds_read_b64_tr_b16 v[180:181], v12 offset:32768
ds_read_b64_tr_b16 v[182:183], v12 offset:33280
s_waitcnt lgkmcnt(10)
v_mfma_f32_32x32x16_bf16 v[160:175], v[188:191], v[76:79], v[160:175]
ds_read_b64_tr_b16 v[184:185], v13 offset:32768
ds_read_b64_tr_b16 v[186:187], v13 offset:33280
s_waitcnt lgkmcnt(6)
v_fmaak_f32 v144, v144, v16, 0x358637bd
v_fmaak_f32 v145, v145, v17, 0x358637bd
v_fmaak_f32 v146, v146, v18, 0x358637bd
v_fmaak_f32 v147, v147, v19, 0x358637bd
v_fmaak_f32 v148, v148, v20, 0x358637bd
v_fmaak_f32 v149, v149, v21, 0x358637bd
v_fmaak_f32 v150, v150, v22, 0x358637bd
v_fmaak_f32 v151, v151, v23, 0x358637bd
v_fmaak_f32 v196, v144, v230, 0xb5c1a2a0
v_mfma_f32_32x32x16_bf16 v[160:175], v[192:195], v[80:83], v[160:175]
ds_read_b64_tr_b16 v[188:189], v10 offset:40960
ds_read_b64_tr_b16 v[190:191], v10 offset:41472
v_fmaak_f32 v197, v145, v230, 0xb5c1a2a0
v_fmaak_f32 v198, v146, v230, 0xb5c1a2a0
v_fmaak_f32 v199, v147, v230, 0xb5c1a2a0
v_fmaak_f32 v200, v148, v230, 0xb5c1a2a0
v_fmaak_f32 v201, v149, v230, 0xb5c1a2a0
v_fmaak_f32 v202, v150, v230, 0xb5c1a2a0
v_fmaak_f32 v203, v151, v230, 0xb5c1a2a0
v_exp_f32_e64 v196, v196 clamp
v_exp_f32_e64 v197, v197 clamp
v_mfma_f32_16x16x32_bf16 v[220:223], v[232:235], v[192:195], v[220:223]
s_waitcnt lgkmcnt(6)
v_mfma_f32_32x32x16_bf16 v[160:175], v[176:179], v[84:87], v[160:175]
ds_read_b64_tr_b16 v[192:193], v11 offset:40960
ds_read_b64_tr_b16 v[194:195], v11 offset:41472
v_exp_f32_e64 v198, v198 clamp
v_exp_f32_e64 v199, v199 clamp
v_exp_f32_e64 v200, v200 clamp
v_exp_f32_e64 v201, v201 clamp
v_exp_f32_e64 v202, v202 clamp
v_exp_f32_e64 v203, v203 clamp
v_max_f32 v144, 0x358637bd, v144
v_max_f32 v145, 0x358637bd, v145
v_max_f32 v146, 0x358637bd, v146
v_lshlrev_b32 v224, 7, v1
s_waitcnt vmcnt(0)
s_barrier
s_cmp_eq_u32 s30, 0
s_cselect_b64 exec, 15, 0
buffer_store_dword v227, v224, s[24:27], s9 offen sc1
s_mov_b64 exec, -1
s_waitcnt lgkmcnt(6)
v_mfma_f32_32x32x16_bf16 v[160:175], v[180:183], v[88:91], v[160:175]
ds_read_b64_tr_b16 v[176:177], v12 offset:40960
ds_read_b64_tr_b16 v[178:179], v12 offset:41472
v_max_f32 v147, 0x358637bd, v147
v_max_f32 v148, 0x358637bd, v148
v_max_f32 v149, 0x358637bd, v149
v_max_f32 v150, 0x358637bd, v150
v_max_f32 v151, 0x358637bd, v151
v_add_f32 v144, v144, v196
v_add_f32 v145, v145, v197
v_add_f32 v146, v146, v198
v_add_f32 v147, v147, v199
s_waitcnt lgkmcnt(6)
v_mfma_f32_32x32x16_bf16 v[160:175], v[184:187], v[92:95], v[160:175]
ds_read_b64_tr_b16 v[180:181], v13 offset:40960
ds_read_b64_tr_b16 v[182:183], v13 offset:41472
v_add_f32 v148, v148, v200
v_add_f32 v149, v149, v201
v_add_f32 v150, v150, v202
v_add_f32 v151, v151, v203
v_fmaak_f32 v152, v152, v24, 0x358637bd
v_fmaak_f32 v153, v153, v25, 0x358637bd
v_fmaak_f32 v154, v154, v26, 0x358637bd
v_fmaak_f32 v155, v155, v27, 0x358637bd
v_fmaak_f32 v156, v156, v28, 0x358637bd
s_waitcnt lgkmcnt(6)
v_mfma_f32_32x32x16_bf16 v[160:175], v[188:191], v[96:99], v[160:175]
ds_read_b64_tr_b16 v[184:185], v10 offset:49152
ds_read_b64_tr_b16 v[186:187], v10 offset:49664
v_fmaak_f32 v157, v157, v29, 0x358637bd
v_fmaak_f32 v158, v158, v30, 0x358637bd
v_fmaak_f32 v159, v159, v31, 0x358637bd
v_fmaak_f32 v204, v152, v230, 0xb5c1a2a0
v_fmaak_f32 v205, v153, v230, 0xb5c1a2a0
v_fmaak_f32 v206, v154, v230, 0xb5c1a2a0
v_fmaak_f32 v207, v155, v230, 0xb5c1a2a0
v_fmaak_f32 v208, v156, v230, 0xb5c1a2a0
v_fmaak_f32 v209, v157, v230, 0xb5c1a2a0
v_mfma_f32_16x16x32_bf16 v[220:223], v[232:235], v[188:191], v[220:223]
s_waitcnt lgkmcnt(6)
v_mfma_f32_32x32x16_bf16 v[160:175], v[192:195], v[100:103], v[160:175]
ds_read_b64_tr_b16 v[188:189], v11 offset:49152
ds_read_b64_tr_b16 v[190:191], v11 offset:49664
v_fmaak_f32 v210, v158, v230, 0xb5c1a2a0
v_fmaak_f32 v211, v159, v230, 0xb5c1a2a0
v_exp_f32_e64 v204, v204 clamp
v_exp_f32_e64 v205, v205 clamp
v_exp_f32_e64 v206, v206 clamp
v_exp_f32_e64 v207, v207 clamp
v_exp_f32_e64 v208, v208 clamp
v_exp_f32_e64 v209, v209 clamp
v_exp_f32_e64 v210, v210 clamp
s_waitcnt lgkmcnt(6)
v_mfma_f32_32x32x16_bf16 v[160:175], v[176:179], v[104:107], v[160:175]
ds_read_b64_tr_b16 v[192:193], v12 offset:49152
ds_read_b64_tr_b16 v[194:195], v12 offset:49664
v_exp_f32_e64 v211, v211 clamp
v_max_f32 v152, 0x358637bd, v152
v_max_f32 v153, 0x358637bd, v153
v_max_f32 v154, 0x358637bd, v154
v_max_f32 v155, 0x358637bd, v155
v_max_f32 v156, 0x358637bd, v156
v_max_f32 v157, 0x358637bd, v157
v_max_f32 v158, 0x358637bd, v158
v_max_f32 v159, 0x358637bd, v159
s_waitcnt lgkmcnt(6)
v_mfma_f32_32x32x16_bf16 v[160:175], v[180:183], v[108:111], v[160:175]
ds_read_b64_tr_b16 v[176:177], v13 offset:49152
ds_read_b64_tr_b16 v[178:179], v13 offset:49664
v_add_f32 v152, v152, v204
v_add_f32 v153, v153, v205
v_add_f32 v154, v154, v206
v_add_f32 v155, v155, v207
v_add_f32 v156, v156, v208
v_add_f32 v157, v157, v209
v_add_f32 v158, v158, v210
v_add_f32 v159, v159, v211
v_cvt_pk_bf16_f32 v212, v144, v145
s_waitcnt lgkmcnt(6)
v_mfma_f32_32x32x16_bf16 v[160:175], v[184:187], v[112:115], v[160:175]
v_cvt_pk_bf16_f32 v213, v146, v147
v_cvt_pk_bf16_f32 v214, v148, v149
v_cvt_pk_bf16_f32 v215, v150, v151
v_cvt_pk_bf16_f32 v216, v152, v153
v_cvt_pk_bf16_f32 v217, v154, v155
v_cvt_pk_bf16_f32 v218, v156, v157
v_cvt_pk_bf16_f32 v219, v158, v159
buffer_store_dwordx4 v[212:215], v252, s[24:27], s48 offen sc1
s_add_u32 s48, s48, 14336
buffer_store_dwordx4 v[216:219], v252, s[24:27], s48 offen sc1
v_mfma_f32_16x16x32_bf16 v[220:223], v[232:235], v[184:187], v[220:223]
s_waitcnt lgkmcnt(4)
v_mfma_f32_32x32x16_bf16 v[160:175], v[188:191], v[116:119], v[160:175]
s_waitcnt lgkmcnt(2)
v_mfma_f32_32x32x16_bf16 v[160:175], v[192:195], v[120:123], v[160:175]
s_waitcnt lgkmcnt(0)
v_mfma_f32_32x32x16_bf16 v[160:175], v[176:179], v[124:127], v[160:175]
ds_write_b32 v254, v220
s_branch P1_GT
P1_B_CW:
s_addk_i32 s53, -1
s_cmp_lt_i32 s53, 0
s_cbranch_scc1 P1_B_CX
v_lshrrev_b32 v2, 1, v253
buffer_load_dword v2, v2, s[4:7], 0 offen sc1
s_waitcnt vmcnt(0)
s_branch P1_B_CR
P1_B_PW:
s_sleep 3
s_addk_i32 s53, -1
s_cmp_lt_i32 s53, 0
s_cbranch_scc1 P1_B_PX
v_cmp_eq_u32 vcc, -1, v3
s_cbranch_vccz P1_B_PS0
s_mov_b64 exec, vcc
buffer_load_dwordx2 v[2:3], v253, s[24:27], s10 offen offset:0 sc1
s_mov_b64 exec, -1
P1_B_PS0:
v_cmp_eq_u32 vcc, -1, v5
s_cbranch_vccz P1_B_PS1
s_mov_b64 exec, vcc
buffer_load_dwordx2 v[4:5], v253, s[24:27], s10 offen offset:512 sc1
s_mov_b64 exec, -1
P1_B_PS1:
v_cmp_eq_u32 vcc, -1, v7
s_cbranch_vccz P1_B_PS2
s_mov_b64 exec, vcc
buffer_load_dwordx2 v[6:7], v253, s[24:27], s10 offen offset:1024 sc1
s_mov_b64 exec, -1
P1_B_PS2:
v_cmp_eq_u32 vcc, -1, v9
s_cbranch_vccz P1_B_PS3
s_mov_b64 exec, vcc
buffer_load_dwordx2 v[8:9], v253, s[24:27], s10 offen offset:1536 sc1
s_mov_b64 exec, -1
P1_B_PS3:
v_cmp_eq_u32 vcc, -1, v245
s_cbranch_vccz P1_B_PS4
s_mov_b64 exec, vcc
buffer_load_dwordx2 v[244:245], v253, s[24:27], s10 offen offset:2048 sc1
s_mov_b64 exec, -1
P1_B_PS4:
v_cmp_eq_u32 vcc, -1, v247
s_cbranch_vccz P1_B_PS5
s_mov_b64 exec, vcc
buffer_load_dwordx2 v[246:247], v253, s[24:27], s10 offen offset:2560 sc1
s_mov_b64 exec, -1
P1_B_PS5:
v_cmp_eq_u32 vcc, -1, v229
s_cbranch_vccz P1_B_PS6
s_mov_b64 exec, vcc
buffer_load_dwordx2 v[228:229], v253, s[24:27], s10 offen offset:3072 sc1
s_mov_b64 exec, -1
P1_B_PS6:
s_waitcnt vmcnt(0)
s_branch P1_B_PR
P1_BL:
s_mov_b32 s12, s74
s_and_b32 s13, s75, 0xffff
s_mov_b32 s14, 8388608
s_mov_b32 s15, 0x20000
s_waitcnt lgkmcnt(6)
v_mfma_f32_32x32x16_bf16 v[144:159], v[16:19], v[176:179], 0
ds_read_b64_tr_b16 v[192:193], v10 offset:8192
ds_read_b64_tr_b16 v[194:195], v10 offset:8704
v_lshrrev_b32 v2, 1, v253
buffer_load_dword v2, v2, s[4:7], 0 offen sc1
buffer_load_dword v255, v0, s[12:15], s8 offen offset:0
v_mfma_f32_16x16x32_bf16 v[220:223], v[232:235], v[176:179], 0
v_add_f32 v245, v225, v227
s_lshl_b32 s33, s30, 9
s_add_u32 s33, s33, 118784
v_add_u32 v15, s33, v253
ds_write_b64 v15, v[244:245]
ds_write_b32 v254, v240 offset:0
v_xor_b32 v15, 2048, v15
s_waitcnt lgkmcnt(8)
v_mfma_f32_32x32x16_bf16 v[144:159], v[20:23], v[180:183], v[144:159]
ds_read_b64_tr_b16 v[176:177], v11 offset:8192
ds_read_b64_tr_b16 v[178:179], v11 offset:8704
s_add_u32 m0, s45, 57344
s_nop 0
buffer_load_dwordx4 v4, s[16:19], s41 offen lds
s_add_u32 s41, s41, s43
s_waitcnt lgkmcnt(8)
v_mfma_f32_32x32x16_bf16 v[144:159], v[24:27], v[184:187], v[144:159]
ds_read_b64_tr_b16 v[180:181], v12 offset:8192
ds_read_b64_tr_b16 v[182:183], v12 offset:8704
s_add_u32 m0, s45, 65536
s_nop 0
buffer_load_dwordx4 v4, s[16:19], s41 offen lds
s_add_u32 s41, s41, s43
s_waitcnt lgkmcnt(4)
s_barrier
v_mfma_f32_32x32x16_bf16 v[144:159], v[28:31], v[188:191], v[144:159]
ds_read_b64_tr_b16 v[184:185], v13 offset:8192
ds_read_b64_tr_b16 v[186:187], v13 offset:8704
s_add_u32 m0, s45, 73728
s_nop 0
buffer_load_dwordx4 v4, s[16:19], s41 offen lds
s_add_u32 s41, s41, s43
ds_read_b64 v[196:197], v15
v_and_b32 v15, 0xfffffff0, v254
ds_read_b128 v[200:203], v15 offset:0
v_mfma_f32_32x32x16_bf16 v[144:159], v[32:35], v[192:195], v[144:159]
ds_read_b64_tr_b16 v[188:189], v10 offset:16384
ds_read_b64_tr_b16 v[190:191], v10 offset:16896
s_add_u32 m0, s45, 81920
s_nop 0
buffer_load_dwordx4 v4, s[16:19], s41 offen lds
s_add_u32 s41, s41, s43
s_waitcnt lgkmcnt(3)
v_add_f32 v224, v244, v196
v_add_f32 v225, v245, v197
v_mov_b32 v196, v224
v_mov_b32 v197, v225
v_mov_b32 v241, 0
v_mov_b32 v242, 0
v_permlane32_swap_b32 v197, v225
v_add_f32 v225, v225, v197
v_mul_f32 v224, 0xbb124925, v224
v_mfma_f32_16x16x32_bf16 v[220:223], v[232:235], v[192:195], v[220:223]
v_mfma_f32_32x32x16_bf16 v[144:159], v[36:39], v[176:179], v[144:159]
ds_read_b64_tr_b16 v[192:193], v11 offset:16384
ds_read_b64_tr_b16 v[194:195], v11 offset:16896
s_add_u32 m0, s45, 90112
s_nop 0
buffer_load_dwordx4 v4, s[16:19], s41 offen lds
s_add_u32 s41, s41, s43
buffer_load_dword v255, v0, s[12:15], s8 offen offset:512
v_mul_f32 v225, 0x3b124925, v225
v_and_b32 v196, 0xffff0000, v224
v_fma_f32 v225, -v224, v224, v225
v_sub_f32 v197, v224, v196
v_max_f32 v225, 0, v225
v_cndmask_b32 v196, v196, v197, s[54:55]
v_add_f32 v225, 0x3727c5ac, v225
v_cvt_pk_bf16_f32 v236, v196, v196
v_rsq_f32 v226, v225
v_mov_b32 v243, 0
v_mfma_f32_32x32x16_bf16 v[144:159], v[40:43], v[180:183], v[144:159]
ds_read_b64_tr_b16 v[176:177], v12 offset:16384
ds_read_b64_tr_b16 v[178:179], v12 offset:16896
s_add_u32 m0, s45, 98304
s_nop 0
buffer_load_dwordx4 v4, s[16:19], s41 offen lds
s_add_u32 s41, s41, s43
s_waitcnt lgkmcnt(6)
v_add_f32 v200, v200, v201
v_add_f32 v202, v202, v203
v_add_f32 v200, v200, v202
v_and_b32 v201, 0xffff0000, v200
v_sub_f32 v200, v200, v201
v_cvt_pk_bf16_f32 v240, v201, v200
v_mul_f32 v229, v225, v226
v_mul_f32 v227, 0xc0135761, v226
v_mfma_f32_32x32x16_bf16 v[128:143], v[240:243], v[236:239], v[128:143]
v_mfma_f32_32x32x16_bf16 v[144:159], v[44:47], v[184:187], v[144:159]
ds_read_b64_tr_b16 v[180:181], v13 offset:16384
ds_read_b64_tr_b16 v[182:183], v13 offset:16896
s_add_u32 m0, s45, 106496
s_nop 0
buffer_load_dwordx4 v4, s[16:19], s41 offen lds
s_add_u32 s41, s41, s43
v_mul_f32 v228, v226, v226
v_mul_f32 v228, v228, v226
v_mul_f32 v228, 0xbdd2d3e8, v228
s_waitcnt vmcnt(10)
s_barrier
s_waitcnt lgkmcnt(6)
v_mfma_f32_32x32x16_bf16 v[144:159], v[48:51], v[188:191], v[144:159]
ds_read_b64_tr_b16 v[184:185], v10 offset:24576
ds_read_b64_tr_b16 v[186:187], v10 offset:25088
s_mov_b32 s16, s68
s_and_b32 s17, s69, 0xffff
s_mov_b32 s18, 401408
s_mov_b32 s19, 0x20000
s_mov_b32 s20, s78
s_and_b32 s21, s79, 0xffff
s_mov_b32 s22, 802816
s_mov_b32 s23, 0x20000
s_mov_b32 s40, 0x33333333
s_mov_b32 s41, 0x33333333
v_mfma_f32_16x16x32_bf16 v[220:223], v[232:235], v[188:191], v[220:223]
s_waitcnt lgkmcnt(6)
v_mfma_f32_32x32x16_bf16 v[144:159], v[52:55], v[192:195], v[144:159]
ds_read_b64_tr_b16 v[188:189], v11 offset:24576
ds_read_b64_tr_b16 v[190:191], v11 offset:25088
s_waitcnt lgkmcnt(6)
v_mfma_f32_32x32x16_bf16 v[144:159], v[56:59], v[176:179], v[144:159]
ds_read_b64_tr_b16 v[192:193], v12 offset:24576
ds_read_b64_tr_b16 v[194:195], v12 offset:25088
buffer_load_dword v255, v0, s[12:15], s8 offen offset:1024
v_mul_f32 v196, v128, v128
v_mul_f32 v197, v129, v129
v_mul_f32 v198, v130, v130
v_mul_f32 v199, v131, v131
v_mul_f32 v200, v132, v132
v_mul_f32 v201, v133, v133
v_mul_f32 v202, v134, v134
v_mul_f32 v203, v135, v135
v_fma_f32 v196, v196, v228, v227
v_fma_f32 v197, v197, v228, v227
v_fma_f32 v198, v198, v228, v227
v_fma_f32 v199, v199, v228, v227
s_waitcnt lgkmcnt(6)
v_mfma_f32_32x32x16_bf16 v[144:159], v[60:63], v[180:183], v[144:159]
ds_read_b64_tr_b16 v[176:177], v13 offset:24576
ds_read_b64_tr_b16 v[178:179], v13 offset:25088
v_fma_f32 v200, v200, v228, v227
v_fma_f32 v201, v201, v228, v227
v_fma_f32 v202, v202, v228, v227
v_fma_f32 v203, v203, v228, v227
v_mul_f32 v196, v196, v128
v_mul_f32 v197, v197, v129
v_mul_f32 v198, v198, v130
v_mul_f32 v199, v199, v131
v_mul_f32 v200, v200, v132
v_mul_f32 v201, v201, v133
v_mul_f32 v202, v202, v134
v_mul_f32 v203, v203, v135
s_waitcnt lgkmcnt(6)
v_mfma_f32_32x32x16_bf16 v[144:159], v[64:67], v[184:187], v[144:159]
ds_read_b64_tr_b16 v[180:181], v10 offset:32768
ds_read_b64_tr_b16 v[182:183], v10 offset:33280
v_exp_f32 v196, v196
v_exp_f32 v197, v197
v_exp_f32 v198, v198
v_exp_f32 v199, v199
v_exp_f32 v200, v200
v_exp_f32 v201, v201
v_exp_f32 v202, v202
v_exp_f32 v203, v203
v_fma_f32 v196, v196, v229, v229
v_fma_f32 v197, v197, v229, v229
v_fma_f32 v198, v198, v229, v229
v_fma_f32 v199, v199, v229, v229
v_mfma_f32_16x16x32_bf16 v[220:223], v[232:235], v[184:187], v[220:223]
s_waitcnt lgkmcnt(6)
v_mfma_f32_32x32x16_bf16 v[144:159], v[68:71], v[188:191], v[144:159]
ds_read_b64_tr_b16 v[184:185], v11 offset:32768
ds_read_b64_tr_b16 v[186:187], v11 offset:33280
s_mul_i32 s33, s37, 392
s_lshl_b32 s34, s33, 1
buffer_load_dword v255, v253, s[16:19], s33 offen
buffer_load_dword v255, v14, s[20:23], s34 offen
v_fma_f32 v200, v200, v229, v229
v_fma_f32 v201, v201, v229, v229
v_fma_f32 v202, v202, v229, v229
v_fma_f32 v203, v203, v229, v229
v_rcp_f32 v196, v196
v_rcp_f32 v197, v197
v_rcp_f32 v198, v198
v_rcp_f32 v199, v199
v_rcp_f32 v200, v200
v_rcp_f32 v201, v201
v_rcp_f32 v202, v202
v_rcp_f32 v203, v203
s_waitcnt lgkmcnt(6)
v_mfma_f32_32x32x16_bf16 v[144:159], v[72:75], v[192:195], v[144:159]
ds_read_b64_tr_b16 v[188:189], v12 offset:32768
ds_read_b64_tr_b16 v[190:191], v12 offset:33280
v_mul_f32 v128, v196, v128
v_mul_f32 v129, v197, v129
v_mul_f32 v130, v198, v130
v_mul_f32 v131, v199, v131
v_mul_f32 v132, v200, v132
v_mul_f32 v133, v201, v133
v_mul_f32 v134, v202, v134
v_mul_f32 v135, v203, v135
v_mov_b32 v224, v128
v_mul_f32 v225, v128, v128
v_add_f32 v224, v224, v129
v_fmac_f32 v225, v129, v129
s_waitcnt lgkmcnt(6)
v_mfma_f32_32x32x16_bf16 v[144:159], v[76:79], v[176:179], v[144:159]
ds_read_b64_tr_b16 v[192:193], v13 offset:32768
ds_read_b64_tr_b16 v[194:195], v13 offset:33280
buffer_load_dword v255, v0, s[12:15], s8 offen offset:1536
v_add_f32 v224, v224, v130
v_fmac_f32 v225, v130, v130
v_add_f32 v224, v224, v131
v_fmac_f32 v225, v131, v131
v_add_f32 v224, v224, v132
v_fmac_f32 v225, v132, v132
v_add_f32 v224, v224, v133
v_fmac_f32 v225, v133, v133
v_add_f32 v224, v224, v134
v_fmac_f32 v225, v134, v134
v_add_f32 v224, v224, v135
v_fmac_f32 v225, v135, v135
s_waitcnt lgkmcnt(6)
v_mfma_f32_32x32x16_bf16 v[144:159], v[80:83], v[180:183], v[144:159]
ds_read_b64_tr_b16 v[176:177], v10 offset:40960
ds_read_b64_tr_b16 v[178:179], v10 offset:41472
v_mul_f32 v204, v136, v136
v_mul_f32 v205, v137, v137
v_mul_f32 v206, v138, v138
v_mul_f32 v207, v139, v139
v_mul_f32 v208, v140, v140
v_mul_f32 v209, v141, v141
v_mul_f32 v210, v142, v142
v_mul_f32 v211, v143, v143
v_fma_f32 v204, v204, v228, v227
v_fma_f32 v205, v205, v228, v227
v_fma_f32 v206, v206, v228, v227
v_fma_f32 v207, v207, v228, v227
v_mfma_f32_16x16x32_bf16 v[220:223], v[232:235], v[180:183], v[220:223]
s_waitcnt lgkmcnt(6)
v_mfma_f32_32x32x16_bf16 v[144:159], v[84:87], v[184:187], v[144:159]
ds_read_b64_tr_b16 v[180:181], v11 offset:40960
ds_read_b64_tr_b16 v[182:183], v11 offset:41472
v_fma_f32 v208, v208, v228, v227
v_fma_f32 v209, v209, v228, v227
v_fma_f32 v210, v210, v228, v227
v_fma_f32 v211, v211, v228, v227
v_mul_f32 v204, v204, v136
v_mul_f32 v205, v205, v137
v_mul_f32 v206, v206, v138
v_mul_f32 v207, v207, v139
v_mul_f32 v208, v208, v140
v_mul_f32 v209, v209, v141
v_mul_f32 v210, v210, v142
v_mul_f32 v211, v211, v143
s_waitcnt lgkmcnt(6)
v_mfma_f32_32x32x16_bf16 v[144:159], v[88:91], v[188:191], v[144:159]
ds_read_b64_tr_b16 v[184:185], v12 offset:40960
ds_read_b64_tr_b16 v[186:187], v12 offset:41472
v_exp_f32 v204, v204
v_exp_f32 v205, v205
v_exp_f32 v206, v206
v_exp_f32 v207, v207
v_exp_f32 v208, v208
v_exp_f32 v209, v209
v_exp_f32 v210, v210
v_exp_f32 v211, v211
v_fma_f32 v204, v204, v229, v229
v_fma_f32 v205, v205, v229, v229
v_fma_f32 v206, v206, v229, v229
v_fma_f32 v207, v207, v229, v229
s_waitcnt lgkmcnt(6)
v_mfma_f32_32x32x16_bf16 v[144:159], v[92:95], v[192:195], v[144:159]
ds_read_b64_tr_b16 v[188:189], v13 offset:40960
ds_read_b64_tr_b16 v[190:191], v13 offset:41472
v_fma_f32 v208, v208, v229, v229
v_fma_f32 v209, v209, v229, v229
v_fma_f32 v210, v210, v229, v229
v_fma_f32 v211, v211, v229, v229
v_rcp_f32 v204, v204
v_rcp_f32 v205, v205
v_rcp_f32 v206, v206
v_rcp_f32 v207, v207
v_rcp_f32 v208, v208
v_rcp_f32 v209, v209
v_rcp_f32 v210, v210
v_rcp_f32 v211, v211
s_waitcnt lgkmcnt(6)
v_mfma_f32_32x32x16_bf16 v[144:159], v[96:99], v[176:179], v[144:159]
ds_read_b64_tr_b16 v[192:193], v10 offset:49152
ds_read_b64_tr_b16 v[194:195], v10 offset:49664
v_mul_f32 v136, v204, v136
v_mul_f32 v137, v205, v137
v_mul_f32 v138, v206, v138
v_mul_f32 v139, v207, v139
v_mul_f32 v140, v208, v140
v_mul_f32 v141, v209, v141
v_mul_f32 v142, v210, v142
v_mul_f32 v143, v211, v143
v_add_f32 v224, v224, v136
v_fmac_f32 v225, v136, v136
v_add_f32 v224, v224, v137
v_fmac_f32 v225, v137, v137
v_mfma_f32_16x16x32_bf16 v[220:223], v[232:235], v[176:179], v[220:223]
s_waitcnt lgkmcnt(6)
v_mfma_f32_32x32x16_bf16 v[144:159], v[100:103], v[180:183], v[144:159]
ds_read_b64_tr_b16 v[176:177], v11 offset:49152
ds_read_b64_tr_b16 v[178:179], v11 offset:49664
v_add_f32 v224, v224, v138
v_fmac_f32 v225, v138, v138
v_add_f32 v224, v224, v139
v_fmac_f32 v225, v139, v139
v_add_f32 v224, v224, v140
v_fmac_f32 v225, v140, v140
v_add_f32 v224, v224, v141
v_fmac_f32 v225, v141, v141
v_add_f32 v224, v224, v142
v_fmac_f32 v225, v142, v142
v_add_f32 v224, v224, v143
s_waitcnt lgkmcnt(6)
v_mfma_f32_32x32x16_bf16 v[144:159], v[104:107], v[184:187], v[144:159]
ds_read_b64_tr_b16 v[180:181], v12 offset:49152
ds_read_b64_tr_b16 v[182:183], v12 offset:49664
v_fmac_f32 v225, v143, v143
v_mov_b32 v196, v224
v_mov_b32 v197, v225
s_lshl_b32 s33, s30, 9
s_add_u32 s33, s33, 118784
v_add_u32 v8, s33, v253
v_mov_b32 v227, 1
v_permlane32_swap_b32 v196, v224
v_permlane32_swap_b32 v197, v225
v_add_f32 v224, v224, v196
v_add_f32 v225, v225, v197
ds_write_b64 v8, v[224:225]
v_xor_b32 v8, 2048, v8
s_waitcnt lgkmcnt(7)
v_mfma_f32_32x32x16_bf16 v[144:159], v[108:111], v[188:191], v[144:159]
ds_read_b64_tr_b16 v[184:185], v13 offset:49152
ds_read_b64_tr_b16 v[186:187], v13 offset:49664
s_waitcnt vmcnt(4)
s_waitcnt lgkmcnt(2)
s_barrier
v_mfma_f32_32x32x16_bf16 v[144:159], v[112:115], v[192:195], v[144:159]
v_add_u32 v10, 57344, v10
v_add_u32 v11, 57344, v11
v_add_u32 v12, 57344, v12
v_add_u32 v13, 57344, v13
ds_read_b64_tr_b16 v[188:189], v10 offset:0
ds_read_b64_tr_b16 v[190:191], v10 offset:512
ds_read_b64 v[196:197], v8
P1_BL_CR:
v_cmp_eq_u32 vcc, 0, v2
s_and_b64 vcc, vcc, s[40:41]
s_cbranch_vccnz P1_BL_CW
P1_BL_CX:
v_mfma_f32_16x16x32_bf16 v[220:223], v[232:235], v[192:195], v[220:223]
v_mfma_f32_32x32x16_bf16 v[144:159], v[116:119], v[176:179], v[144:159]
ds_read_b64_tr_b16 v[192:193], v11 offset:0
ds_read_b64_tr_b16 v[194:195], v11 offset:512
s_waitcnt lgkmcnt(2)
v_add_f32 v224, v224, v196
v_add_f32 v225, v225, v197
s_lshl_b32 s33, s32, 4
s_lshl_b32 exec_lo, 0xffff, s33
s_mov_b32 exec_hi, 0
buffer_store_dwordx2 v[224:225], v253, s[24:27], s10 offen sc1
s_mov_b64 exec, -1
s_and_b32 s10, s10, 0xfffff000
v_mfma_f32_32x32x16_bf16 v[144:159], v[120:123], v[180:183], v[144:159]
ds_read_b64_tr_b16 v[176:177], v12 offset:0
ds_read_b64_tr_b16 v[178:179], v12 offset:512
v_mfma_f32_32x32x16_bf16 v[144:159], v[124:127], v[184:187], v[144:159]
ds_read_b64_tr_b16 v[180:181], v13 offset:0
ds_read_b64_tr_b16 v[182:183], v13 offset:512
ds_write_b32 v254, v220 offset:2048
v_mfma_f32_32x32x16_bf16 v[160:175], v[188:191], v[16:19], 0
ds_read_b64_tr_b16 v[184:185], v10 offset:8192
ds_read_b64_tr_b16 v[186:187], v10 offset:8704
v_mfma_f32_16x16x32_bf16 v[220:223], v[232:235], v[188:191], 0
s_waitcnt lgkmcnt(7)
v_mfma_f32_32x32x16_bf16 v[160:175], v[192:195], v[20:23], v[160:175]
ds_read_b64_tr_b16 v[188:189], v11 offset:8192
ds_read_b64_tr_b16 v[190:191], v11 offset:8704
s_waitcnt lgkmcnt(4)
s_barrier
v_mfma_f32_32x32x16_bf16 v[160:175], v[176:179], v[24:27], v[160:175]
ds_read_b64_tr_b16 v[192:193], v12 offset:8192
ds_read_b64_tr_b16 v[194:195], v12 offset:8704
s_lshl_b32 s35, s30, 8
s_add_u32 s35, s35, 122880
v_lshl_add_u32 v6, v1, 2, s35
ds_write_b32 v6, v226
v_lshrrev_b32 v7, 5, v1
v_lshl_add_u32 v7, v7, 4, s35
ds_read_b128 v[248:251], v15 offset:2048
v_mfma_f32_32x32x16_bf16 v[160:175], v[180:183], v[28:31], v[160:175]
ds_read_b64_tr_b16 v[176:177], v13 offset:8192
ds_read_b64_tr_b16 v[178:179], v13 offset:8704
s_waitcnt lgkmcnt(2)
v_add_f32 v248, v248, v249
v_add_f32 v250, v250, v251
v_add_f32 v248, v248, v250
v_and_b32 v249, 0xffff0000, v248
v_sub_f32 v248, v248, v249
v_cvt_pk_bf16_f32 v240, v249, v248
s_nop 1
v_mfma_f32_32x32x16_bf16 v[144:159], v[236:239], v[240:243], v[144:159]
v_mfma_f32_32x32x16_bf16 v[160:175], v[184:187], v[32:35], v[160:175]
ds_read_b64_tr_b16 v[180:181], v10 offset:16384
ds_read_b64_tr_b16 v[182:183], v10 offset:16896
v_mfma_f32_16x16x32_bf16 v[220:223], v[232:235], v[184:187], v[220:223]
v_mfma_f32_32x32x16_bf16 v[160:175], v[188:191], v[36:39], v[160:175]
ds_read_b64_tr_b16 v[184:185], v11 offset:16384
ds_read_b64_tr_b16 v[186:187], v11 offset:16896
ds_read_b128 v[16:19], v7 offset:0
ds_read_b128 v[20:23], v7 offset:32
ds_read_b128 v[24:27], v7 offset:64
ds_read_b128 v[28:31], v7 offset:96
v_mfma_f32_32x32x16_bf16 v[160:175], v[192:195], v[40:43], v[160:175]
ds_read_b64_tr_b16 v[188:189], v12 offset:16384
ds_read_b64_tr_b16 v[190:191], v12 offset:16896
s_waitcnt lgkmcnt(10)
v_mfma_f32_32x32x16_bf16 v[160:175], v[176:179], v[44:47], v[160:175]
ds_read_b64_tr_b16 v[192:193], v13 offset:16384
ds_read_b64_tr_b16 v[194:195], v13 offset:16896
s_waitcnt lgkmcnt(10)
v_mfma_f32_32x32x16_bf16 v[160:175], v[180:183], v[48:51], v[160:175]
ds_read_b64_tr_b16 v[176:177], v10 offset:24576
ds_read_b64_tr_b16 v[178:179], v10 offset:25088
s_waitcnt lgkmcnt(6)
v_fmaak_f32 v144, v144, v16, 0x358637bd
v_fmaak_f32 v145, v145, v17, 0x358637bd
v_fmaak_f32 v146, v146, v18, 0x358637bd
v_fmaak_f32 v147, v147, v19, 0x358637bd
v_fmaak_f32 v148, v148, v20, 0x358637bd
v_fmaak_f32 v149, v149, v21, 0x358637bd
v_fmaak_f32 v150, v150, v22, 0x358637bd
v_fmaak_f32 v151, v151, v23, 0x358637bd
v_fmaak_f32 v196, v144, v230, 0xb5c1a2a0
v_fmaak_f32 v197, v145, v230, 0xb5c1a2a0
v_fmaak_f32 v198, v146, v230, 0xb5c1a2a0
v_mfma_f32_16x16x32_bf16 v[220:223], v[232:235], v[180:183], v[220:223]
v_mfma_f32_32x32x16_bf16 v[160:175], v[184:187], v[52:55], v[160:175]
ds_read_b64_tr_b16 v[180:181], v11 offset:24576
ds_read_b64_tr_b16 v[182:183], v11 offset:25088
v_fmaak_f32 v199, v147, v230, 0xb5c1a2a0
v_fmaak_f32 v200, v148, v230, 0xb5c1a2a0
v_fmaak_f32 v201, v149, v230, 0xb5c1a2a0
v_fmaak_f32 v202, v150, v230, 0xb5c1a2a0
v_fmaak_f32 v203, v151, v230, 0xb5c1a2a0
v_exp_f32_e64 v196, v196 clamp
v_exp_f32_e64 v197, v197 clamp
v_exp_f32_e64 v198, v198 clamp
v_exp_f32_e64 v199, v199 clamp
v_exp_f32_e64 v200, v200 clamp
v_exp_f32_e64 v201, v201 clamp
v_exp_f32_e64 v202, v202 clamp
s_waitcnt lgkmcnt(6)
v_mfma_f32_32x32x16_bf16 v[160:175], v[188:191], v[56:59], v[160:175]
ds_read_b64_tr_b16 v[184:185], v12 offset:24576
ds_read_b64_tr_b16 v[186:187], v12 offset:25088
v_exp_f32_e64 v203, v203 clamp
v_max_f32 v144, 0x358637bd, v144
v_max_f32 v145, 0x358637bd, v145
v_max_f32 v146, 0x358637bd, v146
v_max_f32 v147, 0x358637bd, v147
v_max_f32 v148, 0x358637bd, v148
v_max_f32 v149, 0x358637bd, v149
v_max_f32 v150, 0x358637bd, v150
v_max_f32 v151, 0x358637bd, v151
v_add_f32 v144, v144, v196
v_add_f32 v145, v145, v197
v_add_f32 v146, v146, v198
s_waitcnt lgkmcnt(6)
v_mfma_f32_32x32x16_bf16 v[160:175], v[192:195], v[60:63], v[160:175]
ds_read_b64_tr_b16 v[188:189], v13 offset:24576
ds_read_b64_tr_b16 v[190:191], v13 offset:25088
v_add_f32 v147, v147, v199
v_add_f32 v148, v148, v200
v_add_f32 v149, v149, v201
v_add_f32 v150, v150, v202
v_add_f32 v151, v151, v203
v_fmaak_f32 v152, v152, v24, 0x358637bd
v_fmaak_f32 v153, v153, v25, 0x358637bd
v_fmaak_f32 v154, v154, v26, 0x358637bd
v_fmaak_f32 v155, v155, v27, 0x358637bd
v_fmaak_f32 v156, v156, v28, 0x358637bd
v_fmaak_f32 v157, v157, v29, 0x358637bd
s_waitcnt lgkmcnt(6)
v_mfma_f32_32x32x16_bf16 v[160:175], v[176:179], v[64:67], v[160:175]
ds_read_b64_tr_b16 v[192:193], v10 offset:32768
ds_read_b64_tr_b16 v[194:195], v10 offset:33280
v_fmaak_f32 v158, v158, v30, 0x358637bd
v_fmaak_f32 v159, v159, v31, 0x358637bd
v_fmaak_f32 v204, v152, v230, 0xb5c1a2a0
v_fmaak_f32 v205, v153, v230, 0xb5c1a2a0
v_fmaak_f32 v206, v154, v230, 0xb5c1a2a0
v_fmaak_f32 v207, v155, v230, 0xb5c1a2a0
v_fmaak_f32 v208, v156, v230, 0xb5c1a2a0
v_fmaak_f32 v209, v157, v230, 0xb5c1a2a0
v_fmaak_f32 v210, v158, v230, 0xb5c1a2a0
v_fmaak_f32 v211, v159, v230, 0xb5c1a2a0
v_exp_f32_e64 v204, v204 clamp
v_mfma_f32_16x16x32_bf16 v[220:223], v[232:235], v[176:179], v[220:223]
s_waitcnt lgkmcnt(6)
v_mfma_f32_32x32x16_bf16 v[160:175], v[180:183], v[68:71], v[160:175]
ds_read_b64_tr_b16 v[176:177], v11 offset:32768
ds_read_b64_tr_b16 v[178:179], v11 offset:33280
v_exp_f32_e64 v205, v205 clamp
v_exp_f32_e64 v206, v206 clamp
v_exp_f32_e64 v207, v207 clamp
v_exp_f32_e64 v208, v208 clamp
v_exp_f32_e64 v209, v209 clamp
v_exp_f32_e64 v210, v210 clamp
v_exp_f32_e64 v211, v211 clamp
v_max_f32 v152, 0x358637bd, v152
v_max_f32 v153, 0x358637bd, v153
v_max_f32 v154, 0x358637bd, v154
v_max_f32 v155, 0x358637bd, v155
s_waitcnt lgkmcnt(6)
v_mfma_f32_32x32x16_bf16 v[160:175], v[184:187], v[72:75], v[160:175]
ds_read_b64_tr_b16 v[180:181], v12 offset:32768
ds_read_b64_tr_b16 v[182:183], v12 offset:33280
v_max_f32 v156, 0x358637bd, v156
v_max_f32 v157, 0x358637bd, v157
v_max_f32 v158, 0x358637bd, v158
v_max_f32 v159, 0x358637bd, v159
v_add_f32 v152, v152, v204
v_add_f32 v153, v153, v205
v_add_f32 v154, v154, v206
v_add_f32 v155, v155, v207
v_add_f32 v156, v156, v208
v_add_f32 v157, v157, v209
v_add_f32 v158, v158, v210
s_waitcnt lgkmcnt(6)
v_mfma_f32_32x32x16_bf16 v[160:175], v[188:191], v[76:79], v[160:175]
ds_read_b64_tr_b16 v[184:185], v13 offset:32768
ds_read_b64_tr_b16 v[186:187], v13 offset:33280
v_add_f32 v159, v159, v211
v_cvt_pk_bf16_f32 v212, v144, v145
v_cvt_pk_bf16_f32 v213, v146, v147
v_cvt_pk_bf16_f32 v214, v148, v149
v_cvt_pk_bf16_f32 v215, v150, v151
v_cvt_pk_bf16_f32 v216, v152, v153
v_cvt_pk_bf16_f32 v217, v154, v155
v_cvt_pk_bf16_f32 v218, v156, v157
v_cvt_pk_bf16_f32 v219, v158, v159
buffer_store_dwordx4 v[212:215], v252, s[24:27], s48 offen sc1
s_add_u32 s48, s48, 14336
buffer_store_dwordx4 v[216:219], v252, s[24:27], s48 offen sc1
s_waitcnt lgkmcnt(6)
v_mfma_f32_32x32x16_bf16 v[160:175], v[192:195], v[80:83], v[160:175]
ds_read_b64_tr_b16 v[188:189], v10 offset:40960
ds_read_b64_tr_b16 v[190:191], v10 offset:41472
v_mfma_f32_16x16x32_bf16 v[220:223], v[232:235], v[192:195], v[220:223]
s_waitcnt lgkmcnt(6)
v_mfma_f32_32x32x16_bf16 v[160:175], v[176:179], v[84:87], v[160:175]
ds_read_b64_tr_b16 v[192:193], v11 offset:40960
ds_read_b64_tr_b16 v[194:195], v11 offset:41472
buffer_load_dwordx2 v[2:3], v253, s[24:27], s10 offen offset:0 sc1
buffer_load_dwordx2 v[4:5], v253, s[24:27], s10 offen offset:512 sc1
buffer_load_dwordx2 v[6:7], v253, s[24:27], s10 offen offset:1024 sc1
buffer_load_dwordx2 v[8:9], v253, s[24:27], s10 offen offset:1536 sc1
buffer_load_dwordx2 v[244:245], v253, s[24:27], s10 offen offset:2048 sc1
buffer_load_dwordx2 v[246:247], v253, s[24:27], s10 offen offset:2560 sc1
buffer_load_dwordx2 v[228:229], v253, s[24:27], s10 offen offset:3072 sc1
s_waitcnt lgkmcnt(6)
v_mfma_f32_32x32x16_bf16 v[160:175], v[180:183], v[88:91], v[160:175]
ds_read_b64_tr_b16 v[176:177], v12 offset:40960
ds_read_b64_tr_b16 v[178:179], v12 offset:41472
s_waitcnt lgkmcnt(6)
v_mfma_f32_32x32x16_bf16 v[160:175], v[184:187], v[92:95], v[160:175]
ds_read_b64_tr_b16 v[180:181], v13 offset:40960
ds_read_b64_tr_b16 v[182:183], v13 offset:41472
s_waitcnt lgkmcnt(6)
v_mfma_f32_32x32x16_bf16 v[160:175], v[188:191], v[96:99], v[160:175]
ds_read_b64_tr_b16 v[184:185], v10 offset:49152
ds_read_b64_tr_b16 v[186:187], v10 offset:49664
v_mfma_f32_16x16x32_bf16 v[220:223], v[232:235], v[188:191], v[220:223]
s_waitcnt lgkmcnt(6)
v_mfma_f32_32x32x16_bf16 v[160:175], v[192:195], v[100:103], v[160:175]
ds_read_b64_tr_b16 v[188:189], v11 offset:49152
ds_read_b64_tr_b16 v[190:191], v11 offset:49664
s_waitcnt lgkmcnt(6)
v_mfma_f32_32x32x16_bf16 v[160:175], v[176:179], v[104:107], v[160:175]
ds_read_b64_tr_b16 v[192:193], v12 offset:49152
ds_read_b64_tr_b16 v[194:195], v12 offset:49664
s_waitcnt vmcnt(0)
P1_BL_PR:
v_max3_u32 v224, v3, v5, v7
v_max3_u32 v225, v9, v245, v247
v_max3_u32 v224, v224, v225, v229
v_cmp_eq_u32 vcc, -1, v224
s_cbranch_vccnz P1_BL_PW
P1_BL_PX:
v_add_f32 v2, v2, v4
v_add_f32 v3, v3, v5
v_add_f32 v6, v6, v8
v_add_f32 v7, v7, v9
v_add_f32 v244, v244, v246
v_add_f32 v245, v245, v247
v_add_f32 v2, v2, v6
v_add_f32 v3, v3, v7
s_waitcnt lgkmcnt(6)
v_mfma_f32_32x32x16_bf16 v[160:175], v[180:183], v[108:111], v[160:175]
ds_read_b64_tr_b16 v[176:177], v13 offset:49152
ds_read_b64_tr_b16 v[178:179], v13 offset:49664
v_add_f32 v244, v244, v228
v_add_f32 v245, v245, v229
v_add_f32 v2, v2, v244
v_add_f32 v3, v3, v245
v_mov_b32 v4, v2
v_mov_b32 v5, v3
s_nop 0
v_permlane32_swap_b32 v4, v2
v_permlane32_swap_b32 v5, v3
s_waitcnt lgkmcnt(6)
v_mfma_f32_32x32x16_bf16 v[160:175], v[184:187], v[112:115], v[160:175]
v_add_f32 v2, v2, v4
v_add_f32 v3, v3, v5
v_mul_f32 v2, 0xba924925, v2
v_mul_f32 v3, 0x3a924925, v3
v_fma_f32 v3, -v2, v2, v3
v_max_f32 v3, 0, v3
v_add_f32 v3, 0x3727c5ac, v3
v_rsq_f32 v3, v3
s_nop 0
v_mfma_f32_16x16x32_bf16 v[220:223], v[232:235], v[184:187], v[220:223]
s_waitcnt lgkmcnt(4)
v_mfma_f32_32x32x16_bf16 v[160:175], v[188:191], v[116:119], v[160:175]
v_mul_f32 v2, v2, v3
v_fma_f32 v128, v128, v3, v2
v_fma_f32 v129, v129, v3, v2
v_fma_f32 v130, v130, v3, v2
v_fma_f32 v131, v131, v3, v2
v_fma_f32 v132, v132, v3, v2
v_fma_f32 v133, v133, v3, v2
v_fma_f32 v134, v134, v3, v2
v_fma_f32 v135, v135, v3, v2
s_waitcnt lgkmcnt(2)
v_mfma_f32_32x32x16_bf16 v[160:175], v[192:195], v[120:123], v[160:175]
v_cvt_pk_bf16_f32 v128, v128, v129
v_cvt_pk_bf16_f32 v129, v130, v131
v_cvt_pk_bf16_f32 v130, v132, v133
v_cvt_pk_bf16_f32 v131, v134, v135
buffer_store_dwordx4 v[128:131], v14, s[24:27], s47 offen sc1
v_fma_f32 v136, v136, v3, v2
v_fma_f32 v137, v137, v3, v2
v_fma_f32 v138, v138, v3, v2
v_fma_f32 v139, v139, v3, v2
s_waitcnt lgkmcnt(0)
v_mfma_f32_32x32x16_bf16 v[160:175], v[176:179], v[124:127], v[160:175]
v_fma_f32 v140, v140, v3, v2
v_fma_f32 v141, v141, v3, v2
v_fma_f32 v142, v142, v3, v2
v_fma_f32 v143, v143, v3, v2
v_cvt_pk_bf16_f32 v132, v136, v137
v_cvt_pk_bf16_f32 v133, v138, v139
v_cvt_pk_bf16_f32 v134, v140, v141
v_cvt_pk_bf16_f32 v135, v142, v143
buffer_store_dwordx4 v[132:135], v14, s[24:27], s47 offen offset:1024 sc1
ds_write_b32 v254, v220
s_branch P1_GT
P1_BL_CW:
s_addk_i32 s53, -1
s_cmp_lt_i32 s53, 0
s_cbranch_scc1 P1_BL_CX
v_lshrrev_b32 v2, 1, v253
buffer_load_dword v2, v2, s[4:7], 0 offen sc1
s_waitcnt vmcnt(0)
s_branch P1_BL_CR
P1_BL_PW:
s_sleep 3
s_addk_i32 s53, -1
s_cmp_lt_i32 s53, 0
s_cbranch_scc1 P1_BL_PX
v_cmp_eq_u32 vcc, -1, v3
s_cbranch_vccz P1_BL_PS0
s_mov_b64 exec, vcc
buffer_load_dwordx2 v[2:3], v253, s[24:27], s10 offen offset:0 sc1
s_mov_b64 exec, -1
P1_BL_PS0:
v_cmp_eq_u32 vcc, -1, v5
s_cbranch_vccz P1_BL_PS1
s_mov_b64 exec, vcc
buffer_load_dwordx2 v[4:5], v253, s[24:27], s10 offen offset:512 sc1
s_mov_b64 exec, -1
P1_BL_PS1:
v_cmp_eq_u32 vcc, -1, v7
s_cbranch_vccz P1_BL_PS2
s_mov_b64 exec, vcc
buffer_load_dwordx2 v[6:7], v253, s[24:27], s10 offen offset:1024 sc1
s_mov_b64 exec, -1
P1_BL_PS2:
v_cmp_eq_u32 vcc, -1, v9
s_cbranch_vccz P1_BL_PS3
s_mov_b64 exec, vcc
buffer_load_dwordx2 v[8:9], v253, s[24:27], s10 offen offset:1536 sc1
s_mov_b64 exec, -1
P1_BL_PS3:
v_cmp_eq_u32 vcc, -1, v245
s_cbranch_vccz P1_BL_PS4
s_mov_b64 exec, vcc
buffer_load_dwordx2 v[244:245], v253, s[24:27], s10 offen offset:2048 sc1
s_mov_b64 exec, -1
P1_BL_PS4:
v_cmp_eq_u32 vcc, -1, v247
s_cbranch_vccz P1_BL_PS5
s_mov_b64 exec, vcc
buffer_load_dwordx2 v[246:247], v253, s[24:27], s10 offen offset:2560 sc1
s_mov_b64 exec, -1
P1_BL_PS5:
v_cmp_eq_u32 vcc, -1, v229
s_cbranch_vccz P1_BL_PS6
s_mov_b64 exec, vcc
buffer_load_dwordx2 v[228:229], v253, s[24:27], s10 offen offset:3072 sc1
s_mov_b64 exec, -1
P1_BL_PS6:
s_waitcnt vmcnt(0)
s_branch P1_BL_PR
P1_KC:
s_mul_i32 s44, s30, 4096
v_add_u32 v3, 4096, v3
s_and_b32 s36, s29, 1
s_lshl_b32 s36, s36, 9
s_add_u32 s36, s36, s34
s_add_u32 s39, s36, 768
s_add_u32 s40, s36, 0
s_add_u32 s41, s36, 1920
s_add_u32 s42, s34, 2176
s_mov_b32 s43, 172032
v_mov_b32 v4, v5
s_waitcnt lgkmcnt(0)
s_mov_b32 s16, s66
s_and_b32 s17, s67, 0xffff
s_mov_b32 s18, 1204224
s_mov_b32 s19, 0x20000
s_mov_b32 s20, s66
s_and_b32 s21, s67, 0xffff
s_mov_b32 s22, 1204224
s_mov_b32 s23, 0x20000
s_mov_b32 s12, s64
s_and_b32 s13, s65, 0xffff
s_mov_b32 s14, 1835008
s_mov_b32 s15, 0x20000
s_add_u32 m0, s44, 57344
s_add_u32 s33, s38, 0
buffer_load_dwordx4 v2, s[12:15], s33 offen lds
buffer_load_dwordx4 v3, s[12:15], s33 offen offset:3072 lds
buffer_load_dwordx4 v4, s[16:19], s39 offen offset:1024 lds
s_add_u32 s39, s39, s43
buffer_load_dwordx4 v5, s[20:23], s40 offen offset:2048 lds
s_add_u32 s40, s40, 172032
s_barrier
s_add_u32 m0, s44, 90112
s_add_u32 s33, s38, 128
buffer_load_dwordx4 v2, s[12:15], s33 offen lds
buffer_load_dwordx4 v3, s[12:15], s33 offen offset:3072 lds
buffer_load_dwordx4 v4, s[16:19], s39 offen offset:1024 lds
s_add_u32 s39, s39, s43
buffer_load_dwordx4 v5, s[20:23], s40 offen offset:2048 lds
s_add_u32 s40, s40, 172032
s_mov_b32 s24, s58
s_and_b32 s25, s59, 0xffff
s_mov_b32 s26, 50331648
s_mov_b32 s27, 0x20000
s_mov_b32 s4, s56
s_and_b32 s5, s57, 0xffff
s_mov_b32 s6, 256
s_mov_b32 s7, 0x20000
s_lshl_b32 s33, s32, 1
s_xor_b32 s46, s33, s31
v_and_b32 v248, 31, v1
v_lshrrev_b32 v249, 5, v1
v_bfe_u32 v250, v1, 1, 3
v_xor_b32 v250, v250, v249
s_lshl_b32 s34, s46, 1
v_xor_b32 v250, s34, v250
v_lshlrev_b32 v250, 4, v250
v_and_b32 v251, 7, v1
v_lshl_add_u32 v250, v251, 7, v250
v_bfe_u32 v251, v1, 3, 1
v_mul_u32_u24 v6, 3072, v251
v_bfe_u32 v251, v1, 4, 1
v_mul_u32_u24 v251, 4096, v251
s_mul_i32 s34, s31, 8192
s_add_u32 s34, s34, 57344
v_add3_u32 v251, v251, v6, s34
v_xor_b32 v6, 0, v250
v_add_u32 v6, v251, v6
v_xor_b32 v7, 32, v250
v_add_u32 v7, v251, v7
v_xor_b32 v8, 64, v250
v_add_u32 v8, v251, v8
v_xor_b32 v9, 96, v250
v_add_u32 v9, v251, v9
v_lshlrev_b32 v252, 5, v248
v_lshl_add_u32 v252, v249, 4, v252
s_lshl_b32 s34, s32, 6
v_and_b32 v248, 3, v1
v_lshlrev_b32 v248, 3, v248
v_and_b32 v250, 16, v1
v_lshl_add_u32 v248, v250, 1, v248
v_and_b32 v250, 8, v1
v_lshlrev_b32 v250, 3, v250
v_xor_b32 v250, s34, v250
v_or_b32 v248, v248, v250
v_bfe_u32 v250, v1, 2, 2
v_lshl_add_u32 v248, v250, 7, v248
v_lshl_add_u32 v15, v249, 10, v248
v_mul_u32_u24 v249, 4096, v249
v_add_u32 v248, v248, v249
s_xor_b32 s35, s46, 0
s_mul_i32 s35, s35, 8192
s_add_u32 s35, s35, 58368
v_add_u32 v10, s35, v248
s_xor_b32 s35, s46, 1
s_mul_i32 s35, s35, 8192
s_add_u32 s35, s35, 58368
v_add_u32 v11, s35, v248
s_xor_b32 s35, s46, 2
s_mul_i32 s35, s35, 8192
s_add_u32 s35, s35, 58368
v_add_u32 v12, s35, v248
s_xor_b32 s35, s46, 3
s_mul_i32 s35, s35, 8192
s_add_u32 s35, s35, 58368
v_add_u32 v13, s35, v248
v_lshlrev_b32 v14, 4, v1
v_lshlrev_b32 v253, 3, v1
s_lshl_b32 s33, s32, 10
s_lshl_b32 s34, s31, 2
s_add_u32 s33, s33, s34
s_add_u32 s33, s33, 114688
v_add_u32 v254, s33, v14
v_mov_b32 v224, 0
v_mov_b32 v225, 0
v_mov_b32 v226, 0
v_mov_b32 v227, 0
s_mov_b32 s54, 0xf0f00f0f
s_mov_b32 s55, 0xf0f00f0f
v_mov_b32 v248, 0x3f803f80
v_cndmask_b32 v232, 0, v248, s[54:55]
v_cndmask_b32 v233, 0, v248, s[54:55]
v_cndmask_b32 v234, 0, v248, s[54:55]
v_cndmask_b32 v235, 0, v248, s[54:55]
s_mov_b32 s54, 0
s_mov_b32 s55, -1
v_mov_b32 v237, 0
v_mov_b32 v238, 0
v_mov_b32 v239, 0
v_mov_b32 v255, 1
s_lshl_b32 s45, s30, 10
s_mov_b32 s53, 0x8000
s_lshl_b32 s33, s28, 2
s_add_u32 s33, s33, s31
s_mul_i32 s35, s33, 28672
s_and_b32 s33, s29, 1
s_lshl_b32 s34, s33, 3
s_add_u32 s34, s34, s32
s_lshl_b32 s34, s34, 10
s_add_u32 s35, s35, 12582912
s_add_u32 s47, s34, s35
s_add_u32 s48, s47, 4096
s_add_u32 s49, s47, 2048
s_lshl_b32 s34, s33, 10
s_add_u32 s34, s34, s35
s_add_u32 s50, s34, 6144
s_lshl_b32 s9, s28, 2
s_add_u32 s9, s9, s33
s_lshl_b32 s9, s9, 2
s_lshl_b32 s34, s28, 1
s_add_u32 s34, s34, s33
s_lshl_b32 s34, s34, 3
s_add_u32 s34, s34, s30
s_lshl_b32 s35, s34, 9
s_add_u32 s35, s35, 15728640
s_lshl_b32 s34, s34, 10
s_add_u32 s10, s34, 14680064
s_xor_b32 s33, s33, 1
s_lshl_b32 s36, s33, 6
v_mov_b32 v248, -1
v_mov_b32 v249, -1
v_mov_b32 v250, -1
v_mov_b32 v251, -1
v_lshlrev_b32 v230, 2, v1
v_lshrrev_b32 v0, 2, v1
v_lshlrev_b32 v0, 5, v0
v_and_or_b32 v0, v1, 3, v0
v_lshlrev_b32 v0, 7, v0
s_and_b32 s33, s2, 6
s_lshl_b32 s33, s33, 4
s_and_b32 s34, s2, 24
s_add_u32 s33, s33, s34
s_add_u32 s33, s33, s30
s_lshl_b32 s33, s33, 5
s_and_b32 s34, s2, 1
s_add_u32 s33, s33, s34
s_lshl_b32 s8, s33, 11
buffer_store_dwordx4 v[248:251], v14, s[24:27], s10 offen sc1
buffer_store_dwordx2 v[238:239], v253, s[24:27], s35 offen sc1
s_add_u32 s35, s35, 4294180864
buffer_store_dwordx2 v[248:249], v253, s[24:27], s35 offen sc1
s_lshl_b32 s11, s28, 9
s_add_u32 s11, s11, s29
s_lshl_b32 s11, s11, 2
s_add_u32 s11, s11, 15728640
s_waitcnt vmcnt(7)
s_barrier
ds_read_b128 v[16:19], v6 offset:0
ds_read_b64_tr_b16 v[160:161], v10 offset:0
ds_read_b64_tr_b16 v[162:163], v10 offset:512
ds_read_b64_tr_b16 v[176:177], v10 offset:1024
ds_read_b64_tr_b16 v[178:179], v10 offset:1536
ds_read_b128 v[20:23], v7 offset:0
ds_read_b64_tr_b16 v[164:165], v11 offset:0
ds_read_b64_tr_b16 v[166:167], v11 offset:512
ds_read_b64_tr_b16 v[180:181], v11 offset:1024
ds_read_b64_tr_b16 v[182:183], v11 offset:1536
ds_read_b128 v[24:27], v8 offset:0
ds_read_b64_tr_b16 v[168:169], v12 offset:0
ds_read_b64_tr_b16 v[170:171], v12 offset:512
ds_read_b64_tr_b16 v[184:185], v12 offset:1024
ds_read_b64_tr_b16 v[186:187], v12 offset:1536
ds_read_b128 v[28:31], v9 offset:0
ds_read_b64_tr_b16 v[172:173], v13 offset:0
ds_read_b64_tr_b16 v[174:175], v13 offset:512
ds_read_b64_tr_b16 v[188:189], v13 offset:1024
ds_read_b64_tr_b16 v[190:191], v13 offset:1536
s_add_u32 m0, s44, 122880
s_add_u32 s33, s38, 256
buffer_load_dwordx4 v2, s[12:15], s33 offen lds
buffer_load_dwordx4 v3, s[12:15], s33 offen offset:3072 lds
buffer_load_dwordx4 v4, s[16:19], s39 offen offset:1024 lds
s_add_u32 s39, s39, s43
buffer_load_dwordx4 v5, s[20:23], s40 offen offset:2048 lds
s_add_u32 s40, s40, 172032
s_waitcnt lgkmcnt(0)
s_waitcnt vmcnt(7)
s_barrier
v_mfma_f32_32x32x16_bf16 v[128:143], v[16:19], v[160:163], 0
ds_read_b128 v[32:35], v6 offset:32768
ds_read_b64_tr_b16 v[192:193], v10 offset:32768
v_lshlrev_b32 v248, 16, v16
v_and_b32 v249, 0xffff0000, v16
v_add_f32 v224, v224, v248
v_fmac_f32 v225, v248, v248
v_add_f32 v226, v226, v249
v_fmac_f32 v227, v249, v249
v_mfma_f32_32x32x16_bf16 v[144:159], v[16:19], v[176:179], 0
ds_read_b64_tr_b16 v[194:195], v10 offset:33280
ds_read_b64_tr_b16 v[208:209], v10 offset:33792
ds_read_b64_tr_b16 v[210:211], v10 offset:34304
s_add_u32 m0, s44, 57344
s_add_u32 s33, s38, 384
buffer_load_dwordx4 v2, s[12:15], s33 offen lds
v_lshlrev_b32 v250, 16, v17
v_and_b32 v251, 0xffff0000, v17
v_add_f32 v224, v224, v250
v_fmac_f32 v225, v250, v250
v_add_f32 v226, v226, v251
v_fmac_f32 v227, v251, v251
v_mfma_f32_32x32x16_bf16 v[128:143], v[20:23], v[164:167], v[128:143]
ds_read_b128 v[36:39], v7 offset:32768
ds_read_b64_tr_b16 v[196:197], v11 offset:32768
v_lshlrev_b32 v248, 16, v18
v_and_b32 v249, 0xffff0000, v18
v_add_f32 v224, v224, v248
v_fmac_f32 v225, v248, v248
v_add_f32 v226, v226, v249
v_fmac_f32 v227, v249, v249
v_mfma_f32_32x32x16_bf16 v[144:159], v[20:23], v[180:183], v[144:159]
ds_read_b64_tr_b16 v[198:199], v11 offset:33280
ds_read_b64_tr_b16 v[212:213], v11 offset:33792
ds_read_b64_tr_b16 v[214:215], v11 offset:34304
buffer_load_dwordx4 v3, s[12:15], s33 offen offset:3072 lds
v_lshlrev_b32 v250, 16, v19
v_and_b32 v251, 0xffff0000, v19
v_add_f32 v224, v224, v250
v_fmac_f32 v225, v250, v250
v_add_f32 v226, v226, v251
v_fmac_f32 v227, v251, v251
v_mfma_f32_16x16x32_bf16 v[240:243], v[232:235], v[160:163], 0
v_mfma_f32_32x32x16_bf16 v[128:143], v[24:27], v[168:171], v[128:143]
ds_read_b128 v[40:43], v8 offset:32768
ds_read_b64_tr_b16 v[200:201], v12 offset:32768
v_lshlrev_b32 v248, 16, v20
v_and_b32 v249, 0xffff0000, v20
v_add_f32 v224, v224, v248
v_fmac_f32 v225, v248, v248
v_add_f32 v226, v226, v249
v_fmac_f32 v227, v249, v249
v_mfma_f32_32x32x16_bf16 v[144:159], v[24:27], v[184:187], v[144:159]
ds_read_b64_tr_b16 v[202:203], v12 offset:33280
ds_read_b64_tr_b16 v[216:217], v12 offset:33792
ds_read_b64_tr_b16 v[218:219], v12 offset:34304
buffer_load_dwordx4 v4, s[16:19], s39 offen offset:1024 lds
s_add_u32 s39, s39, s43
v_lshlrev_b32 v250, 16, v21
v_and_b32 v251, 0xffff0000, v21
v_add_f32 v224, v224, v250
v_fmac_f32 v225, v250, v250
v_add_f32 v226, v226, v251
v_fmac_f32 v227, v251, v251
v_mfma_f32_32x32x16_bf16 v[128:143], v[28:31], v[172:175], v[128:143]
ds_read_b128 v[44:47], v9 offset:32768
ds_read_b64_tr_b16 v[204:205], v13 offset:32768
v_lshlrev_b32 v248, 16, v22
v_and_b32 v249, 0xffff0000, v22
v_add_f32 v224, v224, v248
v_fmac_f32 v225, v248, v248
v_add_f32 v226, v226, v249
v_fmac_f32 v227, v249, v249
v_mfma_f32_32x32x16_bf16 v[144:159], v[28:31], v[188:191], v[144:159]
ds_read_b64_tr_b16 v[206:207], v13 offset:33280
ds_read_b64_tr_b16 v[220:221], v13 offset:33792
ds_read_b64_tr_b16 v[222:223], v13 offset:34304
buffer_load_dwordx4 v5, s[20:23], s40 offen offset:2048 lds
s_add_u32 s40, s40, 172032
v_lshlrev_b32 v250, 16, v23
v_and_b32 v251, 0xffff0000, v23
v_add_f32 v224, v224, v250
v_fmac_f32 v225, v250, v250
v_add_f32 v226, v226, v251
v_fmac_f32 v227, v251, v251
v_mfma_f32_16x16x32_bf16 v[244:247], v[232:235], v[176:179], 0
s_waitcnt lgkmcnt(0)
s_waitcnt vmcnt(4)
s_barrier
v_add_u32 v6, 49152, v6
v_add_u32 v7, 49152, v7
v_add_u32 v8, 49152, v8
v_add_u32 v9, 49152, v9
v_add_u32 v10, 49152, v10
v_add_u32 v11, 49152, v11
v_add_u32 v12, 49152, v12
v_add_u32 v13, 49152, v13
v_mfma_f32_32x32x16_bf16 v[128:143], v[32:35], v[192:195], v[128:143]
ds_read_b128 v[48:51], v6 offset:16384
ds_read_b64_tr_b16 v[160:161], v10 offset:16384
v_lshlrev_b32 v248, 16, v32
v_and_b32 v249, 0xffff0000, v32
v_add_f32 v224, v224, v248
v_fmac_f32 v225, v248, v248
v_add_f32 v226, v226, v249
v_fmac_f32 v227, v249, v249
v_mfma_f32_32x32x16_bf16 v[144:159], v[32:35], v[208:211], v[144:159]
ds_read_b64_tr_b16 v[162:163], v10 offset:16896
ds_read_b64_tr_b16 v[176:177], v10 offset:17408
ds_read_b64_tr_b16 v[178:179], v10 offset:17920
s_add_u32 m0, s44, 90112
s_add_u32 s33, s38, 512
buffer_load_dwordx4 v2, s[12:15], s33 offen lds
v_lshlrev_b32 v250, 16, v33
v_and_b32 v251, 0xffff0000, v33
v_add_f32 v224, v224, v250
v_fmac_f32 v225, v250, v250
v_add_f32 v226, v226, v251
v_fmac_f32 v227, v251, v251
v_mfma_f32_32x32x16_bf16 v[128:143], v[36:39], v[196:199], v[128:143]
ds_read_b128 v[52:55], v7 offset:16384
ds_read_b64_tr_b16 v[164:165], v11 offset:16384
v_lshlrev_b32 v248, 16, v34
v_and_b32 v249, 0xffff0000, v34
v_add_f32 v224, v224, v248
v_fmac_f32 v225, v248, v248
v_add_f32 v226, v226, v249
v_fmac_f32 v227, v249, v249
v_mfma_f32_32x32x16_bf16 v[144:159], v[36:39], v[212:215], v[144:159]
ds_read_b64_tr_b16 v[166:167], v11 offset:16896
ds_read_b64_tr_b16 v[180:181], v11 offset:17408
ds_read_b64_tr_b16 v[182:183], v11 offset:17920
buffer_load_dwordx4 v3, s[12:15], s33 offen offset:3072 lds
v_lshlrev_b32 v250, 16, v35
v_and_b32 v251, 0xffff0000, v35
v_add_f32 v224, v224, v250
v_fmac_f32 v225, v250, v250
v_add_f32 v226, v226, v251
v_fmac_f32 v227, v251, v251
v_mfma_f32_16x16x32_bf16 v[240:243], v[232:235], v[192:195], v[240:243]
v_mfma_f32_32x32x16_bf16 v[128:143], v[40:43], v[200:203], v[128:143]
ds_read_b128 v[56:59], v8 offset:16384
ds_read_b64_tr_b16 v[168:169], v12 offset:16384
buffer_load_dwordx4 v4, s[16:19], s39 offen offset:1024 lds
s_add_u32 s39, s39, s43
v_lshlrev_b32 v248, 16, v36
v_and_b32 v249, 0xffff0000, v36
v_add_f32 v224, v224, v248
v_fmac_f32 v225, v248, v248
v_add_f32 v226, v226, v249
v_fmac_f32 v227, v249, v249
v_mfma_f32_32x32x16_bf16 v[144:159], v[40:43], v[216:219], v[144:159]
ds_read_b64_tr_b16 v[170:171], v12 offset:16896
ds_read_b64_tr_b16 v[184:185], v12 offset:17408
ds_read_b64_tr_b16 v[186:187], v12 offset:17920
v_lshlrev_b32 v250, 16, v37
v_and_b32 v251, 0xffff0000, v37
v_add_f32 v224, v224, v250
v_fmac_f32 v225, v250, v250
v_add_f32 v226, v226, v251
v_fmac_f32 v227, v251, v251
v_mfma_f32_32x32x16_bf16 v[128:143], v[44:47], v[204:207], v[128:143]
ds_read_b128 v[60:63], v9 offset:16384
ds_read_b64_tr_b16 v[172:173], v13 offset:16384
buffer_load_dwordx4 v5, s[20:23], s40 offen offset:2048 lds
s_add_u32 s40, s40, 172032
v_lshlrev_b32 v248, 16, v38
v_and_b32 v249, 0xffff0000, v38
v_add_f32 v224, v224, v248
v_fmac_f32 v225, v248, v248
v_add_f32 v226, v226, v249
v_fmac_f32 v227, v249, v249
v_mfma_f32_32x32x16_bf16 v[144:159], v[44:47], v[220:223], v[144:159]
ds_read_b64_tr_b16 v[174:175], v13 offset:16896
ds_read_b64_tr_b16 v[188:189], v13 offset:17408
ds_read_b64_tr_b16 v[190:191], v13 offset:17920
s_cmp_eq_u32 s30, 7
s_cselect_b64 exec, 1, 0
buffer_store_dword v255, v237, s[4:7], s9 offen sc1
s_mov_b64 exec, -1
v_lshlrev_b32 v250, 16, v39
v_and_b32 v251, 0xffff0000, v39
v_add_f32 v224, v224, v250
v_fmac_f32 v225, v250, v250
v_add_f32 v226, v226, v251
v_fmac_f32 v227, v251, v251
v_mfma_f32_16x16x32_bf16 v[244:247], v[232:235], v[208:211], v[244:247]
s_waitcnt lgkmcnt(0)
s_waitcnt vmcnt(4)
s_barrier
v_subrev_u32 v6, 49152, v6
v_subrev_u32 v7, 49152, v7
v_subrev_u32 v8, 49152, v8
v_subrev_u32 v9, 49152, v9
v_subrev_u32 v10, 49152, v10
v_subrev_u32 v11, 49152, v11
v_subrev_u32 v12, 49152, v12
v_subrev_u32 v13, 49152, v13
v_mfma_f32_32x32x16_bf16 v[128:143], v[48:51], v[160:163], v[128:143]
ds_read_b128 v[64:67], v6 offset:0
ds_read_b64_tr_b16 v[192:193], v10 offset:0
v_lshlrev_b32 v248, 16, v48
v_and_b32 v249, 0xffff0000, v48
v_add_f32 v224, v224, v248
v_fmac_f32 v225, v248, v248
v_add_f32 v226, v226, v249
v_fmac_f32 v227, v249, v249
v_mfma_f32_32x32x16_bf16 v[144:159], v[48:51], v[176:179], v[144:159]
ds_read_b64_tr_b16 v[194:195], v10 offset:512
ds_read_b64_tr_b16 v[208:209], v10 offset:1024
ds_read_b64_tr_b16 v[210:211], v10 offset:1536
s_add_u32 m0, s44, 122880
s_add_u32 s33, s38, 640
buffer_load_dwordx4 v2, s[12:15], s33 offen lds
v_lshlrev_b32 v250, 16, v49
v_and_b32 v251, 0xffff0000, v49
v_add_f32 v224, v224, v250
v_fmac_f32 v225, v250, v250
v_add_f32 v226, v226, v251
v_fmac_f32 v227, v251, v251
v_mfma_f32_32x32x16_bf16 v[128:143], v[52:55], v[164:167], v[128:143]
ds_read_b128 v[68:71], v7 offset:0
ds_read_b64_tr_b16 v[196:197], v11 offset:0
v_lshlrev_b32 v248, 16, v50
v_and_b32 v249, 0xffff0000, v50
v_add_f32 v224, v224, v248
v_fmac_f32 v225, v248, v248
v_add_f32 v226, v226, v249
v_fmac_f32 v227, v249, v249
v_mfma_f32_32x32x16_bf16 v[144:159], v[52:55], v[180:183], v[144:159]
ds_read_b64_tr_b16 v[198:199], v11 offset:512
ds_read_b64_tr_b16 v[212:213], v11 offset:1024
ds_read_b64_tr_b16 v[214:215], v11 offset:1536
buffer_load_dwordx4 v3, s[12:15], s33 offen offset:3072 lds
v_lshlrev_b32 v250, 16, v51
v_and_b32 v251, 0xffff0000, v51
v_add_f32 v224, v224, v250
v_fmac_f32 v225, v250, v250
v_add_f32 v226, v226, v251
v_fmac_f32 v227, v251, v251
v_mfma_f32_16x16x32_bf16 v[240:243], v[232:235], v[160:163], v[240:243]
v_mfma_f32_32x32x16_bf16 v[128:143], v[56:59], v[168:171], v[128:143]
ds_read_b128 v[72:75], v8 offset:0
ds_read_b64_tr_b16 v[200:201], v12 offset:0
v_lshlrev_b32 v248, 16, v52
v_and_b32 v249, 0xffff0000, v52
v_add_f32 v224, v224, v248
v_fmac_f32 v225, v248, v248
v_add_f32 v226, v226, v249
v_fmac_f32 v227, v249, v249
v_mfma_f32_32x32x16_bf16 v[144:159], v[56:59], v[184:187], v[144:159]
ds_read_b64_tr_b16 v[202:203], v12 offset:512
ds_read_b64_tr_b16 v[216:217], v12 offset:1024
ds_read_b64_tr_b16 v[218:219], v12 offset:1536
buffer_load_dwordx4 v4, s[16:19], s39 offen offset:1024 lds
s_add_u32 s39, s39, s43
v_lshlrev_b32 v250, 16, v53
v_and_b32 v251, 0xffff0000, v53
v_add_f32 v224, v224, v250
v_fmac_f32 v225, v250, v250
v_add_f32 v226, v226, v251
v_fmac_f32 v227, v251, v251
v_mfma_f32_32x32x16_bf16 v[128:143], v[60:63], v[172:175], v[128:143]
ds_read_b128 v[76:79], v9 offset:0
ds_read_b64_tr_b16 v[204:205], v13 offset:0
v_lshlrev_b32 v248, 16, v54
v_and_b32 v249, 0xffff0000, v54
v_add_f32 v224, v224, v248
v_fmac_f32 v225, v248, v248
v_add_f32 v226, v226, v249
v_fmac_f32 v227, v249, v249
v_mfma_f32_32x32x16_bf16 v[144:159], v[60:63], v[188:191], v[144:159]
ds_read_b64_tr_b16 v[206:207], v13 offset:512
ds_read_b64_tr_b16 v[220:221], v13 offset:1024
ds_read_b64_tr_b16 v[222:223], v13 offset:1536
buffer_load_dwordx4 v5, s[20:23], s40 offen offset:2048 lds
s_add_u32 s40, s40, 172032
v_lshlrev_b32 v250, 16, v55
v_and_b32 v251, 0xffff0000, v55
v_add_f32 v224, v224, v250
v_fmac_f32 v225, v250, v250
v_add_f32 v226, v226, v251
v_fmac_f32 v227, v251, v251
v_mfma_f32_16x16x32_bf16 v[244:247], v[232:235], v[176:179], v[244:247]
s_waitcnt lgkmcnt(0)
s_waitcnt vmcnt(4)
s_barrier
v_mfma_f32_32x32x16_bf16 v[128:143], v[64:67], v[192:195], v[128:143]
ds_read_b128 v[80:83], v6 offset:32768
ds_read_b64_tr_b16 v[160:161], v10 offset:32768
v_lshlrev_b32 v248, 16, v64
v_and_b32 v249, 0xffff0000, v64
v_add_f32 v224, v224, v248
v_fmac_f32 v225, v248, v248
v_add_f32 v226, v226, v249
v_fmac_f32 v227, v249, v249
v_mfma_f32_32x32x16_bf16 v[144:159], v[64:67], v[208:211], v[144:159]
ds_read_b64_tr_b16 v[162:163], v10 offset:33280
ds_read_b64_tr_b16 v[176:177], v10 offset:33792
ds_read_b64_tr_b16 v[178:179], v10 offset:34304
s_add_u32 m0, s44, 57344
s_add_u32 s33, s38, 768
buffer_load_dwordx4 v2, s[12:15], s33 offen lds
v_lshlrev_b32 v250, 16, v65
v_and_b32 v251, 0xffff0000, v65
v_add_f32 v224, v224, v250
v_fmac_f32 v225, v250, v250
v_add_f32 v226, v226, v251
v_fmac_f32 v227, v251, v251
v_mfma_f32_32x32x16_bf16 v[128:143], v[68:71], v[196:199], v[128:143]
ds_read_b128 v[84:87], v7 offset:32768
ds_read_b64_tr_b16 v[164:165], v11 offset:32768
v_lshlrev_b32 v248, 16, v66
v_and_b32 v249, 0xffff0000, v66
v_add_f32 v224, v224, v248
v_fmac_f32 v225, v248, v248
v_add_f32 v226, v226, v249
v_fmac_f32 v227, v249, v249
v_mfma_f32_32x32x16_bf16 v[144:159], v[68:71], v[212:215], v[144:159]
ds_read_b64_tr_b16 v[166:167], v11 offset:33280
ds_read_b64_tr_b16 v[180:181], v11 offset:33792
ds_read_b64_tr_b16 v[182:183], v11 offset:34304
buffer_load_dwordx4 v3, s[12:15], s33 offen offset:3072 lds
v_lshlrev_b32 v250, 16, v67
v_and_b32 v251, 0xffff0000, v67
v_add_f32 v224, v224, v250
v_fmac_f32 v225, v250, v250
v_add_f32 v226, v226, v251
v_fmac_f32 v227, v251, v251
v_mfma_f32_16x16x32_bf16 v[240:243], v[232:235], v[192:195], v[240:243]
v_mfma_f32_32x32x16_bf16 v[128:143], v[72:75], v[200:203], v[128:143]
ds_read_b128 v[88:91], v8 offset:32768
ds_read_b64_tr_b16 v[168:169], v12 offset:32768
v_lshlrev_b32 v248, 16, v68
v_and_b32 v249, 0xffff0000, v68
v_add_f32 v224, v224, v248
v_fmac_f32 v225, v248, v248
v_add_f32 v226, v226, v249
v_fmac_f32 v227, v249, v249
v_mfma_f32_32x32x16_bf16 v[144:159], v[72:75], v[216:219], v[144:159]
ds_read_b64_tr_b16 v[170:171], v12 offset:33280
ds_read_b64_tr_b16 v[184:185], v12 offset:33792
ds_read_b64_tr_b16 v[186:187], v12 offset:34304
buffer_load_dwordx4 v4, s[16:19], s39 offen offset:1024 lds
s_add_u32 s39, s39, s43
v_lshlrev_b32 v250, 16, v69
v_and_b32 v251, 0xffff0000, v69
v_add_f32 v224, v224, v250
v_fmac_f32 v225, v250, v250
v_add_f32 v226, v226, v251
v_fmac_f32 v227, v251, v251
v_mfma_f32_32x32x16_bf16 v[128:143], v[76:79], v[204:207], v[128:143]
ds_read_b128 v[92:95], v9 offset:32768
ds_read_b64_tr_b16 v[172:173], v13 offset:32768
v_lshlrev_b32 v248, 16, v70
v_and_b32 v249, 0xffff0000, v70
v_add_f32 v224, v224, v248
v_fmac_f32 v225, v248, v248
v_add_f32 v226, v226, v249
v_fmac_f32 v227, v249, v249
v_mfma_f32_32x32x16_bf16 v[144:159], v[76:79], v[220:223], v[144:159]
ds_read_b64_tr_b16 v[174:175], v13 offset:33280
ds_read_b64_tr_b16 v[188:189], v13 offset:33792
ds_read_b64_tr_b16 v[190:191], v13 offset:34304
buffer_load_dwordx4 v5, s[20:23], s40 offen offset:2048 lds
s_add_u32 s40, s40, 172032
v_lshlrev_b32 v250, 16, v71
v_and_b32 v251, 0xffff0000, v71
v_add_f32 v224, v224, v250
v_fmac_f32 v225, v250, v250
v_add_f32 v226, v226, v251
v_fmac_f32 v227, v251, v251
v_mfma_f32_16x16x32_bf16 v[244:247], v[232:235], v[208:211], v[244:247]
s_waitcnt lgkmcnt(0)
s_waitcnt vmcnt(4)
s_barrier
v_add_u32 v6, 49152, v6
v_add_u32 v7, 49152, v7
v_add_u32 v8, 49152, v8
v_add_u32 v9, 49152, v9
v_add_u32 v10, 49152, v10
v_add_u32 v11, 49152, v11
v_add_u32 v12, 49152, v12
v_add_u32 v13, 49152, v13
v_mfma_f32_32x32x16_bf16 v[128:143], v[80:83], v[160:163], v[128:143]
ds_read_b128 v[96:99], v6 offset:16384
ds_read_b64_tr_b16 v[192:193], v10 offset:16384
v_lshlrev_b32 v248, 16, v80
v_and_b32 v249, 0xffff0000, v80
v_add_f32 v224, v224, v248
v_fmac_f32 v225, v248, v248
v_add_f32 v226, v226, v249
v_fmac_f32 v227, v249, v249
v_mfma_f32_32x32x16_bf16 v[144:159], v[80:83], v[176:179], v[144:159]
ds_read_b64_tr_b16 v[194:195], v10 offset:16896
ds_read_b64_tr_b16 v[208:209], v10 offset:17408
ds_read_b64_tr_b16 v[210:211], v10 offset:17920
s_add_u32 m0, s45, 0
s_nop 0
buffer_load_dwordx4 v4, s[16:19], s41 offen lds
s_add_u32 s41, s41, s43
v_lshlrev_b32 v250, 16, v81
v_and_b32 v251, 0xffff0000, v81
v_add_f32 v224, v224, v250
v_fmac_f32 v225, v250, v250
v_add_f32 v226, v226, v251
v_fmac_f32 v227, v251, v251
v_mfma_f32_32x32x16_bf16 v[128:143], v[84:87], v[164:167], v[128:143]
ds_read_b128 v[100:103], v7 offset:16384
ds_read_b64_tr_b16 v[196:197], v11 offset:16384
v_lshlrev_b32 v248, 16, v82
v_and_b32 v249, 0xffff0000, v82
v_add_f32 v224, v224, v248
v_fmac_f32 v225, v248, v248
v_add_f32 v226, v226, v249
v_fmac_f32 v227, v249, v249
v_mfma_f32_32x32x16_bf16 v[144:159], v[84:87], v[180:183], v[144:159]
ds_read_b64_tr_b16 v[198:199], v11 offset:16896
ds_read_b64_tr_b16 v[212:213], v11 offset:17408
ds_read_b64_tr_b16 v[214:215], v11 offset:17920
s_add_u32 m0, s45, 8192
s_nop 0
buffer_load_dwordx4 v4, s[16:19], s41 offen lds
s_add_u32 s41, s41, s43
v_lshlrev_b32 v250, 16, v83
v_and_b32 v251, 0xffff0000, v83
v_add_f32 v224, v224, v250
v_fmac_f32 v225, v250, v250
v_add_f32 v226, v226, v251
v_fmac_f32 v227, v251, v251
v_mfma_f32_16x16x32_bf16 v[240:243], v[232:235], v[160:163], v[240:243]
v_mfma_f32_32x32x16_bf16 v[128:143], v[88:91], v[168:171], v[128:143]
ds_read_b128 v[104:107], v8 offset:16384
ds_read_b64_tr_b16 v[200:201], v12 offset:16384
v_lshlrev_b32 v248, 16, v84
v_and_b32 v249, 0xffff0000, v84
v_add_f32 v224, v224, v248
v_fmac_f32 v225, v248, v248
v_add_f32 v226, v226, v249
v_fmac_f32 v227, v249, v249
v_mfma_f32_32x32x16_bf16 v[144:159], v[88:91], v[184:187], v[144:159]
ds_read_b64_tr_b16 v[202:203], v12 offset:16896
ds_read_b64_tr_b16 v[216:217], v12 offset:17408
ds_read_b64_tr_b16 v[218:219], v12 offset:17920
s_add_u32 m0, s45, 16384
s_nop 0
buffer_load_dwordx4 v4, s[16:19], s41 offen lds
s_add_u32 s41, s41, s43
v_lshlrev_b32 v250, 16, v85
v_and_b32 v251, 0xffff0000, v85
v_add_f32 v224, v224, v250
v_fmac_f32 v225, v250, v250
v_add_f32 v226, v226, v251
v_fmac_f32 v227, v251, v251
v_mfma_f32_32x32x16_bf16 v[128:143], v[92:95], v[172:175], v[128:143]
ds_read_b128 v[108:111], v9 offset:16384
ds_read_b64_tr_b16 v[204:205], v13 offset:16384
v_lshlrev_b32 v248, 16, v86
v_and_b32 v249, 0xffff0000, v86
v_add_f32 v224, v224, v248
v_fmac_f32 v225, v248, v248
v_add_f32 v226, v226, v249
v_fmac_f32 v227, v249, v249
v_mfma_f32_32x32x16_bf16 v[144:159], v[92:95], v[188:191], v[144:159]
ds_read_b64_tr_b16 v[206:207], v13 offset:16896
ds_read_b64_tr_b16 v[220:221], v13 offset:17408
ds_read_b64_tr_b16 v[222:223], v13 offset:17920
s_add_u32 m0, s45, 24576
s_nop 0
buffer_load_dwordx4 v4, s[16:19], s41 offen lds
s_add_u32 s41, s41, s43
v_lshlrev_b32 v250, 16, v87
v_and_b32 v251, 0xffff0000, v87
v_add_f32 v224, v224, v250
v_fmac_f32 v225, v250, v250
v_add_f32 v226, v226, v251
v_fmac_f32 v227, v251, v251
v_mfma_f32_16x16x32_bf16 v[244:247], v[232:235], v[176:179], v[244:247]
s_waitcnt lgkmcnt(0)
s_waitcnt vmcnt(4)
s_barrier
v_subrev_u32 v6, 49152, v6
v_subrev_u32 v7, 49152, v7
v_subrev_u32 v8, 49152, v8
v_subrev_u32 v9, 49152, v9
v_subrev_u32 v10, 49152, v10
v_subrev_u32 v11, 49152, v11
v_subrev_u32 v12, 49152, v12
v_subrev_u32 v13, 49152, v13
v_mfma_f32_32x32x16_bf16 v[128:143], v[96:99], v[192:195], v[128:143]
ds_read_b128 v[112:115], v6 offset:0
ds_read_b64_tr_b16 v[160:161], v10 offset:0
v_lshlrev_b32 v248, 16, v96
v_and_b32 v249, 0xffff0000, v96
v_add_f32 v224, v224, v248
v_fmac_f32 v225, v248, v248
v_add_f32 v226, v226, v249
v_fmac_f32 v227, v249, v249
v_mfma_f32_32x32x16_bf16 v[144:159], v[96:99], v[208:211], v[144:159]
ds_read_b64_tr_b16 v[162:163], v10 offset:512
ds_read_b64_tr_b16 v[176:177], v10 offset:1024
ds_read_b64_tr_b16 v[178:179], v10 offset:1536
v_lshlrev_b32 v250, 16, v97
v_and_b32 v251, 0xffff0000, v97
v_add_f32 v224, v224, v250
v_fmac_f32 v225, v250, v250
v_add_f32 v226, v226, v251
v_fmac_f32 v227, v251, v251
v_mfma_f32_32x32x16_bf16 v[128:143], v[100:103], v[196:199], v[128:143]
ds_read_b128 v[116:119], v7 offset:0
ds_read_b64_tr_b16 v[164:165], v11 offset:0
s_add_u32 m0, s45, 32768
s_nop 0
buffer_load_dwordx4 v4, s[16:19], s41 offen lds
s_add_u32 s41, s41, s43
v_lshlrev_b32 v248, 16, v98
v_and_b32 v249, 0xffff0000, v98
v_add_f32 v224, v224, v248
v_fmac_f32 v225, v248, v248
v_add_f32 v226, v226, v249
v_fmac_f32 v227, v249, v249
v_mfma_f32_32x32x16_bf16 v[144:159], v[100:103], v[212:215], v[144:159]
ds_read_b64_tr_b16 v[166:167], v11 offset:512
ds_read_b64_tr_b16 v[180:181], v11 offset:1024
ds_read_b64_tr_b16 v[182:183], v11 offset:1536
v_lshlrev_b32 v250, 16, v99
v_and_b32 v251, 0xffff0000, v99
v_add_f32 v224, v224, v250
v_fmac_f32 v225, v250, v250
v_add_f32 v226, v226, v251
v_fmac_f32 v227, v251, v251
v_mfma_f32_16x16x32_bf16 v[240:243], v[232:235], v[192:195], v[240:243]
v_mfma_f32_32x32x16_bf16 v[128:143], v[104:107], v[200:203], v[128:143]
ds_read_b128 v[120:123], v8 offset:0
ds_read_b64_tr_b16 v[168:169], v12 offset:0
v_lshlrev_b32 v248, 16, v100
v_and_b32 v249, 0xffff0000, v100
v_add_f32 v224, v224, v248
v_fmac_f32 v225, v248, v248
v_add_f32 v226, v226, v249
v_fmac_f32 v227, v249, v249
v_mfma_f32_32x32x16_bf16 v[144:159], v[104:107], v[216:219], v[144:159]
ds_read_b64_tr_b16 v[170:171], v12 offset:512
ds_read_b64_tr_b16 v[184:185], v12 offset:1024
ds_read_b64_tr_b16 v[186:187], v12 offset:1536
s_add_u32 m0, s45, 40960
s_nop 0
buffer_load_dwordx4 v4, s[16:19], s41 offen lds
s_add_u32 s41, s41, s43
v_lshlrev_b32 v250, 16, v101
v_and_b32 v251, 0xffff0000, v101
v_add_f32 v224, v224, v250
v_fmac_f32 v225, v250, v250
v_add_f32 v226, v226, v251
v_fmac_f32 v227, v251, v251
v_mfma_f32_32x32x16_bf16 v[128:143], v[108:111], v[204:207], v[128:143]
ds_read_b128 v[124:127], v9 offset:0
ds_read_b64_tr_b16 v[172:173], v13 offset:0
v_lshlrev_b32 v248, 16, v102
v_and_b32 v249, 0xffff0000, v102
v_add_f32 v224, v224, v248
v_fmac_f32 v225, v248, v248
v_add_f32 v226, v226, v249
v_fmac_f32 v227, v249, v249
v_mfma_f32_32x32x16_bf16 v[144:159], v[108:111], v[220:223], v[144:159]
ds_read_b64_tr_b16 v[174:175], v13 offset:512
ds_read_b64_tr_b16 v[188:189], v13 offset:1024
ds_read_b64_tr_b16 v[190:191], v13 offset:1536
s_add_u32 m0, s45, 49152
s_nop 0
buffer_load_dwordx4 v4, s[16:19], s41 offen lds
s_add_u32 s41, s41, s43
v_lshlrev_b32 v250, 16, v103
v_and_b32 v251, 0xffff0000, v103
v_add_f32 v224, v224, v250
v_fmac_f32 v225, v250, v250
v_add_f32 v226, v226, v251
v_fmac_f32 v227, v251, v251
v_mfma_f32_16x16x32_bf16 v[244:247], v[232:235], v[208:211], v[244:247]
s_waitcnt lgkmcnt(0)
s_waitcnt vmcnt(4)
s_barrier
v_mfma_f32_32x32x16_bf16 v[128:143], v[112:115], v[160:163], v[128:143]
s_xor_b32 s35, s46, 0
s_lshl_b32 s35, s35, 11
v_add_u32 v10, s35, v15
s_xor_b32 s35, s46, 1
s_lshl_b32 s35, s35, 11
v_add_u32 v11, s35, v15
s_xor_b32 s35, s46, 2
s_lshl_b32 s35, s35, 11
v_add_u32 v12, s35, v15
s_xor_b32 s35, s46, 3
s_lshl_b32 s35, s35, 11
v_add_u32 v13, s35, v15
v_lshlrev_b32 v248, 16, v112
v_and_b32 v249, 0xffff0000, v112
v_add_f32 v224, v224, v248
v_fmac_f32 v225, v248, v248
v_add_f32 v226, v226, v249
v_fmac_f32 v227, v249, v249
v_mfma_f32_32x32x16_bf16 v[144:159], v[112:115], v[176:179], v[144:159]
ds_read_b64_tr_b16 v[192:193], v10 offset:0
v_lshlrev_b32 v250, 16, v113
v_and_b32 v251, 0xffff0000, v113
v_add_f32 v224, v224, v250
v_fmac_f32 v225, v250, v250
v_add_f32 v226, v226, v251
v_fmac_f32 v227, v251, v251
v_mfma_f32_32x32x16_bf16 v[128:143], v[116:119], v[164:167], v[128:143]
ds_read_b64_tr_b16 v[194:195], v10 offset:512
v_lshlrev_b32 v248, 16, v114
v_and_b32 v249, 0xffff0000, v114
v_add_f32 v224, v224, v248
v_fmac_f32 v225, v248, v248
v_add_f32 v226, v226, v249
v_fmac_f32 v227, v249, v249
v_mfma_f32_32x32x16_bf16 v[144:159], v[116:119], v[180:183], v[144:159]
ds_read_b64_tr_b16 v[196:197], v11 offset:0
v_lshlrev_b32 v250, 16, v115
v_and_b32 v251, 0xffff0000, v115
v_add_f32 v224, v224, v250
v_fmac_f32 v225, v250, v250
v_add_f32 v226, v226, v251
v_fmac_f32 v227, v251, v251
v_mfma_f32_16x16x32_bf16 v[240:243], v[232:235], v[160:163], v[240:243]
v_mfma_f32_32x32x16_bf16 v[128:143], v[120:123], v[168:171], v[128:143]
ds_read_b64_tr_b16 v[198:199], v11 offset:512
v_lshlrev_b32 v248, 16, v116
v_and_b32 v249, 0xffff0000, v116
v_add_f32 v224, v224, v248
v_fmac_f32 v225, v248, v248
v_add_f32 v226, v226, v249
v_fmac_f32 v227, v249, v249
v_mfma_f32_32x32x16_bf16 v[144:159], v[120:123], v[184:187], v[144:159]
ds_read_b64_tr_b16 v[200:201], v12 offset:0
v_lshlrev_b32 v250, 16, v117
v_and_b32 v251, 0xffff0000, v117
v_add_f32 v224, v224, v250
v_fmac_f32 v225, v250, v250
v_add_f32 v226, v226, v251
v_fmac_f32 v227, v251, v251
v_mfma_f32_32x32x16_bf16 v[128:143], v[124:127], v[172:175], v[128:143]
ds_read_b64_tr_b16 v[202:203], v12 offset:512
v_lshlrev_b32 v248, 16, v118
v_and_b32 v249, 0xffff0000, v118
v_add_f32 v224, v224, v248
v_fmac_f32 v225, v248, v248
v_add_f32 v226, v226, v249
v_fmac_f32 v227, v249, v249
v_mfma_f32_32x32x16_bf16 v[144:159], v[124:127], v[188:191], v[144:159]
ds_read_b64_tr_b16 v[204:205], v13 offset:0
ds_read_b64_tr_b16 v[206:207], v13 offset:512
v_lshlrev_b32 v250, 16, v119
v_and_b32 v251, 0xffff0000, v119
v_add_f32 v224, v224, v250
v_fmac_f32 v225, v250, v250
v_add_f32 v226, v226, v251
v_fmac_f32 v227, v251, v251
v_mfma_f32_16x16x32_bf16 v[244:247], v[232:235], v[176:179], v[244:247]
s_mov_b32 s12, s74
s_and_b32 s13, s75, 0xffff
s_mov_b32 s14, 8388608
s_mov_b32 s15, 0x20000
s_waitcnt lgkmcnt(6)
v_mfma_f32_32x32x16_bf16 v[160:175], v[16:19], v[192:195], 0
ds_read_b64_tr_b16 v[208:209], v10 offset:8192
ds_read_b64_tr_b16 v[210:211], v10 offset:8704
v_lshrrev_b32 v2, 1, v253
buffer_load_dword v2, v2, s[4:7], 0 offen sc1
v_mfma_f32_16x16x32_bf16 v[220:223], v[232:235], v[192:195], 0
v_add_f32 v224, v224, v226
v_add_f32 v225, v225, v227
s_lshl_b32 s33, s30, 9
s_add_u32 s33, s33, 118784
v_add_u32 v15, s33, v253
ds_write_b64 v15, v[224:225]
ds_write_b32 v254, v240 offset:0
ds_write_b32 v254, v244 offset:2048
v_xor_b32 v15, 2048, v15
s_waitcnt lgkmcnt(9)
v_mfma_f32_32x32x16_bf16 v[160:175], v[20:23], v[196:199], v[160:175]
ds_read_b64_tr_b16 v[192:193], v11 offset:8192
ds_read_b64_tr_b16 v[194:195], v11 offset:8704
s_add_u32 m0, s45, 57344
s_nop 0
buffer_load_dwordx4 v4, s[16:19], s42 offen lds
s_add_u32 s42, s42, s43
s_waitcnt lgkmcnt(9)
v_mfma_f32_32x32x16_bf16 v[160:175], v[24:27], v[200:203], v[160:175]
ds_read_b64_tr_b16 v[196:197], v12 offset:8192
ds_read_b64_tr_b16 v[198:199], v12 offset:8704
s_add_u32 m0, s45, 65536
s_nop 0
buffer_load_dwordx4 v4, s[16:19], s42 offen lds
s_add_u32 s42, s42, s43
s_waitcnt lgkmcnt(4)
s_barrier
v_mfma_f32_32x32x16_bf16 v[160:175], v[28:31], v[204:207], v[160:175]
ds_read_b64_tr_b16 v[200:201], v13 offset:8192
ds_read_b64_tr_b16 v[202:203], v13 offset:8704
s_add_u32 m0, s45, 73728
s_nop 0
buffer_load_dwordx4 v4, s[16:19], s42 offen lds
s_add_u32 s42, s42, s43
ds_read_b64 v[176:177], v15
v_and_b32 v15, 0xfffffff0, v254
ds_read_b128 v[180:183], v15 offset:0
ds_read_b128 v[184:187], v15 offset:2048
v_mfma_f32_32x32x16_bf16 v[160:175], v[32:35], v[208:211], v[160:175]
ds_read_b64_tr_b16 v[204:205], v10 offset:16384
ds_read_b64_tr_b16 v[206:207], v10 offset:16896
s_add_u32 m0, s45, 81920
s_nop 0
buffer_load_dwordx4 v4, s[16:19], s42 offen lds
s_add_u32 s42, s42, s43
s_waitcnt lgkmcnt(4)
v_add_f32 v224, v224, v176
v_add_f32 v225, v225, v177
v_mov_b32 v176, v224
v_mov_b32 v177, v225
v_mfma_f32_16x16x32_bf16 v[220:223], v[232:235], v[208:211], v[220:223]
v_mfma_f32_32x32x16_bf16 v[160:175], v[36:39], v[192:195], v[160:175]
ds_read_b64_tr_b16 v[208:209], v11 offset:16384
ds_read_b64_tr_b16 v[210:211], v11 offset:16896
s_add_u32 m0, s45, 90112
s_nop 0
buffer_load_dwordx4 v4, s[16:19], s42 offen lds
s_add_u32 s42, s42, s43
v_mov_b32 v241, 0
v_mov_b32 v242, 0
v_permlane32_swap_b32 v177, v225
v_permlane32_swap_b32 v176, v224
v_add_f32 v224, v224, v176
v_mfma_f32_32x32x16_bf16 v[160:175], v[40:43], v[196:199], v[160:175]
ds_read_b64_tr_b16 v[192:193], v12 offset:16384
ds_read_b64_tr_b16 v[194:195], v12 offset:16896
s_add_u32 m0, s45, 98304
s_nop 0
buffer_load_dwordx4 v4, s[16:19], s42 offen lds
s_add_u32 s42, s42, s43
v_add_f32 v225, v225, v177
v_mul_f32 v224, 0xbb124925, v224
v_mul_f32 v225, 0x3b124925, v225
v_and_b32 v176, 0xffff0000, v224
v_fma_f32 v225, -v224, v224, v225
v_mfma_f32_32x32x16_bf16 v[160:175], v[44:47], v[200:203], v[160:175]
ds_read_b64_tr_b16 v[196:197], v13 offset:16384
ds_read_b64_tr_b16 v[198:199], v13 offset:16896
s_add_u32 m0, s45, 106496
s_nop 0
buffer_load_dwordx4 v4, s[16:19], s42 offen lds
s_add_u32 s42, s42, s43
v_sub_f32 v177, v224, v176
v_max_f32 v225, 0, v225
v_cndmask_b32 v176, v176, v177, s[54:55]
v_add_f32 v225, 0x3727c5ac, v225
v_cvt_pk_bf16_f32 v236, v176, v176
s_waitcnt vmcnt(8)
s_barrier
s_waitcnt lgkmcnt(6)
v_mfma_f32_32x32x16_bf16 v[160:175], v[48:51], v[204:207], v[160:175]
ds_read_b64_tr_b16 v[200:201], v10 offset:24576
ds_read_b64_tr_b16 v[202:203], v10 offset:25088
s_mov_b32 s40, 0x33333333
s_mov_b32 s41, 0x33333333
v_rsq_f32 v226, v225
v_mov_b32 v243, 0
v_mov_b32 v245, 0
v_mov_b32 v246, 0
v_mov_b32 v247, 0
v_mfma_f32_16x16x32_bf16 v[220:223], v[232:235], v[204:207], v[220:223]
s_waitcnt lgkmcnt(6)
v_mfma_f32_32x32x16_bf16 v[160:175], v[52:55], v[208:211], v[160:175]
ds_read_b64_tr_b16 v[204:205], v11 offset:24576
ds_read_b64_tr_b16 v[206:207], v11 offset:25088
v_add_f32 v180, v180, v181
v_add_f32 v182, v182, v183
v_add_f32 v180, v180, v182
v_and_b32 v181, 0xffff0000, v180
s_waitcnt lgkmcnt(6)
v_mfma_f32_32x32x16_bf16 v[160:175], v[56:59], v[192:195], v[160:175]
ds_read_b64_tr_b16 v[208:209], v12 offset:24576
ds_read_b64_tr_b16 v[210:211], v12 offset:25088
v_sub_f32 v180, v180, v181
v_cvt_pk_bf16_f32 v240, v181, v180
v_add_f32 v184, v184, v185
v_add_f32 v186, v186, v187
v_add_f32 v184, v184, v186
s_waitcnt lgkmcnt(6)
v_mfma_f32_32x32x16_bf16 v[160:175], v[60:63], v[196:199], v[160:175]
ds_read_b64_tr_b16 v[192:193], v13 offset:24576
ds_read_b64_tr_b16 v[194:195], v13 offset:25088
v_and_b32 v185, 0xffff0000, v184
v_sub_f32 v184, v184, v185
v_cvt_pk_bf16_f32 v244, v185, v184
s_lshl_b32 s35, s30, 8
s_add_u32 s35, s35, 122880
v_lshl_add_u32 v6, v1, 2, s35
ds_write_b32 v6, v226
s_waitcnt lgkmcnt(7)
v_mfma_f32_32x32x16_bf16 v[160:175], v[64:67], v[200:203], v[160:175]
ds_read_b64_tr_b16 v[196:197], v10 offset:32768
ds_read_b64_tr_b16 v[198:199], v10 offset:33280
v_mfma_f32_32x32x16_bf16 v[128:143], v[236:239], v[240:243], v[128:143]
v_mfma_f32_32x32x16_bf16 v[144:159], v[236:239], v[244:247], v[144:159]
v_lshrrev_b32 v7, 5, v1
v_lshl_add_u32 v7, v7, 4, s35
ds_read_b128 v[176:179], v7 offset:0
v_mfma_f32_16x16x32_bf16 v[220:223], v[232:235], v[200:203], v[220:223]
s_waitcnt lgkmcnt(8)
v_mfma_f32_32x32x16_bf16 v[160:175], v[68:71], v[204:207], v[160:175]
ds_read_b64_tr_b16 v[200:201], v11 offset:32768
ds_read_b64_tr_b16 v[202:203], v11 offset:33280
ds_read_b128 v[180:183], v7 offset:32
ds_read_b128 v[184:187], v7 offset:64
ds_read_b128 v[188:191], v7 offset:96
s_waitcnt lgkmcnt(11)
v_mfma_f32_32x32x16_bf16 v[160:175], v[72:75], v[208:211], v[160:175]
ds_read_b64_tr_b16 v[204:205], v12 offset:32768
ds_read_b64_tr_b16 v[206:207], v12 offset:33280
s_waitcnt lgkmcnt(11)
v_mfma_f32_32x32x16_bf16 v[160:175], v[76:79], v[192:195], v[160:175]
ds_read_b64_tr_b16 v[208:209], v13 offset:32768
ds_read_b64_tr_b16 v[210:211], v13 offset:33280
s_waitcnt lgkmcnt(10)
v_mfma_f32_32x32x16_bf16 v[160:175], v[80:83], v[196:199], v[160:175]
ds_read_b64_tr_b16 v[192:193], v10 offset:40960
ds_read_b64_tr_b16 v[194:195], v10 offset:41472
s_waitcnt lgkmcnt(6)
v_mul_f32 v128, v128, v176
v_mul_f32 v129, v129, v177
v_mul_f32 v130, v130, v178
v_mul_f32 v131, v131, v179
v_mfma_f32_16x16x32_bf16 v[220:223], v[232:235], v[196:199], v[220:223]
v_mfma_f32_32x32x16_bf16 v[160:175], v[84:87], v[200:203], v[160:175]
ds_read_b64_tr_b16 v[196:197], v11 offset:40960
ds_read_b64_tr_b16 v[198:199], v11 offset:41472
v_mul_f32 v132, v132, v180
v_mul_f32 v133, v133, v181
v_mul_f32 v134, v134, v182
v_mul_f32 v135, v135, v183
v_mul_f32 v136, v136, v184
s_waitcnt lgkmcnt(6)
v_mfma_f32_32x32x16_bf16 v[160:175], v[88:91], v[204:207], v[160:175]
ds_read_b64_tr_b16 v[200:201], v12 offset:40960
ds_read_b64_tr_b16 v[202:203], v12 offset:41472
v_mul_f32 v137, v137, v185
v_mul_f32 v138, v138, v186
v_mul_f32 v139, v139, v187
v_mul_f32 v140, v140, v188
v_mul_f32 v141, v141, v189
s_waitcnt lgkmcnt(6)
v_mfma_f32_32x32x16_bf16 v[160:175], v[92:95], v[208:211], v[160:175]
ds_read_b64_tr_b16 v[204:205], v13 offset:40960
ds_read_b64_tr_b16 v[206:207], v13 offset:41472
v_mul_f32 v142, v142, v190
v_mul_f32 v143, v143, v191
v_cvt_pk_bf16_f32 v212, v128, v129
v_cvt_pk_bf16_f32 v213, v130, v131
v_cvt_pk_bf16_f32 v214, v132, v133
s_waitcnt lgkmcnt(6)
v_mfma_f32_32x32x16_bf16 v[160:175], v[96:99], v[192:195], v[160:175]
ds_read_b64_tr_b16 v[208:209], v10 offset:49152
ds_read_b64_tr_b16 v[210:211], v10 offset:49664
v_cvt_pk_bf16_f32 v215, v134, v135
v_cvt_pk_bf16_f32 v216, v136, v137
v_cvt_pk_bf16_f32 v217, v138, v139
v_cvt_pk_bf16_f32 v218, v140, v141
v_cvt_pk_bf16_f32 v219, v142, v143
v_mfma_f32_16x16x32_bf16 v[220:223], v[232:235], v[192:195], v[220:223]
s_waitcnt lgkmcnt(6)
v_mfma_f32_32x32x16_bf16 v[160:175], v[100:103], v[196:199], v[160:175]
ds_read_b64_tr_b16 v[192:193], v11 offset:49152
ds_read_b64_tr_b16 v[194:195], v11 offset:49664
buffer_store_dwordx4 v[212:215], v252, s[24:27], s47 offen sc1
s_add_u32 s47, s47, 14336
buffer_store_dwordx4 v[216:219], v252, s[24:27], s47 offen sc1
v_mul_f32 v144, v144, v176
v_mul_f32 v145, v145, v177
v_mul_f32 v146, v146, v178
s_waitcnt lgkmcnt(6)
v_mfma_f32_32x32x16_bf16 v[160:175], v[104:107], v[200:203], v[160:175]
ds_read_b64_tr_b16 v[196:197], v12 offset:49152
ds_read_b64_tr_b16 v[198:199], v12 offset:49664
v_mul_f32 v147, v147, v179
v_mul_f32 v148, v148, v180
v_mul_f32 v149, v149, v181
v_mul_f32 v150, v150, v182
s_waitcnt lgkmcnt(6)
v_mfma_f32_32x32x16_bf16 v[160:175], v[108:111], v[204:207], v[160:175]
ds_read_b64_tr_b16 v[200:201], v13 offset:49152
ds_read_b64_tr_b16 v[202:203], v13 offset:49664
v_mul_f32 v151, v151, v183
v_mul_f32 v152, v152, v184
v_mul_f32 v153, v153, v185
v_mul_f32 v154, v154, v186
s_waitcnt lgkmcnt(6)
v_mfma_f32_32x32x16_bf16 v[160:175], v[112:115], v[208:211], v[160:175]
v_mul_f32 v155, v155, v187
v_mul_f32 v156, v156, v188
v_mul_f32 v157, v157, v189
v_mul_f32 v158, v158, v190
v_mfma_f32_16x16x32_bf16 v[220:223], v[232:235], v[208:211], v[220:223]
s_waitcnt lgkmcnt(4)
v_mfma_f32_32x32x16_bf16 v[160:175], v[116:119], v[192:195], v[160:175]
v_mul_f32 v159, v159, v191
v_cvt_pk_bf16_f32 v212, v144, v145
v_cvt_pk_bf16_f32 v213, v146, v147
v_cvt_pk_bf16_f32 v214, v148, v149
s_waitcnt lgkmcnt(2)
v_mfma_f32_32x32x16_bf16 v[160:175], v[120:123], v[196:199], v[160:175]
v_cvt_pk_bf16_f32 v215, v150, v151
v_cvt_pk_bf16_f32 v216, v152, v153
v_cvt_pk_bf16_f32 v217, v154, v155
v_cvt_pk_bf16_f32 v218, v156, v157
s_waitcnt lgkmcnt(0)
v_mfma_f32_32x32x16_bf16 v[160:175], v[124:127], v[200:203], v[160:175]
v_cvt_pk_bf16_f32 v219, v158, v159
buffer_store_dwordx4 v[212:215], v252, s[24:27], s48 offen sc1
s_add_u32 s48, s48, 14336
buffer_store_dwordx4 v[216:219], v252, s[24:27], s48 offen sc1
v_mov_b32 v227, 1
ds_write_b32 v254, v220
s_waitcnt vmcnt(4)
s_waitcnt lgkmcnt(0)
s_barrier
s_cmp_eq_u32 s32, 0
s_cbranch_scc0 P1_C_CH1
ds_read_b128 v[248:251], v15 offset:0
s_waitcnt lgkmcnt(0)
v_add_f32 v248, v248, v249
v_add_f32 v250, v250, v251
v_add_f32 v248, v248, v250
v_and_b32 v249, 0xffff0000, v248
v_sub_f32 v248, v248, v249
v_cvt_pk_bf16_f32 v240, v249, v248
s_nop 1
v_mfma_f32_32x32x16_bf16 v[160:175], v[236:239], v[240:243], v[160:175]
s_nop 11
v_mul_f32 v160, v160, v176
v_mul_f32 v161, v161, v177
v_mul_f32 v162, v162, v178
v_mul_f32 v163, v163, v179
v_mul_f32 v164, v164, v180
v_mul_f32 v165, v165, v181
v_mul_f32 v166, v166, v182
v_mul_f32 v167, v167, v183
v_mul_f32 v168, v168, v184
v_mul_f32 v169, v169, v185
v_mul_f32 v170, v170, v186
v_mul_f32 v171, v171, v187
v_mul_f32 v172, v172, v188
v_mul_f32 v173, v173, v189
v_mul_f32 v174, v174, v190
v_mul_f32 v175, v175, v191
v_cvt_pk_bf16_f32 v212, v160, v161
v_cvt_pk_bf16_f32 v213, v162, v163
v_cvt_pk_bf16_f32 v214, v164, v165
v_cvt_pk_bf16_f32 v215, v166, v167
v_cvt_pk_bf16_f32 v216, v168, v169
v_cvt_pk_bf16_f32 v217, v170, v171
v_cvt_pk_bf16_f32 v218, v172, v173
v_cvt_pk_bf16_f32 v219, v174, v175
buffer_store_dwordx4 v[212:215], v252, s[24:27], s49 offen sc1
s_add_u32 s49, s49, 14336
buffer_store_dwordx4 v[216:219], v252, s[24:27], s49 offen sc1
s_barrier
s_branch P1_C_J
P1_C_CH1:
v_add_u32 v10, 57344, v10
v_xor_b32 v10, s36, v10
v_add_u32 v11, 57344, v11
v_xor_b32 v11, s36, v11
v_add_u32 v12, 57344, v12
v_xor_b32 v12, s36, v12
v_add_u32 v13, 57344, v13
v_xor_b32 v13, s36, v13
ds_read_b64_tr_b16 v[192:193], v10 offset:0
ds_read_b64_tr_b16 v[194:195], v10 offset:512
ds_read_b64_tr_b16 v[196:197], v11 offset:0
ds_read_b64_tr_b16 v[198:199], v11 offset:512
ds_read_b64_tr_b16 v[200:201], v12 offset:0
ds_read_b64_tr_b16 v[202:203], v12 offset:512
ds_read_b64_tr_b16 v[204:205], v13 offset:0
ds_read_b64_tr_b16 v[206:207], v13 offset:512
s_waitcnt lgkmcnt(6)
v_mfma_f32_32x32x16_bf16 v[128:143], v[16:19], v[192:195], 0
ds_read_b64_tr_b16 v[208:209], v10 offset:8192
ds_read_b64_tr_b16 v[210:211], v10 offset:8704
ds_read_b128 v[248:251], v15 offset:0
v_mfma_f32_16x16x32_bf16 v[220:223], v[232:235], v[192:195], 0
s_waitcnt lgkmcnt(7)
v_mfma_f32_32x32x16_bf16 v[128:143], v[20:23], v[196:199], v[128:143]
ds_read_b64_tr_b16 v[192:193], v11 offset:8192
ds_read_b64_tr_b16 v[194:195], v11 offset:8704
s_waitcnt lgkmcnt(2)
v_add_f32 v248, v248, v249
v_add_f32 v250, v250, v251
v_mfma_f32_32x32x16_bf16 v[128:143], v[24:27], v[200:203], v[128:143]
ds_read_b64_tr_b16 v[196:197], v12 offset:8192
ds_read_b64_tr_b16 v[198:199], v12 offset:8704
v_add_f32 v248, v248, v250
v_and_b32 v249, 0xffff0000, v248
v_sub_f32 v248, v248, v249
v_mfma_f32_32x32x16_bf16 v[128:143], v[28:31], v[204:207], v[128:143]
ds_read_b64_tr_b16 v[200:201], v13 offset:8192
ds_read_b64_tr_b16 v[202:203], v13 offset:8704
v_cvt_pk_bf16_f32 v240, v249, v248
s_nop 1
v_mfma_f32_32x32x16_bf16 v[160:175], v[236:239], v[240:243], v[160:175]
v_mfma_f32_32x32x16_bf16 v[128:143], v[32:35], v[208:211], v[128:143]
ds_read_b64_tr_b16 v[204:205], v10 offset:16384
ds_read_b64_tr_b16 v[206:207], v10 offset:16896
v_mfma_f32_16x16x32_bf16 v[220:223], v[232:235], v[208:211], v[220:223]
s_waitcnt lgkmcnt(6)
v_mfma_f32_32x32x16_bf16 v[128:143], v[36:39], v[192:195], v[128:143]
ds_read_b64_tr_b16 v[208:209], v11 offset:16384
ds_read_b64_tr_b16 v[210:211], v11 offset:16896
s_waitcnt lgkmcnt(6)
v_mfma_f32_32x32x16_bf16 v[128:143], v[40:43], v[196:199], v[128:143]
ds_read_b64_tr_b16 v[192:193], v12 offset:16384
ds_read_b64_tr_b16 v[194:195], v12 offset:16896
s_waitcnt lgkmcnt(6)
v_mfma_f32_32x32x16_bf16 v[128:143], v[44:47], v[200:203], v[128:143]
ds_read_b64_tr_b16 v[196:197], v13 offset:16384
ds_read_b64_tr_b16 v[198:199], v13 offset:16896
v_mul_f32 v160, v160, v176
v_mul_f32 v161, v161, v177
v_mul_f32 v162, v162, v178
s_waitcnt lgkmcnt(6)
v_mfma_f32_32x32x16_bf16 v[128:143], v[48:51], v[204:207], v[128:143]
ds_read_b64_tr_b16 v[200:201], v10 offset:24576
ds_read_b64_tr_b16 v[202:203], v10 offset:25088
v_mul_f32 v163, v163, v179
v_mul_f32 v164, v164, v180
v_mul_f32 v165, v165, v181
v_mfma_f32_16x16x32_bf16 v[220:223], v[232:235], v[204:207], v[220:223]
s_waitcnt lgkmcnt(6)
v_mfma_f32_32x32x16_bf16 v[128:143], v[52:55], v[208:211], v[128:143]
ds_read_b64_tr_b16 v[204:205], v11 offset:24576
ds_read_b64_tr_b16 v[206:207], v11 offset:25088
v_mul_f32 v166, v166, v182
v_mul_f32 v167, v167, v183
v_mul_f32 v168, v168, v184
s_waitcnt lgkmcnt(6)
v_mfma_f32_32x32x16_bf16 v[128:143], v[56:59], v[192:195], v[128:143]
ds_read_b64_tr_b16 v[208:209], v12 offset:24576
ds_read_b64_tr_b16 v[210:211], v12 offset:25088
v_mul_f32 v169, v169, v185
v_mul_f32 v170, v170, v186
v_mul_f32 v171, v171, v187
s_waitcnt lgkmcnt(6)
v_mfma_f32_32x32x16_bf16 v[128:143], v[60:63], v[196:199], v[128:143]
ds_read_b64_tr_b16 v[192:193], v13 offset:24576
ds_read_b64_tr_b16 v[194:195], v13 offset:25088
v_mul_f32 v172, v172, v188
v_mul_f32 v173, v173, v189
v_mul_f32 v174, v174, v190
s_waitcnt lgkmcnt(6)
v_mfma_f32_32x32x16_bf16 v[128:143], v[64:67], v[200:203], v[128:143]
ds_read_b64_tr_b16 v[196:197], v10 offset:32768
ds_read_b64_tr_b16 v[198:199], v10 offset:33280
v_mul_f32 v175, v175, v191
v_cvt_pk_bf16_f32 v212, v160, v161
v_cvt_pk_bf16_f32 v213, v162, v163
v_mfma_f32_16x16x32_bf16 v[220:223], v[232:235], v[200:203], v[220:223]
s_waitcnt lgkmcnt(6)
v_mfma_f32_32x32x16_bf16 v[128:143], v[68:71], v[204:207], v[128:143]
ds_read_b64_tr_b16 v[200:201], v11 offset:32768
ds_read_b64_tr_b16 v[202:203], v11 offset:33280
v_cvt_pk_bf16_f32 v214, v164, v165
v_cvt_pk_bf16_f32 v215, v166, v167
v_cvt_pk_bf16_f32 v216, v168, v169
s_waitcnt lgkmcnt(6)
v_mfma_f32_32x32x16_bf16 v[128:143], v[72:75], v[208:211], v[128:143]
ds_read_b64_tr_b16 v[204:205], v12 offset:32768
ds_read_b64_tr_b16 v[206:207], v12 offset:33280
v_cvt_pk_bf16_f32 v217, v170, v171
v_cvt_pk_bf16_f32 v218, v172, v173
v_cvt_pk_bf16_f32 v219, v174, v175
s_waitcnt lgkmcnt(6)
v_mfma_f32_32x32x16_bf16 v[128:143], v[76:79], v[192:195], v[128:143]
ds_read_b64_tr_b16 v[208:209], v13 offset:32768
ds_read_b64_tr_b16 v[210:211], v13 offset:33280
buffer_store_dwordx4 v[212:215], v252, s[24:27], s49 offen sc1
s_add_u32 s49, s49, 14336
buffer_store_dwordx4 v[216:219], v252, s[24:27], s49 offen sc1
s_waitcnt lgkmcnt(6)
v_mfma_f32_32x32x16_bf16 v[128:143], v[80:83], v[196:199], v[128:143]
ds_read_b64_tr_b16 v[192:193], v10 offset:40960
ds_read_b64_tr_b16 v[194:195], v10 offset:41472
v_mfma_f32_16x16x32_bf16 v[220:223], v[232:235], v[196:199], v[220:223]
s_waitcnt lgkmcnt(6)
v_mfma_f32_32x32x16_bf16 v[128:143], v[84:87], v[200:203], v[128:143]
ds_read_b64_tr_b16 v[196:197], v11 offset:40960
ds_read_b64_tr_b16 v[198:199], v11 offset:41472
s_waitcnt lgkmcnt(6)
v_mfma_f32_32x32x16_bf16 v[128:143], v[88:91], v[204:207], v[128:143]
ds_read_b64_tr_b16 v[200:201], v12 offset:40960
ds_read_b64_tr_b16 v[202:203], v12 offset:41472
s_waitcnt lgkmcnt(6)
v_mfma_f32_32x32x16_bf16 v[128:143], v[92:95], v[208:211], v[128:143]
ds_read_b64_tr_b16 v[204:205], v13 offset:40960
ds_read_b64_tr_b16 v[206:207], v13 offset:41472
s_waitcnt lgkmcnt(6)
v_mfma_f32_32x32x16_bf16 v[128:143], v[96:99], v[192:195], v[128:143]
ds_read_b64_tr_b16 v[208:209], v10 offset:49152
ds_read_b64_tr_b16 v[210:211], v10 offset:49664
v_mfma_f32_16x16x32_bf16 v[220:223], v[232:235], v[192:195], v[220:223]
s_waitcnt lgkmcnt(6)
v_mfma_f32_32x32x16_bf16 v[128:143], v[100:103], v[196:199], v[128:143]
ds_read_b64_tr_b16 v[192:193], v11 offset:49152
ds_read_b64_tr_b16 v[194:195], v11 offset:49664
s_waitcnt lgkmcnt(6)
v_mfma_f32_32x32x16_bf16 v[128:143], v[104:107], v[200:203], v[128:143]
ds_read_b64_tr_b16 v[196:197], v12 offset:49152
ds_read_b64_tr_b16 v[198:199], v12 offset:49664
s_waitcnt lgkmcnt(6)
v_mfma_f32_32x32x16_bf16 v[128:143], v[108:111], v[204:207], v[128:143]
ds_read_b64_tr_b16 v[200:201], v13 offset:49152
ds_read_b64_tr_b16 v[202:203], v13 offset:49664
s_waitcnt lgkmcnt(6)
v_mfma_f32_32x32x16_bf16 v[128:143], v[112:115], v[208:211], v[128:143]
v_mfma_f32_16x16x32_bf16 v[220:223], v[232:235], v[208:211], v[220:223]
s_waitcnt lgkmcnt(4)
v_mfma_f32_32x32x16_bf16 v[128:143], v[116:119], v[192:195], v[128:143]
s_waitcnt lgkmcnt(2)
v_mfma_f32_32x32x16_bf16 v[128:143], v[120:123], v[196:199], v[128:143]
s_waitcnt lgkmcnt(0)
v_mfma_f32_32x32x16_bf16 v[128:143], v[124:127], v[200:203], v[128:143]
ds_write_b32 v254, v220 offset:2048
s_waitcnt lgkmcnt(0)
s_barrier
ds_read_b128 v[248:251], v15 offset:2048
s_waitcnt lgkmcnt(0)
v_add_f32 v248, v248, v249
v_add_f32 v250, v250, v251
v_add_f32 v248, v248, v250
v_and_b32 v249, 0xffff0000, v248
v_sub_f32 v248, v248, v249
v_cvt_pk_bf16_f32 v240, v249, v248
s_nop 1
v_mfma_f32_32x32x16_bf16 v[128:143], v[236:239], v[240:243], v[128:143]
s_nop 11
v_mul_f32 v128, v128, v176
v_mul_f32 v129, v129, v177
v_mul_f32 v130, v130, v178
v_mul_f32 v131, v131, v179
v_mul_f32 v132, v132, v180
v_mul_f32 v133, v133, v181
v_mul_f32 v134, v134, v182
v_mul_f32 v135, v135, v183
v_mul_f32 v136, v136, v184
v_mul_f32 v137, v137, v185
v_mul_f32 v138, v138, v186
v_mul_f32 v139, v139, v187
v_mul_f32 v140, v140, v188
v_mul_f32 v141, v141, v189
v_mul_f32 v142, v142, v190
v_mul_f32 v143, v143, v191
v_cvt_pk_bf16_f32 v212, v128, v129
v_cvt_pk_bf16_f32 v213, v130, v131
v_cvt_pk_bf16_f32 v214, v132, v133
v_cvt_pk_bf16_f32 v215, v134, v135
v_cvt_pk_bf16_f32 v216, v136, v137
v_cvt_pk_bf16_f32 v217, v138, v139
v_cvt_pk_bf16_f32 v218, v140, v141
v_cvt_pk_bf16_f32 v219, v142, v143
buffer_store_dwordx4 v[212:215], v252, s[24:27], s50 offen sc1
s_add_u32 s50, s50, 14336
buffer_store_dwordx4 v[216:219], v252, s[24:27], s50 offen sc1
P1_C_J:
P1_C_CR:
v_cmp_eq_u32 vcc, 0, v2
s_and_b64 vcc, vcc, s[40:41]
s_cbranch_vccnz P1_C_CW
P1_C_CX:
s_and_b32 s33, s2, 7
s_lshl_b32 s28, s33, 1
s_bfe_u32 s33, s2, 0x10003
s_add_u32 s28, s28, s33
s_bfe_u32 s29, s2, 0x10004
s_lshl_b32 s36, s29, 3
s_add_u32 s41, s36, s30
v_lshlrev_b32 v2, 7, v1
v_mov_b32 v3, 1
s_waitcnt vmcnt(0)
s_barrier
s_cmp_eq_u32 s30, 0
s_cselect_b64 exec, 0xff, 0
buffer_store_dword v3, v2, s[24:27], s11 offen sc1
s_mov_b32 s20, s76
s_and_b32 s21, s77, 0xffff
s_mov_b32 s22, 4096
s_mov_b32 s23, 0x20000
s_cmp_eq_u32 s30, 0
s_cselect_b64 exec, -1, 0
buffer_load_dword v220, v2, s[20:23], 0 offen
s_mov_b64 exec, -1
s_and_b32 s33, s2, 7
s_lshl_b32 s33, s33, 7
s_lshl_b32 s44, s41, 11
s_add_u32 s44, s44, s33
s_add_u32 s36, s44, 15728696
s_mul_i32 s33, s28, 7
s_lshr_b32 s33, s33, 4
s_lshl_b32 s33, s33, 2
s_add_u32 s44, s44, s33
s_add_u32 s44, s44, 15728640
s_add_u32 s35, s44, 28
s_mul_i32 s34, s41, 114688
s_mul_i32 s33, s28, 896
s_add_u32 s34, s34, s33
s_add_u32 s62, s34, 10485760
s_add_u32 s34, s34, 12582912
A_V_R:
s_buffer_load_dwordx2 s[56:57], s[24:27], s36 glc
s_waitcnt lgkmcnt(0)
s_and_b32 s56, s56, s57
s_cbranch_scc1 A_V_X
s_sleep 4
s_addk_i32 s53, -1
s_cmp_lt_i32 s53, 0
s_cbranch_scc0 A_V_R
A_V_X:
buffer_load_dwordx4 v[20:23], v252, s[24:27], s34 offen
s_add_u32 s34, s34, 14336
buffer_load_dwordx4 v[28:31], v252, s[24:27], s34 offen
s_add_u32 s34, s34, 14336
buffer_load_dwordx4 v[36:39], v252, s[24:27], s34 offen
s_add_u32 s34, s34, 14336
buffer_load_dwordx4 v[44:47], v252, s[24:27], s34 offen
s_add_u32 s34, s34, 14336
buffer_load_dwordx4 v[52:55], v252, s[24:27], s34 offen
s_add_u32 s34, s34, 14336
buffer_load_dwordx4 v[60:63], v252, s[24:27], s34 offen
s_add_u32 s34, s34, 14336
buffer_load_dwordx4 v[68:71], v252, s[24:27], s34 offen
s_add_u32 s34, s34, 14336
buffer_load_dwordx4 v[76:79], v252, s[24:27], s34 offen
s_add_u32 s34, s34, 14336
A_K_R:
s_buffer_load_dwordx2 s[56:57], s[24:27], s35 glc
s_waitcnt lgkmcnt(0)
s_and_b32 s56, s56, s57
s_cbranch_scc1 A_K_X
s_sleep 4
s_addk_i32 s53, -1
s_cmp_lt_i32 s53, 0
s_cbranch_scc0 A_K_R
A_K_X:
buffer_load_dwordx4 v[16:19], v252, s[24:27], s62 offen
s_add_u32 s62, s62, 14336
buffer_load_dwordx4 v[24:27], v252, s[24:27], s62 offen
s_add_u32 s62, s62, 14336
buffer_load_dwordx4 v[32:35], v252, s[24:27], s62 offen
s_add_u32 s62, s62, 14336
buffer_load_dwordx4 v[40:43], v252, s[24:27], s62 offen
s_add_u32 s62, s62, 14336
buffer_load_dwordx4 v[48:51], v252, s[24:27], s62 offen
s_add_u32 s62, s62, 14336
buffer_load_dwordx4 v[56:59], v252, s[24:27], s62 offen
s_add_u32 s62, s62, 14336
buffer_load_dwordx4 v[64:67], v252, s[24:27], s62 offen
s_add_u32 s62, s62, 14336
buffer_load_dwordx4 v[72:75], v252, s[24:27], s62 offen
s_add_u32 s62, s62, 14336
v_mov_b32 v208, 0x3f803f80
v_mov_b32 v209, 0x3f803f80
v_mov_b32 v210, 0x3f803f80
v_mov_b32 v211, 0x3f803f80
s_waitcnt vmcnt(7)
v_mfma_f32_32x32x16_bf16 v[176:191], v[16:19], v[20:23], 0
v_mfma_f32_32x32x16_bf16 v[192:207], v[16:19], v[208:211], 0
s_waitcnt vmcnt(6)
v_mfma_f32_32x32x16_bf16 v[176:191], v[24:27], v[28:31], v[176:191]
v_mfma_f32_32x32x16_bf16 v[192:207], v[24:27], v[208:211], v[192:207]
s_waitcnt vmcnt(5)
v_mfma_f32_32x32x16_bf16 v[176:191], v[32:35], v[36:39], v[176:191]
v_mfma_f32_32x32x16_bf16 v[192:207], v[32:35], v[208:211], v[192:207]
s_waitcnt vmcnt(4)
v_mfma_f32_32x32x16_bf16 v[176:191], v[40:43], v[44:47], v[176:191]
v_mfma_f32_32x32x16_bf16 v[192:207], v[40:43], v[208:211], v[192:207]
s_waitcnt vmcnt(3)
v_mfma_f32_32x32x16_bf16 v[176:191], v[48:51], v[52:55], v[176:191]
v_mfma_f32_32x32x16_bf16 v[192:207], v[48:51], v[208:211], v[192:207]
s_waitcnt vmcnt(2)
v_mfma_f32_32x32x16_bf16 v[176:191], v[56:59], v[60:63], v[176:191]
v_mfma_f32_32x32x16_bf16 v[192:207], v[56:59], v[208:211], v[192:207]
s_waitcnt vmcnt(1)
v_mfma_f32_32x32x16_bf16 v[176:191], v[64:67], v[68:71], v[176:191]
v_mfma_f32_32x32x16_bf16 v[192:207], v[64:67], v[208:211], v[192:207]
s_waitcnt vmcnt(0)
v_mfma_f32_32x32x16_bf16 v[176:191], v[72:75], v[76:79], v[176:191]
v_mfma_f32_32x32x16_bf16 v[192:207], v[72:75], v[208:211], v[192:207]
A_Q_R:
s_buffer_load_dwordx2 s[56:57], s[24:27], s44 glc
s_waitcnt lgkmcnt(0)
s_and_b32 s56, s56, s57
s_cbranch_scc1 A_Q_X
s_sleep 4
s_addk_i32 s53, -1
s_cmp_lt_i32 s53, 0
s_cbranch_scc0 A_Q_R
A_Q_X:
v_and_b32 v5, 0xff, v253
s_mul_i32 s34, s41, 114688
s_mul_i32 s35, s28, 1792
s_add_u32 s34, s34, s35
s_add_u32 s34, s34, 8388608
s_lshl_b32 s43, s41, 8
s_lshl_b32 s36, s28, 2
s_add_u32 s11, s43, s36
s_add_u32 s11, s11, 15777792
s_mul_i32 s41, s41, 589824
s_lshl_b32 s36, s28, 11
s_add_u32 s41, s41, s36
s_add_u32 s41, s41, 16777216
buffer_load_dwordx2 v[144:145], v253, s[24:27], s34 offen offset:0
buffer_load_dwordx2 v[146:147], v253, s[24:27], s34 offen offset:512
buffer_load_dwordx2 v[148:149], v253, s[24:27], s34 offen offset:1024
buffer_load_dwordx2 v[150:151], v5, s[24:27], s34 offen offset:1536
s_add_u32 s34, s34, 28672
buffer_load_dwordx2 v[152:153], v253, s[24:27], s34 offen offset:0
buffer_load_dwordx2 v[154:155], v253, s[24:27], s34 offen offset:512
buffer_load_dwordx2 v[156:157], v253, s[24:27], s34 offen offset:1024
buffer_load_dwordx2 v[158:159], v5, s[24:27], s34 offen offset:1536
s_add_u32 s34, s34, 28672
buffer_load_dwordx2 v[160:161], v253, s[24:27], s34 offen offset:0
buffer_load_dwordx2 v[162:163], v253, s[24:27], s34 offen offset:512
buffer_load_dwordx2 v[164:165], v253, s[24:27], s34 offen offset:1024
buffer_load_dwordx2 v[166:167], v5, s[24:27], s34 offen offset:1536
s_add_u32 s34, s34, 28672
buffer_load_dwordx2 v[168:169], v253, s[24:27], s34 offen offset:0
buffer_load_dwordx2 v[170:171], v253, s[24:27], s34 offen offset:512
buffer_load_dwordx2 v[172:173], v253, s[24:27], s34 offen offset:1024
buffer_load_dwordx2 v[174:175], v5, s[24:27], s34 offen offset:1536
s_add_u32 s34, s34, 28672
s_mov_b32 s42, 0x10000000
s_mov_b32 s43, 0x10000000
s_mov_b32 s44, -1
s_mov_b32 s45, 0
s_lshl_b32 s34, s30, 12
v_add_u32 v4, s34, v253
s_nop 10
v_cndmask_b32 v176, v176, v192, s[42:43]
v_cndmask_b32 v177, v177, v193, s[42:43]
v_cndmask_b32 v178, v178, v194, s[42:43]
v_cndmask_b32 v179, v179, v195, s[42:43]
v_cndmask_b32 v180, v180, v196, s[42:43]
v_cndmask_b32 v181, v181, v197, s[42:43]
v_cndmask_b32 v182, v182, v198, s[42:43]
v_cndmask_b32 v183, v183, v199, s[42:43]
v_cndmask_b32 v184, v184, v200, s[42:43]
v_cndmask_b32 v185, v185, v201, s[42:43]
v_cndmask_b32 v186, v186, v202, s[42:43]
v_cndmask_b32 v187, v187, v203, s[42:43]
v_cndmask_b32 v188, v188, v204, s[42:43]
v_cndmask_b32 v189, v189, v205, s[42:43]
v_cndmask_b32 v190, v190, v206, s[42:43]
v_cndmask_b32 v191, v191, v207, s[42:43]
ds_write_b64 v4, v[176:177] offset:0
ds_write_b64 v4, v[178:179] offset:512
ds_write_b64 v4, v[180:181] offset:1024
ds_write_b64 v4, v[182:183] offset:1536
ds_write_b64 v4, v[184:185] offset:2048
ds_write_b64 v4, v[186:187] offset:2560
ds_write_b64 v4, v[188:189] offset:3072
ds_write_b64 v4, v[190:191] offset:3584
s_lshl_b32 s34, s30, 9
v_add_u32 v4, s34, v253
s_waitcnt lgkmcnt(0)
s_barrier
ds_read_b64 v[176:177], v4 offset:0
ds_read_b64 v[178:179], v4 offset:4096
ds_read_b64 v[180:181], v4 offset:8192
ds_read_b64 v[182:183], v4 offset:12288
ds_read_b64 v[184:185], v4 offset:16384
ds_read_b64 v[186:187], v4 offset:20480
ds_read_b64 v[188:189], v4 offset:24576
ds_read_b64 v[190:191], v4 offset:28672
s_cmp_ge_u32 s30, 6
s_mov_b32 s42, 0x1fffffff
s_cselect_b32 s43, 0, s42
s_lshl_b32 s35, s28, 1
s_add_u32 s35, s35, s29
s_lshl_b32 s35, s35, 3
s_add_u32 s35, s35, s30
s_lshl_b32 s35, s35, 9
s_add_u32 s35, s35, 14942208
s_xor_b32 s36, s35, 4096
s_lshl_b32 s34, s30, 2
s_add_u32 s34, s34, 32768
v_lshl_add_u32 v4, v1, 5, s34
s_waitcnt lgkmcnt(0)
v_pk_add_f32 v[176:177], v[176:177], v[184:185]
v_pk_add_f32 v[178:179], v[178:179], v[186:187]
v_pk_add_f32 v[180:181], v[180:181], v[188:189]
v_pk_add_f32 v[182:183], v[182:183], v[190:191]
v_pk_add_f32 v[176:177], v[176:177], v[180:181]
v_pk_add_f32 v[178:179], v[178:179], v[182:183]
v_pk_add_f32 v[176:177], v[176:177], v[178:179]
v_cndmask_b32 v176, 0, v176, s[42:43]
v_cndmask_b32 v177, 0, v177, s[42:43]
buffer_store_dwordx2 v[176:177], v253, s[24:27], s35 offen sc1
buffer_load_dwordx2 v[178:179], v253, s[24:27], s36 offen sc1
s_lshl_b32 s35, s29, 3
s_add_u32 s35, s35, s30
s_lshl_b32 s35, s35, 0
s_lshl_b32 s34, s28, 4
s_add_u32 s35, s35, s34
s_lshl_b32 s35, s35, 2
s_add_u32 s35, s35, 15794176
s_mov_b64 exec, 1
s_waitcnt vmcnt(2)
buffer_store_dword v3, v2, s[24:27], s35 offen sc1
s_mov_b64 exec, -1
s_waitcnt vmcnt(1)
s_branch A_X_C
A_X_R:
buffer_load_dwordx2 v[178:179], v253, s[24:27], s36 offen sc1
s_waitcnt vmcnt(0)
A_X_C:
v_max_u32 v180, v178, v179
v_cmp_eq_u32 vcc, -1, v180
s_cbranch_vccz A_X_X
s_sleep 4
s_addk_i32 s53, -1
s_cmp_lt_i32 s53, 0
s_cbranch_scc0 A_X_R
A_X_X:
v_pk_add_f32 v[176:177], v[176:177], v[178:179]
v_cvt_pk_bf16_f32 v176, v176, v177
ds_write_b32 v4, v176
v_lshlrev_b32 v4, 5, v1
s_waitcnt lgkmcnt(0)
s_barrier
ds_read_b128 v[212:215], v4 offset:32768
ds_read_b128 v[216:219], v4 offset:32784
s_waitcnt lgkmcnt(0)
v_mfma_f32_32x32x16_bf16 v[16:31], v[212:215], v[144:147], 0
v_mfma_f32_32x32x16_bf16 v[16:31], v[216:219], v[148:151], v[16:31]
v_mfma_f32_32x32x16_bf16 v[32:47], v[212:215], v[152:155], 0
v_mfma_f32_32x32x16_bf16 v[32:47], v[216:219], v[156:159], v[32:47]
v_mfma_f32_32x32x16_bf16 v[48:63], v[212:215], v[160:163], 0
v_mfma_f32_32x32x16_bf16 v[48:63], v[216:219], v[164:167], v[48:63]
v_mfma_f32_32x32x16_bf16 v[64:79], v[212:215], v[168:171], 0
v_mfma_f32_32x32x16_bf16 v[64:79], v[216:219], v[172:175], v[64:79]
s_nop 5
v_add_f32 v220, 0x358637bd, v28
v_mov_b32 v221, v220
s_nop 1
v_permlane32_swap_b32 v221, v220
v_rcp_f32 v220, v220
s_nop 0
v_mul_f32 v16, v16, v220
v_mul_f32 v17, v17, v220
v_mul_f32 v18, v18, v220
v_mul_f32 v19, v19, v220
v_mul_f32 v20, v20, v220
v_mul_f32 v21, v21, v220
v_mul_f32 v22, v22, v220
v_mul_f32 v23, v23, v220
v_mul_f32 v24, v24, v220
v_mul_f32 v25, v25, v220
v_mul_f32 v26, v26, v220
v_mul_f32 v27, v27, v220
v_mul_f32 v28, v28, v220
v_mul_f32 v29, v29, v220
v_mul_f32 v30, v30, v220
v_mul_f32 v31, v31, v220
v_cvt_pk_bf16_f32 v80, v16, v17
v_cvt_pk_bf16_f32 v81, v18, v19
v_cvt_pk_bf16_f32 v82, v20, v21
v_cvt_pk_bf16_f32 v83, v22, v23
v_cvt_pk_bf16_f32 v84, v24, v25
v_cvt_pk_bf16_f32 v85, v26, v27
v_cvt_pk_bf16_f32 v86, v28, v29
v_cvt_pk_bf16_f32 v87, v30, v31
v_cndmask_b32 v86, 0, v86, s[44:45]
v_cndmask_b32 v87, 0, v87, s[44:45]
buffer_store_dwordx4 v[80:83], v14, s[24:27], s41 offen sc1
buffer_store_dwordx4 v[84:87], v14, s[24:27], s41 offen offset:1024 sc1
s_add_u32 s41, s41, 147456
v_add_f32 v220, 0x358637bd, v44
v_mov_b32 v221, v220
s_nop 1
v_permlane32_swap_b32 v221, v220
v_rcp_f32 v220, v220
s_nop 0
v_mul_f32 v32, v32, v220
v_mul_f32 v33, v33, v220
v_mul_f32 v34, v34, v220
v_mul_f32 v35, v35, v220
v_mul_f32 v36, v36, v220
v_mul_f32 v37, v37, v220
v_mul_f32 v38, v38, v220
v_mul_f32 v39, v39, v220
v_mul_f32 v40, v40, v220
v_mul_f32 v41, v41, v220
v_mul_f32 v42, v42, v220
v_mul_f32 v43, v43, v220
v_mul_f32 v44, v44, v220
v_mul_f32 v45, v45, v220
v_mul_f32 v46, v46, v220
v_mul_f32 v47, v47, v220
v_cvt_pk_bf16_f32 v88, v32, v33
v_cvt_pk_bf16_f32 v89, v34, v35
v_cvt_pk_bf16_f32 v90, v36, v37
v_cvt_pk_bf16_f32 v91, v38, v39
v_cvt_pk_bf16_f32 v92, v40, v41
v_cvt_pk_bf16_f32 v93, v42, v43
v_cvt_pk_bf16_f32 v94, v44, v45
v_cvt_pk_bf16_f32 v95, v46, v47
v_cndmask_b32 v94, 0, v94, s[44:45]
v_cndmask_b32 v95, 0, v95, s[44:45]
buffer_store_dwordx4 v[88:91], v14, s[24:27], s41 offen sc1
buffer_store_dwordx4 v[92:95], v14, s[24:27], s41 offen offset:1024 sc1
s_add_u32 s41, s41, 147456
v_add_f32 v220, 0x358637bd, v60
v_mov_b32 v221, v220
s_nop 1
v_permlane32_swap_b32 v221, v220
v_rcp_f32 v220, v220
s_nop 0
v_mul_f32 v48, v48, v220
v_mul_f32 v49, v49, v220
v_mul_f32 v50, v50, v220
v_mul_f32 v51, v51, v220
v_mul_f32 v52, v52, v220
v_mul_f32 v53, v53, v220
v_mul_f32 v54, v54, v220
v_mul_f32 v55, v55, v220
v_mul_f32 v56, v56, v220
v_mul_f32 v57, v57, v220
v_mul_f32 v58, v58, v220
v_mul_f32 v59, v59, v220
v_mul_f32 v60, v60, v220
v_mul_f32 v61, v61, v220
v_mul_f32 v62, v62, v220
v_mul_f32 v63, v63, v220
v_cvt_pk_bf16_f32 v96, v48, v49
v_cvt_pk_bf16_f32 v97, v50, v51
v_cvt_pk_bf16_f32 v98, v52, v53
v_cvt_pk_bf16_f32 v99, v54, v55
v_cvt_pk_bf16_f32 v100, v56, v57
v_cvt_pk_bf16_f32 v101, v58, v59
v_cvt_pk_bf16_f32 v102, v60, v61
v_cvt_pk_bf16_f32 v103, v62, v63
v_cndmask_b32 v102, 0, v102, s[44:45]
v_cndmask_b32 v103, 0, v103, s[44:45]
buffer_store_dwordx4 v[96:99], v14, s[24:27], s41 offen sc1
buffer_store_dwordx4 v[100:103], v14, s[24:27], s41 offen offset:1024 sc1
s_add_u32 s41, s41, 147456
v_add_f32 v220, 0x358637bd, v76
v_mov_b32 v221, v220
s_nop 1
v_permlane32_swap_b32 v221, v220
v_rcp_f32 v220, v220
s_nop 0
v_mul_f32 v64, v64, v220
v_mul_f32 v65, v65, v220
v_mul_f32 v66, v66, v220
v_mul_f32 v67, v67, v220
v_mul_f32 v68, v68, v220
v_mul_f32 v69, v69, v220
v_mul_f32 v70, v70, v220
v_mul_f32 v71, v71, v220
v_mul_f32 v72, v72, v220
v_mul_f32 v73, v73, v220
v_mul_f32 v74, v74, v220
v_mul_f32 v75, v75, v220
v_mul_f32 v76, v76, v220
v_mul_f32 v77, v77, v220
v_mul_f32 v78, v78, v220
v_mul_f32 v79, v79, v220
v_cvt_pk_bf16_f32 v104, v64, v65
v_cvt_pk_bf16_f32 v105, v66, v67
v_cvt_pk_bf16_f32 v106, v68, v69
v_cvt_pk_bf16_f32 v107, v70, v71
v_cvt_pk_bf16_f32 v108, v72, v73
v_cvt_pk_bf16_f32 v109, v74, v75
v_cvt_pk_bf16_f32 v110, v76, v77
v_cvt_pk_bf16_f32 v111, v78, v79
v_cndmask_b32 v110, 0, v110, s[44:45]
v_cndmask_b32 v111, 0, v111, s[44:45]
buffer_store_dwordx4 v[104:107], v14, s[24:27], s41 offen sc1
buffer_store_dwordx4 v[108:111], v14, s[24:27], s41 offen offset:1024 sc1
s_add_u32 s41, s41, 147456
v_mov_b32 v220, 1
v_lshlrev_b32 v221, 7, v1
s_mov_b64 exec, 3
s_waitcnt vmcnt(0)
buffer_store_dword v220, v221, s[24:27], s11 offen sc1
s_endpgm
P1_C_CW:
s_addk_i32 s53, -1
s_cmp_lt_i32 s53, 0
s_cbranch_scc1 P1_C_CX
v_lshrrev_b32 v2, 1, v253
buffer_load_dword v2, v2, s[4:7], 0 offen sc1
s_waitcnt vmcnt(0)
s_branch P1_C_CR
K_EXIT:
s_endpgm
.section .rodata,"a"
.p2align 6
.amdhsa_kernel parallel_sum__linear_attn_block__mixer_gmlp__prompt_kernel
  .amdhsa_next_free_vgpr 256
  .amdhsa_next_free_sgpr 100
  .amdhsa_accum_offset 256
  .amdhsa_group_segment_fixed_size 0
  .amdhsa_kernarg_size 88
  .amdhsa_user_sgpr_count 2
  .amdhsa_user_sgpr_kernarg_segment_ptr 1
  .amdhsa_system_sgpr_workgroup_id_x 1
.end_amdhsa_kernel
```
